```python
import torch

def _softmax(x, axis=-1):
    return torch.softmax(x, dim=axis)
def _gelu(x):
    return torch.nn.functional.gelu(x, approximate="tanh")
def _silu(x):
    return torch.nn.functional.silu(x)
def _sigmoid(x):
    return torch.sigmoid(x)
def _layernorm(x, axis=-1, eps=1e-5):
    m = x.mean(dim=axis, keepdim=True)
    v = x.var(dim=axis, keepdim=True, unbiased=False)
    return (x - m) / torch.sqrt(v + eps)
def _scatter_add(tgt, idx, src, axis=0):
    return tgt.clone().index_add_(axis, idx, src)
def _segment_sum(src, seg, n):
    out = torch.zeros((n,) + src.shape[1:], dtype=src.dtype)
    return out.index_add_(0, seg, src)
def _pad(x, pw):
    flat = tuple(v for pair in reversed(pw) for v in pair)
    return torch.nn.functional.pad(x, flat)

kernel_name = 'interleave_layers__ssm_conv_s4d__mixer_token_mlp__prompt'

def setup_inputs():

    _w = (lambda a: (lambda t: t.to(torch.bfloat16) if t.is_floating_point() else t)(torch.as_tensor(a)))
    def _A_setup():
        Bsz, L, D, N = 1, 2048, 512, 128
        return {
            "u": _w((lambda *s: torch.randn(*s, dtype=torch.bfloat16) * 0.05)(Bsz, L, D)),
            "log_A_real": _w((lambda *s: torch.randn(*s, dtype=torch.bfloat16) * 3.2)(D, N) * 0.5),
            "A_imag": _w((lambda *s: torch.randn(*s, dtype=torch.bfloat16) * 0.05)(D, N) * 3.14),
            "C_real": _w((lambda *s: torch.randn(*s, dtype=torch.bfloat16) * 0.05)(D, N) / N ** 0.5),
            "C_imag": _w((lambda *s: torch.randn(*s, dtype=torch.bfloat16) * 0.1)(D, N) / N ** 0.5),
            "log_dt": _w((lambda *s: torch.randn(*s, dtype=torch.bfloat16) * 0.05)(D) * 0.5 - 4.0),
            "D_skip": _w((lambda *s: torch.randn(*s, dtype=torch.bfloat16) * 0.05)(D)),
        }
    _A_in = _A_setup()

    def _B_setup():
        B, S, D, F = 1, 2048, 512, 1792
        return {
            "x": _w((lambda *s: torch.randn(*s, dtype=torch.bfloat16) * 0.05)(B, S, D)),
            "w1": _w((lambda *s: torch.randn(*s, dtype=torch.bfloat16) * 0.4)(S, F) * (S ** -0.5)),
            "b1": _w((lambda *s: torch.randn(*s, dtype=torch.bfloat16) * 12.8)(F) * 0.02),
            "w2": _w((lambda *s: torch.randn(*s, dtype=torch.bfloat16) * 0.4)(F, S) * (F ** -0.5)),
            "b2": _w((lambda *s: torch.randn(*s, dtype=torch.bfloat16) * 6.4)(S) * 0.02),
        }
    _B_in = _B_setup()

    return {
        "A_u": _A_in["u"],
        "A_log_A_real": _A_in["log_A_real"],
        "A_A_imag": _A_in["A_imag"],
        "A_C_real": _A_in["C_real"],
        "A_C_imag": _A_in["C_imag"],
        "A_log_dt": _A_in["log_dt"],
        "A_D_skip": _A_in["D_skip"],
        "B_x": _B_in["x"],
        "B_w1": _B_in["w1"],
        "B_b1": _B_in["b1"],
        "B_w2": _B_in["w2"],
        "B_b2": _B_in["b2"],
    }

def reference(A_u, A_log_A_real, A_A_imag, A_C_real, A_C_imag, A_log_dt, A_D_skip, B_x, B_w1, B_b1, B_w2, B_b2):
    def _A_ref(u, log_A_real, A_imag, C_real, C_imag, log_dt, D_skip):
        L = u.shape[1]
        dt = torch.exp(log_dt)
        A = -torch.exp(log_A_real) + 1j * A_imag
        C = (C_real + 1j * C_imag) * dt[:, None]
        pos = (lambda x, dt: x.to(dt))(torch.arange(L), log_dt.dtype)
        P = torch.exp((A * dt[:, None])[:, :, None] * pos[None, None, :])
        K = 2.0 * torch.einsum("dn,dnl->dl", C, P).real
        L2 = 2 * L
        u_t = (lambda x, *d: x.permute(*d))(u, 0, 2, 1)
        Kf = (lambda x, *a, **k: torch.fft.rfft(x.float(), *a, **k))(K, L2)
        Uf = (lambda x, *a, **k: torch.fft.rfft(x.float(), *a, **k))(u_t, L2)
        y = (lambda x, *a, **k: torch.fft.irfft(x, *a, **k).to(torch.bfloat16))(Uf * Kf[None, :, :], L2)[:, :, :L]
        y = (lambda x, *d: x.permute(*d))(y, 0, 2, 1)
        return y + u * D_skip[None, None, :]

    def _B_ref(x, w1, b1, w2, b2):
        B, S, D = x.shape
        h = _layernorm(x, axis=-1)
        u = torch.einsum("bsd,sf->bdf", h, w1) + b1
        u = _gelu(u)
        y = torch.einsum("bdf,fs->bds", u, w2) + b2
        return (lambda x, *d: x.permute(*d))(y, 0, 2, 1)

    x = A_u
    x = x + _A_ref(_layernorm(x, axis=-1), A_log_A_real, A_A_imag, A_C_real, A_C_imag, A_log_dt, A_D_skip)
    x = x + _B_ref(_layernorm(x, axis=-1), B_w1, B_b1, B_w2, B_b2)
    x = x + _A_ref(_layernorm(x, axis=-1), A_log_A_real, A_A_imag, A_C_real, A_C_imag, A_log_dt, A_D_skip)
    x = x + _B_ref(_layernorm(x, axis=-1), B_w1, B_b1, B_w2, B_b2)
    return x
```

```asm
; @launch grid=(256,1,1) block=(256,1,1) lds=163840
.amdgcn_target "amdgcn-amd-amdhsa--gfx950"
.text
.globl interleave_layers__ssm_conv_s4d__mixer_token_mlp__prompt_kernel
.p2align 8
.type interleave_layers__ssm_conv_s4d__mixer_token_mlp__prompt_kernel,@function
interleave_layers__ssm_conv_s4d__mixer_token_mlp__prompt_kernel:
    s_cmp_ge_u32 s2, 256
    s_cbranch_scc1 interleave_layers__ssm_conv_s4d__mixer_token_mlp__prompt_kernel_end1
    s_load_dwordx16 s[4:19], s[0:1], 0
    s_load_dwordx8 s[20:27], s[0:1], 64
    s_load_dwordx4 s[28:31], s[0:1], 96
    s_load_dwordx2 s[32:33], s[0:1], 112
    s_getpc_b64 s[50:51]
interleave_layers__ssm_conv_s4d__mixer_token_mlp__prompt_kernel_pc2:
    s_lshr_b32 s39, s2, 3
    s_lshl_b32 s39, s39, 11
    v_lshl_add_u32 v15, v0, 3, s39
    v_min_u32 v15, interleave_layers__ssm_conv_s4d__mixer_token_mlp__prompt_kernel_codeend-interleave_layers__ssm_conv_s4d__mixer_token_mlp__prompt_kernel_pc2-8, v15
    global_load_dwordx2 v[140:141], v15, s[50:51]
    v_lshrrev_b32 v15, 6, v0
    v_lshlrev_b32 v1, 4, v0
    v_readfirstlane_b32 s3, v15
    s_and_b32 s39, s2, 7
    s_lshr_b32 s40, s2, 3
    s_lshl_b32 s34, s39, 5
    s_add_u32 s34, s34, s40
    s_and_b32 s35, s39, 1
    s_lshl_b32 s35, s35, 2
    s_and_b32 s41, s40, 3
    s_add_u32 s35, s35, s41
    s_lshl_b32 s41, s35, 4
    s_add_u32 s41, s41, interleave_layers__ssm_conv_s4d__mixer_token_mlp__prompt_kernel_order-interleave_layers__ssm_conv_s4d__mixer_token_mlp__prompt_kernel_pc2
    s_load_dwordx4 s[64:67], s[50:51], s41
    s_lshr_b32 s38, s40, 2
    s_lshr_b32 s39, s39, 1
    s_mul_i32 s36, s39, 7
    s_min_u32 s40, s38, 6
    s_add_u32 s36, s36, s40
    s_lshl_b32 s37, s39, 3
    s_xor_b32 s40, s38, 4
    s_add_u32 s37, s37, s40
    s_mul_i32 s46, s34, 8320
    s_lshl_b32 s47, s34, 13
    v_mov_b32 v136, -1
    v_mov_b32 v137, -1
    v_mov_b32 v138, -1
    v_mov_b32 v139, -1
    v_mov_b32 v120, 0
    v_mov_b32 v121, 0
    v_mov_b32 v122, 0
    v_mov_b32 v123, 0
    v_mov_b32 v124, 0
    v_mov_b32 v125, 0
    v_mov_b32 v126, 0
    v_mov_b32 v127, 0
    v_mov_b32 v128, 0
    v_mov_b32 v129, 0
    v_mov_b32 v130, 0
    v_mov_b32 v131, 0
    v_mov_b32 v132, 0
    v_mov_b32 v133, 0
    v_mov_b32 v134, 0
    v_mov_b32_e64 v135, 0
    v_and_b32 v15, 0xf0, v0
    v_add_lshl_u32 v15, v15, v0, 1
    s_add_u32 s42, s47, 4096
    v_mov_b32 v112, 0
    v_mov_b32 v113, 0
    v_mov_b32 v114, 0
    v_mov_b32 v115, 0
    v_mov_b32_e64 v116, 0
    s_and_b32 s39, s34, 0x78
    s_and_b32 s40, s34, 0x7f
    s_add_u32 s39, s39, s40
    s_lshr_b32 s40, s34, 7
    s_lshl3_add_u32 s40, s40, s39
    s_lshl_b32 s39, s40, 9
    v_lshl_add_u32 v16, v0, 1, s39
    s_lshl_b32 s39, s40, 2
    v_lshrrev_b32 v17, 7, v0
    v_lshl_add_u32 v17, v17, 1, s39
    v_mov_b32 v247, 28049408
    s_waitcnt lgkmcnt(0)
    s_mov_b32 s18, 0x3f80
    s_mov_b32 s19, 0x3f800000
    s_mov_b32 s60, s4
    s_mov_b32 s61, s5
    s_mov_b32 s62, 0x200000
    s_mov_b32 s63, 0x20000
    s_mov_b32 s52, s32
    s_mov_b32 s53, s33
    s_mov_b32 s54, 0x1b01000
    s_mov_b32 s55, 0x20000
    buffer_load_short_d16_hi v120, v15, s[60:63], s47 offen offset:0
    buffer_load_short_d16_hi v128, v15, s[60:63], s47 offen offset:32
    buffer_load_short_d16_hi v121, v15, s[60:63], s47 offen offset:1024
    buffer_load_short_d16_hi v129, v15, s[60:63], s47 offen offset:1056
    buffer_load_short_d16_hi v122, v15, s[60:63], s47 offen offset:2048
    buffer_load_short_d16_hi v130, v15, s[60:63], s47 offen offset:2080
    buffer_load_short_d16_hi v123, v15, s[60:63], s47 offen offset:3072
    buffer_load_short_d16_hi v131, v15, s[60:63], s47 offen offset:3104
    buffer_load_short_d16_hi v124, v15, s[60:63], s42 offen offset:0
    buffer_load_short_d16_hi v132, v15, s[60:63], s42 offen offset:32
    buffer_load_short_d16_hi v125, v15, s[60:63], s42 offen offset:1024
    buffer_load_short_d16_hi v133, v15, s[60:63], s42 offen offset:1056
    buffer_load_short_d16_hi v126, v15, s[60:63], s42 offen offset:2048
    buffer_load_short_d16_hi v134, v15, s[60:63], s42 offen offset:2080
    buffer_load_short_d16_hi v127, v15, s[60:63], s42 offen offset:3072
    buffer_load_short_d16_hi v135, v15, s[60:63], s42 offen offset:3104
    v_mov_b32 v18, 0
    v_mov_b32 v19, 0
    v_and_b32 v15, 0xf0, v0
    v_add_lshl_u32 v15, v15, v0, 1
    global_load_short_d16_hi v18, v15, s[16:17]
    global_load_short_d16_hi v19, v15, s[16:17] offset:32
    global_load_short_d16_hi v112, v16, s[6:7]
    global_load_short_d16_hi v113, v16, s[8:9]
    global_load_short_d16_hi v114, v16, s[10:11]
    global_load_short_d16_hi v115, v16, s[12:13]
    global_load_short_d16_hi v116, v17, s[14:15]
    s_lshl_b32 s39, s34, 4
    s_load_dwordx4 s[72:75], s[26:27], s39
    buffer_load_dword v248, v247, s[52:55], 0 offen sc1
    v_and_b32 v15, 60, v0
    v_add_lshl_u32 v15, v15, s3, 2
    v_and_b32 v16, 0x70, v1
    s_add_u32 s70, s46, 0
    s_add_u32 s71, s70, 4096
    s_mov_b32 s56, s20
    s_mov_b32 s57, s21
    s_mov_b32 s58, 0x700000
    s_mov_b32 s59, 0x20000
    s_mov_b32 s60, s24
    s_mov_b32 s61, s25
    s_mov_b32 s62, 0x700000
    s_mov_b32 s63, 0x20000
    v_lshrrev_b32 v20, 2, v0
    v_xor_b32_e64 v21, v0, v20
    v_bfe_u32 v21, v21, 5, 1
    v_lshrrev_b32 v20, 3, v0
    v_and_b32 v20, 2, v20
    v_and_b32 v17, 3, v0
    v_xor_b32 v20, v17, v20
    v_lshl_add_u32 v21, v21, 2, v20
    v_lshlrev_b32_e64 v21, 4, v21
    v_bfe_u32 v20, v0, 2, 3
    v_lshl_add_u32 v2, v20, 12, v21
    v_and_b32 v17, 4, v20
    v_add_u32 v20, v20, v17
    v_mul_u32_u24 v255, 3584, v20
    v_add_u32 v255, v255, v21
    s_lshl_b32 s4, s3, 12
    s_add_u32 s4, s4, 49152
    s_mul_i32 s5, s3, 1835008
    s_lshl_b32 s39, s36, 7
    s_add_u32 s5, s5, s39
    s_mul_i32 s6, s3, 1835008
    s_lshl_b32 s39, s37, 7
    s_add_u32 s6, s6, s39
    v_add_u32 v254, 56320, v255
    v_add_u32 v253, 12288, v255
    v_add_u32 v252, 68608, v255
    s_cmp_ge_u32 s38, 7
    s_cselect_b32 s5, 0x40000000, s5
    s_bfe_u32 s48, s64, 0x40000
    s_mul_i32 s48, s48, 114688
    s_add_u32 s48, s48, s5
    s_add_u32 m0, s4, 32768
    s_nop 0
    buffer_load_dwordx4 v255, s[56:59], s48 offen offset:0 lds
    buffer_load_dwordx4 v254, s[56:59], s48 offen offset:1024 lds
    buffer_load_dwordx4 v253, s[56:59], s48 offen offset:2048 lds
    buffer_load_dwordx4 v252, s[56:59], s48 offen offset:3072 lds
    s_lshr_b32 s39, s3, 1
    s_and_b32 s40, s3, 1
    s_mul_i32 s41, s39, 16896
    s_lshl_b32 s7, s40, 8
    s_add_u32 s7, s7, s41
    v_bfe_u32 v25, v0, 5, 1
    v_lshl_add_u32 v23, v25, 4, s41
    v_and_b32_e64 v22, 31, v0
    v_mul_u32_u24 v244, 528, v22
    v_add_u32_e64 v244, v244, v23
    s_mov_b32 s39, 0x3020100
    v_writelane_b32 v24, s39, 0
    s_mov_b32 s39, 0xa090808
    v_writelane_b32 v24, s39, 1
    s_mov_b32 s39, 0x7060504
    v_writelane_b32 v24, s39, 2
    s_mov_b32 s39, 0xc0b0a0a
    v_writelane_b32 v24, s39, 3
    s_mov_b32 s39, 0xe0d
    v_writelane_b32 v24, s39, 4
    s_mov_b32 s39, 0x100f
    v_writelane_b32 v24, s39, 5
    s_mov_b32 s39, 0x1211
    v_writelane_b32 v24, s39, 6
    s_mov_b32 s39, 0x1413
    v_writelane_b32 v24, s39, 7
    v_and_b32_e64 v22, 28, v0
    ds_bpermute_b32 v24, v22, v24
    s_add_u32 s39, s41, 64496
    v_and_b32 v243, 0x3f0, v1
    v_sub_u32 v243, s39, v243
    v_and_b32 v22, 1, v0
    v_lshlrev_b32 v242, 8, v22
    v_and_b32 v22, 30, v0
    v_add_u32_e64 v242, v242, v22
    v_lshl_add_u32 v242, v25, 5, v242
    v_lshl_add_u32 v241, v25, 5, v242
    s_add_u32 s39, s41, 62974
    v_sub_u32_e64 v242, s39, v242
    s_add_u32 s39, s41, 62110
    v_sub_u32_e64 v241, s39, v241
    s_add_u32 s39, s41, 60416
    v_mov_b32 v240, s39
    v_and_b32 v22, 3, v0
    v_lshlrev_b32 v22, 3, v22
    s_waitcnt lgkmcnt(0)
    v_bfe_u32 v24, v24, v22, 8
    v_mul_u32_u24 v245, 528, v24
    v_add_u32 v245, v245, v23
    v_mov_b32 v236, 0
    v_mov_b32 v237, 0
    v_mov_b32 v238, 0
    v_mov_b32_e64 v239, 0
    v_bfe_u32 v23, v0, 5, 1
    v_mul_u32_u24 v23, 4672, v23
    v_and_b32_e64 v22, 31, v0
    v_lshl_add_u32 v23, v22, 4, v23
    ds_write_b128 v23, v[236:239] offset:36992
    v_bfe_u32 v235, v0, 2, 3
    v_mul_u32_u24 v235, 4160, v235
    v_and_b32_e64 v22, 3, v0
    v_lshl_add_u32 v235, v22, 4, v235
    v_add_u32 v234, 60416, v1
    v_and_b32_e64 v22, 1, v0
    v_mul_u32_u24 v22, 16896, v22
    v_add_u32 v22, 64512, v22
    ds_write_b128 v234, v[236:239] offset:0
    ds_write_b128 v234, v[236:239] offset:16896
    ds_write_b128 v22, v[236:239]
    s_waitcnt vmcnt(12)
    s_waitcnt lgkmcnt(0)
    v_pk_mul_f32 v[104:105], v[120:121], v[120:121]
    v_pk_mul_f32 v[106:107], v[122:123], v[122:123]
    v_pk_mul_f32 v[108:109], v[124:125], v[124:125]
    v_pk_mul_f32 v[110:111], v[126:127], v[126:127]
    v_pk_add_f32 v[88:89], v[120:121], v[128:129]
    v_pk_add_f32 v[90:91], v[122:123], v[130:131]
    v_pk_add_f32 v[92:93], v[124:125], v[132:133]
    v_pk_add_f32 v[94:95], v[126:127], v[134:135]
    v_pk_fma_f32 v[104:105], v[128:129], v[128:129], v[104:105]
    v_pk_fma_f32 v[106:107], v[130:131], v[130:131], v[106:107]
    v_pk_fma_f32 v[108:109], v[132:133], v[132:133], v[108:109]
    v_pk_fma_f32 v[110:111], v[134:135], v[134:135], v[110:111]
    v_permlane32_swap_b32 v88, v104
    v_permlane32_swap_b32 v89, v105
    v_permlane32_swap_b32 v90, v106
    v_permlane32_swap_b32 v91, v107
    v_permlane32_swap_b32 v92, v108
    v_permlane32_swap_b32 v93, v109
    v_permlane32_swap_b32 v94, v110
    v_permlane32_swap_b32 v95, v111
    v_pk_add_f32 v[88:89], v[88:89], v[104:105]
    v_pk_add_f32 v[92:93], v[92:93], v[108:109]
    v_pk_add_f32 v[90:91], v[90:91], v[106:107]
    v_pk_add_f32 v[94:95], v[94:95], v[110:111]
    v_permlane16_swap_b32 v88, v92
    v_permlane16_swap_b32 v89, v93
    v_permlane16_swap_b32 v90, v94
    v_permlane16_swap_b32 v91, v95
    v_pk_add_f32 v[88:89], v[88:89], v[92:93]
    v_pk_add_f32 v[90:91], v[90:91], v[94:95]
    s_nop 0
    v_add_f32_dpp v104, v88, v88 row_ror:8 row_mask:0xf bank_mask:0x3
    v_add_f32_dpp v105, v89, v89 row_ror:8 row_mask:0xf bank_mask:0x3
    s_nop 0
    v_add_f32_dpp v104, v90, v90 row_ror:8 row_mask:0xf bank_mask:0xc
    v_add_f32_dpp v105, v91, v91 row_ror:8 row_mask:0xf bank_mask:0xc
    s_nop 0
    v_add_f32_dpp v88, v104, v104 row_shl:4 row_mask:0xf bank_mask:0x5
    s_nop 1
    v_add_f32_dpp v88, v105, v105 row_shr:4 row_mask:0xf bank_mask:0xa
    s_nop 1
    v_add_f32_dpp v88, v88, v88 quad_perm:[1,0,3,2] row_mask:0xf bank_mask:0xf
    s_nop 1
    v_add_f32_dpp v88, v88, v88 quad_perm:[2,3,0,1] row_mask:0xf bank_mask:0xf
    ds_write_b32 v15, v88 offset:46336
    v_mov_b32 v95, v95
    v_mov_b32 v95, v95
    v_mov_b32 v95, v95
    v_mov_b32 v95, v95
    s_waitcnt lgkmcnt(0)
    s_barrier
    ds_read_b128 v[88:91], v16 offset:46336
    ds_read_b128 v[104:107], v16 offset:46464
    v_mov_b32 v95, v95
    v_mov_b32 v95, v95
    v_mov_b32 v95, v95
    v_mov_b32 v95, v95
    v_mov_b32_e64 v95, v95
    v_mov_b32 v95, v95
    s_waitcnt lgkmcnt(0)
    v_pk_add_f32 v[88:89], v[88:89], v[90:91]
    v_pk_add_f32 v[104:105], v[104:105], v[106:107]
    v_add_f32 v72, v88, v89
    v_add_f32 v73, v104, v105
    v_mul_f32 v72, 0x3b000000, v72
    v_mul_f32 v73, 0x3b000000, v73
    v_fma_f32 v73, -v72, v72, v73
    v_max_f32_e64 v73, 0, v73
    v_add_f32 v74, 0x3727c5ac, v73
    v_rsq_f32 v74, v74
    s_nop 0
    v_mul_f32 v72, -v72, v74
    v_mov_b32_dpp v88, v74 row_newbcast:0 row_mask:0xf bank_mask:0xf
    v_mov_b32_dpp v89, v74 row_newbcast:1 row_mask:0xf bank_mask:0xf
    v_mov_b32_dpp v90, v74 row_newbcast:2 row_mask:0xf bank_mask:0xf
    v_mov_b32_dpp v91, v74 row_newbcast:3 row_mask:0xf bank_mask:0xf
    v_mov_b32_dpp v92, v74 row_newbcast:4 row_mask:0xf bank_mask:0xf
    v_mov_b32_dpp v93, v74 row_newbcast:5 row_mask:0xf bank_mask:0xf
    v_mov_b32_dpp v94, v74 row_newbcast:6 row_mask:0xf bank_mask:0xf
    v_mov_b32_dpp v95, v74 row_newbcast:7 row_mask:0xf bank_mask:0xf
    v_mov_b32_dpp v104, v72 row_newbcast:0 row_mask:0xf bank_mask:0xf
    v_mov_b32_dpp v105, v72 row_newbcast:1 row_mask:0xf bank_mask:0xf
    v_mov_b32_dpp v106, v72 row_newbcast:2 row_mask:0xf bank_mask:0xf
    v_mov_b32_dpp v107, v72 row_newbcast:3 row_mask:0xf bank_mask:0xf
    v_mov_b32_dpp v108, v72 row_newbcast:4 row_mask:0xf bank_mask:0xf
    v_mov_b32_dpp v109, v72 row_newbcast:5 row_mask:0xf bank_mask:0xf
    v_mov_b32_dpp v110, v72 row_newbcast:6 row_mask:0xf bank_mask:0xf
    v_mov_b32_dpp v111, v72 row_newbcast:7 row_mask:0xf bank_mask:0xf
    v_pk_fma_f32 v[72:73], v[120:121], v[88:89], v[104:105]
    v_pk_fma_f32 v[74:75], v[122:123], v[90:91], v[106:107]
    v_pk_fma_f32 v[76:77], v[124:125], v[92:93], v[108:109]
    v_pk_fma_f32 v[78:79], v[126:127], v[94:95], v[110:111]
    v_cvt_pk_bf16_f32 v96, v72, v73
    v_cvt_pk_bf16_f32 v97, v74, v75
    v_cvt_pk_bf16_f32 v98, v76, v77
    v_cvt_pk_bf16_f32 v99, v78, v79
    buffer_store_dwordx4 v[96:99], v1, s[52:55], s70 offen sc1
    v_pk_fma_f32 v[80:81], v[128:129], v[88:89], v[104:105]
    v_pk_fma_f32 v[82:83], v[130:131], v[90:91], v[106:107]
    v_pk_fma_f32 v[84:85], v[132:133], v[92:93], v[108:109]
    v_pk_fma_f32 v[86:87], v[134:135], v[94:95], v[110:111]
    v_cvt_pk_bf16_f32 v100, v80, v81
    v_cvt_pk_bf16_f32 v101, v82, v83
    v_cvt_pk_bf16_f32 v102, v84, v85
    v_cvt_pk_bf16_f32 v103, v86, v87
    buffer_store_dwordx4 v[100:103], v1, s[52:55], s71 offen sc1
    s_nop 0
    s_waitcnt vmcnt(12)
    v_pk_fma_f32 v[120:121], v[72:73], v[18:19], v[120:121] op_sel:[0,0,0] op_sel_hi:[1,0,1]
    v_pk_fma_f32 v[122:123], v[74:75], v[18:19], v[122:123] op_sel:[0,0,0] op_sel_hi:[1,0,1]
    v_pk_fma_f32 v[124:125], v[76:77], v[18:19], v[124:125] op_sel:[0,0,0] op_sel_hi:[1,0,1]
    v_pk_fma_f32 v[126:127], v[78:79], v[18:19], v[126:127] op_sel:[0,0,0] op_sel_hi:[1,0,1]
    v_pk_fma_f32 v[128:129], v[80:81], v[18:19], v[128:129] op_sel:[0,1,0] op_sel_hi:[1,1,1]
    v_pk_fma_f32 v[130:131], v[82:83], v[18:19], v[130:131] op_sel:[0,1,0] op_sel_hi:[1,1,1]
    v_pk_fma_f32 v[132:133], v[84:85], v[18:19], v[132:133] op_sel:[0,1,0] op_sel_hi:[1,1,1]
    v_pk_fma_f32 v[134:135], v[86:87], v[18:19], v[134:135] op_sel:[0,1,0] op_sel_hi:[1,1,1]
    s_add_u32 s49, s46, 2359296
    buffer_store_dwordx4 v[136:139], v1, s[52:55], s49 offen sc1
    s_add_u32 s49, s46, 2363392
    buffer_store_dwordx4 v[136:139], v1, s[52:55], s49 offen sc1
    v_lshrrev_b32_e64 v15, 1, v0
    v_mul_u32_u24 v88, 8320, v15
    v_and_b32_e64 v15, 1, v0
    v_lshl_add_u32 v88, v15, 4, v88
    s_lshl_b32 s8, s34, 5
    s_add_u32 s8, s8, 0
    s_add_u32 s9, s8, 1064960
    v_bfe_u32 v247, v0, 5, 1
    v_and_b32_e64 v246, 31, v0
    v_lshl_add_u32 v247, v247, 7, v246
    v_mul_u32_u24_e64 v247, 64, v247
    s_mul_i32 s10, s3, 2048
    s_add_u32 s10, s10, 27918336
    v_bfe_u32 v20, v0, 5, 1
    v_lshl_add_u32 v6, v20, 10, s4
    v_bfe_u32 v20, v0, 2, 3
    v_lshl_add_u32 v6, v20, 6, v6
    v_bfe_u32 v20, v0, 4, 1
    v_lshl_add_u32 v6, v20, 5, v6
    v_and_b32_e64 v20, 3, v0
    v_lshl_add_u32 v6, v20, 3, v6
    v_xor_b32_e64 v7, 32, v6
    v_add_u32 v8, 0x10000, v6
    v_xor_b32_e64 v9, 32, v8
    s_mov_b32 vcc_lo, 0x380
    s_mov_b32 vcc_hi, 0x7c000
    s_cmp_eq_u32 s3, 1
    s_cmov_b32 vcc_lo, 0xfe00000
    s_cmov_b32 vcc_hi, 0x0
    s_cmp_eq_u32 s3, 2
    s_cmov_b32 vcc_lo, 0x380
    s_cmov_b32 vcc_hi, 0x7c000
    s_cmp_eq_u32 s3, 3
    s_cmov_b32 vcc_lo, 0x1ff00000
    s_cmov_b32 vcc_hi, 0x0
    v_mov_b32 v16, 0x3f80
    v_cndmask_b32 v16, 0, v16, vcc
    v_lshlrev_b32_e64 v15, 1, v0
    v_sub_u32 v15, 61726, v15
    ds_write_b16 v15, v16 offset:0
    ds_write_b16 v15, v16 offset:16896
    s_waitcnt vmcnt(9)
    v_mul_f32 v112, 0x3fb8aa3b, v112
    v_mul_f32 v116, 0x3fb8aa3b, v116
    v_exp_f32 v112, v112
    v_exp_f32 v116, v116
    s_nop 0
    v_cvt_pk_bf16_f32 v16, v112, v116
    v_lshlrev_b32_e64 v112, 16, v16
    v_and_b32 v116, 0xffff0000, v16
    v_mul_f32 v112, v112, v116
    v_mul_f32 v113, v113, v116
    v_add_f32_e64 v116, v116, v116
    v_mul_f32 v112, 0xbfb8aa3b, v112
    v_mul_f32 v113, 0x3e22f983, v113
    v_mul_f32 v18, v114, v116
    v_mul_f32 v19, v115, v116
    v_mul_f32 v21, 0x3f800000, v113
    v_mul_f32 v23, 0x41000000, v113
    v_mul_f32 v25, 0x43800000, v113
    v_mul_f32 v27, 0x43000000, v113
    v_mul_f32_e64 v20, 0x3f800000, v112
    v_mul_f32 v22, 0x41000000, v112
    v_mul_f32 v24, 0x43800000, v112
    v_mul_f32 v26, 0x43000000, v112
    v_fract_f32 v21, v21
    v_fract_f32 v23, v23
    v_fract_f32 v25, v25
    v_fract_f32 v27, v27
    v_exp_f32 v20, v20
    v_exp_f32 v22, v22
    v_exp_f32 v24, v24
    v_exp_f32 v26, v26
    v_cos_f32 v36, v21
    v_cos_f32 v38, v23
    v_cos_f32 v40, v25
    v_cos_f32 v42, v27
    v_sin_f32 v37, v21
    v_sin_f32 v39, v23
    v_sin_f32 v41, v25
    v_sin_f32 v43, v27
    v_pk_mul_f32 v[36:37], v[36:37], v[20:21] op_sel_hi:[1,0]
    v_pk_mul_f32 v[38:39], v[38:39], v[22:23] op_sel_hi:[1,0]
    v_pk_mul_f32 v[40:41], v[40:41], v[24:25] op_sel_hi:[1,0]
    v_pk_mul_f32 v[42:43], v[42:43], v[26:27] op_sel_hi:[1,0]
    s_nop 0
    s_mov_b32 m0, s7
    v_cvt_pk_bf16_f32 v15, v18, -v19
    v_mov_b32 v48, 0x3f80
    v_pk_mul_f32 v[34:35], v[18:19], v[38:39] op_sel_hi:[1,0]
    v_add_u32 v3, 31744, v2
    v_cvt_pk_bf16_f32 v60, v42, v43
    ds_write_addtid_b32 v15 offset:49152
    ds_write_addtid_b32 v48
    v_add_u32 v4, 63488, v2
    v_pk_fma_f32 v[34:35], v[18:19], v[38:39], v[34:35] op_sel:[1,1,0] op_sel_hi:[0,1,1] neg_lo:[0,1,0]
    ds_write_addtid_b32 v60 offset:8448
    v_pk_mul_f32 v[20:21], v[18:19], v[36:37] op_sel_hi:[1,0]
    v_add_u32 v5, 95232, v2
    v_cvt_pk_bf16_f32 v48, v38, v39
    v_pk_mul_f32 v[50:51], v[18:19], v[40:41] op_sel_hi:[1,0]
    v_pk_mul_f32 v[58:59], v[42:43], v[38:39] op_sel_hi:[1,0]
    s_bfe_u32 s48, s64, 0x40004
    v_pk_fma_f32 v[20:21], v[18:19], v[36:37], v[20:21] op_sel:[1,1,0] op_sel_hi:[0,1,1] neg_lo:[0,1,0]
    ds_write_addtid_b32 v48 offset:528
    v_pk_fma_f32 v[50:51], v[18:19], v[40:41], v[50:51] op_sel:[1,1,0] op_sel_hi:[0,1,1] neg_lo:[0,1,0]
    s_mul_i32 s48, s48, 114688
    v_pk_fma_f32 v[58:59], v[42:43], v[38:39], v[58:59] op_sel:[1,1,0] op_sel_hi:[0,1,1] neg_lo:[0,1,0]
    v_cvt_pk_bf16_f32 v15, v20, -v21
    v_pk_mul_f32 v[44:45], v[38:39], v[38:39] op_sel_hi:[1,0]
    s_nop 0
    s_add_u32 s48, s48, s5
    v_cvt_pk_bf16_f32 v49, v50, -v51
    v_cvt_pk_bf16_f32 v60, v58, v59
    ds_write_addtid_b32 v15 offset:49680
    s_add_u32 s69, s4, 49152
    v_pk_fma_f32 v[44:45], v[38:39], v[38:39], v[44:45] op_sel:[1,1,0] op_sel_hi:[0,1,1] neg_lo:[0,1,0]
    ds_write_addtid_b32 v49 offset:53376
    ds_write_addtid_b32 v60 offset:8976
    s_mov_b32 m0, s69
    s_nop 0
    buffer_load_dwordx4 v255, s[56:59], s48 offen offset:0 lds
    s_nop 0
    s_mov_b32 m0, s7
    v_pk_mul_f32 v[22:23], v[20:21], v[36:37] op_sel_hi:[1,0]
    v_cvt_pk_bf16_f32 v48, v44, v45
    v_pk_mul_f32 v[52:53], v[34:35], v[40:41] op_sel_hi:[1,0]
    v_pk_mul_f32 v[56:57], v[58:59], v[38:39] op_sel_hi:[1,0]
    v_pk_fma_f32 v[22:23], v[20:21], v[36:37], v[22:23] op_sel:[1,1,0] op_sel_hi:[0,1,1] neg_lo:[0,1,0]
    ds_write_addtid_b32 v48 offset:1056
    v_pk_fma_f32 v[52:53], v[34:35], v[40:41], v[52:53] op_sel:[1,1,0] op_sel_hi:[0,1,1] neg_lo:[0,1,0]
    v_pk_fma_f32 v[56:57], v[58:59], v[38:39], v[56:57] op_sel:[1,1,0] op_sel_hi:[0,1,1] neg_lo:[0,1,0]
    v_cvt_pk_bf16_f32 v15, v22, -v23
    v_pk_mul_f32 v[46:47], v[44:45], v[38:39] op_sel_hi:[1,0]
    v_cvt_pk_bf16_f32 v49, v52, -v53
    v_cvt_pk_bf16_f32 v60, v56, v57
    ds_write_addtid_b32 v15 offset:50208
    v_pk_fma_f32 v[46:47], v[44:45], v[38:39], v[46:47] op_sel:[1,1,0] op_sel_hi:[0,1,1] neg_lo:[0,1,0]
    ds_write_addtid_b32 v49 offset:55488
    s_mov_b32 m0, s69
    s_nop 0
    buffer_load_dwordx4 v254, s[56:59], s48 offen offset:1024 lds
    s_mov_b32 m0, s7
    s_nop 0
    ds_write_addtid_b32 v60 offset:9504
    v_pk_mul_f32 v[24:25], v[22:23], v[36:37] op_sel_hi:[1,0]
    v_cvt_pk_bf16_f32 v48, v46, v47
    v_pk_mul_f32 v[54:55], v[52:53], v[40:41] op_sel_hi:[1,0]
    v_pk_mul_f32 v[58:59], v[56:57], v[38:39] op_sel_hi:[1,0]
    v_pk_fma_f32 v[24:25], v[22:23], v[36:37], v[24:25] op_sel:[1,1,0] op_sel_hi:[0,1,1] neg_lo:[0,1,0]
    ds_write_addtid_b32 v48 offset:1584
    v_pk_fma_f32 v[54:55], v[52:53], v[40:41], v[54:55] op_sel:[1,1,0] op_sel_hi:[0,1,1] neg_lo:[0,1,0]
    v_pk_fma_f32 v[58:59], v[56:57], v[38:39], v[58:59] op_sel:[1,1,0] op_sel_hi:[0,1,1] neg_lo:[0,1,0]
    v_cvt_pk_bf16_f32 v15, v24, -v25
    v_pk_mul_f32 v[44:45], v[46:47], v[38:39] op_sel_hi:[1,0]
    v_cvt_pk_bf16_f32 v49, v54, -v55
    v_cvt_pk_bf16_f32 v60, v58, v59
    ds_write_addtid_b32 v15 offset:50736
    v_pk_fma_f32 v[44:45], v[46:47], v[38:39], v[44:45] op_sel:[1,1,0] op_sel_hi:[0,1,1] neg_lo:[0,1,0]
    s_mov_b32 m0, s69
    s_nop 0
    buffer_load_dwordx4 v253, s[56:59], s48 offen offset:2048 lds
    s_mov_b32 m0, s7
    s_nop 0
    ds_write_addtid_b32 v49 offset:56544
    ds_write_addtid_b32 v60 offset:10032
    v_pk_mul_f32 v[26:27], v[24:25], v[36:37] op_sel_hi:[1,0]
    v_cvt_pk_bf16_f32 v48, v44, v45
    v_pk_mul_f32 v[52:53], v[54:55], v[40:41] op_sel_hi:[1,0]
    v_pk_mul_f32 v[56:57], v[58:59], v[38:39] op_sel_hi:[1,0]
    v_pk_fma_f32 v[26:27], v[24:25], v[36:37], v[26:27] op_sel:[1,1,0] op_sel_hi:[0,1,1] neg_lo:[0,1,0]
    ds_write_addtid_b32 v48 offset:2112
    v_pk_fma_f32 v[52:53], v[54:55], v[40:41], v[52:53] op_sel:[1,1,0] op_sel_hi:[0,1,1] neg_lo:[0,1,0]
    v_pk_fma_f32 v[56:57], v[58:59], v[38:39], v[56:57] op_sel:[1,1,0] op_sel_hi:[0,1,1] neg_lo:[0,1,0]
    v_cvt_pk_bf16_f32 v15, v26, -v27
    v_pk_mul_f32 v[46:47], v[44:45], v[38:39] op_sel_hi:[1,0]
    v_cvt_pk_bf16_f32 v49, v52, -v53
    v_cvt_pk_bf16_f32 v60, v56, v57
    ds_write_addtid_b32 v15 offset:51264
    s_mov_b32 m0, s69
    s_nop 0
    buffer_load_dwordx4 v252, s[56:59], s48 offen offset:3072 lds
    s_nop 0
    s_mov_b32 m0, s7
    v_pk_fma_f32 v[46:47], v[44:45], v[38:39], v[46:47] op_sel:[1,1,0] op_sel_hi:[0,1,1] neg_lo:[0,1,0]
    ds_write_addtid_b32 v49 offset:57600
    ds_write_addtid_b32 v60 offset:10560
    v_pk_mul_f32 v[28:29], v[26:27], v[36:37] op_sel_hi:[1,0]
    v_cvt_pk_bf16_f32 v48, v46, v47
    v_pk_mul_f32 v[54:55], v[52:53], v[40:41] op_sel_hi:[1,0]
    v_pk_mul_f32 v[58:59], v[56:57], v[38:39] op_sel_hi:[1,0]
    v_pk_fma_f32 v[28:29], v[26:27], v[36:37], v[28:29] op_sel:[1,1,0] op_sel_hi:[0,1,1] neg_lo:[0,1,0]
    ds_write_addtid_b32 v48 offset:2640
    v_pk_fma_f32 v[54:55], v[52:53], v[40:41], v[54:55] op_sel:[1,1,0] op_sel_hi:[0,1,1] neg_lo:[0,1,0]
    v_pk_fma_f32 v[58:59], v[56:57], v[38:39], v[58:59] op_sel:[1,1,0] op_sel_hi:[0,1,1] neg_lo:[0,1,0]
    v_cvt_pk_bf16_f32 v15, v28, -v29
    v_pk_mul_f32 v[44:45], v[46:47], v[38:39] op_sel_hi:[1,0]
    v_cvt_pk_bf16_f32 v49, v54, -v55
    v_cvt_pk_bf16_f32 v60, v58, v59
    ds_write_addtid_b32 v15 offset:51792
    v_pk_fma_f32 v[44:45], v[46:47], v[38:39], v[44:45] op_sel:[1,1,0] op_sel_hi:[0,1,1] neg_lo:[0,1,0]
    ds_write_addtid_b32 v49 offset:58128
    ds_write_addtid_b32 v60 offset:11088
    v_pk_mul_f32 v[30:31], v[28:29], v[36:37] op_sel_hi:[1,0]
    v_cvt_pk_bf16_f32 v48, v44, v45
    v_pk_mul_f32 v[52:53], v[54:55], v[40:41] op_sel_hi:[1,0]
    v_pk_mul_f32 v[56:57], v[58:59], v[38:39] op_sel_hi:[1,0]
    v_pk_fma_f32 v[30:31], v[28:29], v[36:37], v[30:31] op_sel:[1,1,0] op_sel_hi:[0,1,1] neg_lo:[0,1,0]
    ds_write_addtid_b32 v48 offset:3168
    v_pk_fma_f32 v[52:53], v[54:55], v[40:41], v[52:53] op_sel:[1,1,0] op_sel_hi:[0,1,1] neg_lo:[0,1,0]
    v_pk_fma_f32 v[56:57], v[58:59], v[38:39], v[56:57] op_sel:[1,1,0] op_sel_hi:[0,1,1] neg_lo:[0,1,0]
    v_cvt_pk_bf16_f32 v15, v30, -v31
    v_pk_mul_f32 v[46:47], v[44:45], v[38:39] op_sel_hi:[1,0]
    v_cvt_pk_bf16_f32 v49, v52, -v53
    v_cvt_pk_bf16_f32 v60, v56, v57
    ds_write_addtid_b32 v15 offset:52320
    v_pk_fma_f32 v[46:47], v[44:45], v[38:39], v[46:47] op_sel:[1,1,0] op_sel_hi:[0,1,1] neg_lo:[0,1,0]
    ds_write_addtid_b32 v49 offset:58656
    ds_write_addtid_b32 v60 offset:11616
    v_pk_mul_f32 v[32:33], v[30:31], v[36:37] op_sel_hi:[1,0]
    v_cvt_pk_bf16_f32 v48, v46, v47
    v_pk_mul_f32 v[54:55], v[52:53], v[40:41] op_sel_hi:[1,0]
    v_pk_mul_f32 v[58:59], v[56:57], v[38:39] op_sel_hi:[1,0]
    v_pk_fma_f32 v[32:33], v[30:31], v[36:37], v[32:33] op_sel:[1,1,0] op_sel_hi:[0,1,1] neg_lo:[0,1,0]
    ds_write_addtid_b32 v48 offset:3696
    v_pk_fma_f32 v[54:55], v[52:53], v[40:41], v[54:55] op_sel:[1,1,0] op_sel_hi:[0,1,1] neg_lo:[0,1,0]
    v_pk_fma_f32 v[58:59], v[56:57], v[38:39], v[58:59] op_sel:[1,1,0] op_sel_hi:[0,1,1] neg_lo:[0,1,0]
    v_cvt_pk_bf16_f32 v15, v32, -v33
    v_pk_mul_f32 v[44:45], v[46:47], v[38:39] op_sel_hi:[1,0]
    v_cvt_pk_bf16_f32 v49, v54, -v55
    v_cvt_pk_bf16_f32 v60, v58, v59
    ds_write_addtid_b32 v15 offset:52848
    v_pk_fma_f32 v[44:45], v[46:47], v[38:39], v[44:45] op_sel:[1,1,0] op_sel_hi:[0,1,1] neg_lo:[0,1,0]
    ds_write_addtid_b32 v49 offset:59184
    ds_write_addtid_b32 v60 offset:12144
    s_waitcnt vmcnt(4)
    s_barrier
    v_readfirstlane_b32 s68, v248
    s_nop 0
    s_add_u32 s68, s68, 0x9e3779b9
    v_mov_b32 v248, s68
    v_lshrrev_b32 v246, 2, v0
    v_lshl_add_u32 v246, v246, 25, v1
    s_nop 0
    s_mul_i32 s39, s34, 64
    s_add_u32 s39, s39, 27918336
    buffer_store_dwordx4 v[248:251], v246, s[52:55], s39 offen sc1
    v_pk_mul_f32 v[20:21], v[22:23], v[40:41] op_sel_hi:[1,0]
    v_cvt_pk_bf16_f32 v48, v44, v45
    v_pk_mul_f32 v[52:53], v[54:55], v[40:41] op_sel_hi:[1,0]
    s_add_u32 s49, s47, 4718592
    v_pk_mul_f32 v[56:57], v[58:59], v[38:39] op_sel_hi:[1,0]
    v_pk_fma_f32 v[20:21], v[22:23], v[40:41], v[20:21] op_sel:[1,1,0] op_sel_hi:[0,1,1] neg_lo:[0,1,0]
    ds_write_addtid_b32 v48 offset:4224
    buffer_store_dwordx4 v[136:139], v1, s[52:55], s49 offen sc1
    v_pk_fma_f32 v[52:53], v[54:55], v[40:41], v[52:53] op_sel:[1,1,0] op_sel_hi:[0,1,1] neg_lo:[0,1,0]
    v_pk_fma_f32 v[56:57], v[58:59], v[38:39], v[56:57] op_sel:[1,1,0] op_sel_hi:[0,1,1] neg_lo:[0,1,0]
    v_cvt_pk_bf16_f32 v15, v20, -v21
    s_add_u32 s49, s47, 4722688
    v_pk_mul_f32 v[46:47], v[44:45], v[38:39] op_sel_hi:[1,0]
    v_cvt_pk_bf16_f32 v49, v52, -v53
    v_cvt_pk_bf16_f32 v60, v56, v57
    ds_read_b64_tr_b16 a[0:1], v6 offset:32768
    ds_write_addtid_b32 v15 offset:53904
    v_pk_fma_f32 v[46:47], v[44:45], v[38:39], v[46:47] op_sel:[1,1,0] op_sel_hi:[0,1,1] neg_lo:[0,1,0]
    ds_write_addtid_b32 v49 offset:59712
    ds_read_b64_tr_b16 a[2:3], v6 offset:34816
    ds_write_addtid_b32 v60 offset:12672
    v_pk_mul_f32 v[24:25], v[30:31], v[40:41] op_sel_hi:[1,0]
    v_cvt_pk_bf16_f32 v48, v46, v47
    ds_read_b64_tr_b16 a[4:5], v7 offset:32768
    v_pk_mul_f32 v[58:59], v[56:57], v[38:39] op_sel_hi:[1,0]
    v_pk_fma_f32 v[24:25], v[30:31], v[40:41], v[24:25] op_sel:[1,1,0] op_sel_hi:[0,1,1] neg_lo:[0,1,0]
    ds_write_addtid_b32 v48 offset:4752
    buffer_store_dwordx4 v[136:139], v1, s[52:55], s49 offen sc1
    v_pk_fma_f32 v[58:59], v[56:57], v[38:39], v[58:59] op_sel:[1,1,0] op_sel_hi:[0,1,1] neg_lo:[0,1,0]
    v_cvt_pk_bf16_f32 v15, v24, -v25
    v_pk_mul_f32 v[44:45], v[46:47], v[38:39] op_sel_hi:[1,0]
    s_bfe_u32 s48, s64, 0x40008
    v_cvt_pk_bf16_f32 v60, v58, v59
    ds_write_addtid_b32 v15 offset:54960
    v_pk_fma_f32 v[44:45], v[46:47], v[38:39], v[44:45] op_sel:[1,1,0] op_sel_hi:[0,1,1] neg_lo:[0,1,0]
    s_mul_i32 s48, s48, 114688
    ds_write_addtid_b32 v60 offset:13200
    v_pk_mul_f32 v[28:29], v[26:27], v[40:41] op_sel_hi:[1,0]
    v_cvt_pk_bf16_f32 v48, v44, v45
    s_nop 0
    s_add_u32 s48, s48, s5
    v_pk_mul_f32 v[56:57], v[58:59], v[38:39] op_sel_hi:[1,0]
    v_pk_fma_f32 v[28:29], v[26:27], v[40:41], v[28:29] op_sel:[1,1,0] op_sel_hi:[0,1,1] neg_lo:[0,1,0]
    ds_write_addtid_b32 v48 offset:5280
    s_add_u32 s69, s4, 65536
    v_pk_fma_f32 v[56:57], v[58:59], v[38:39], v[56:57] op_sel:[1,1,0] op_sel_hi:[0,1,1] neg_lo:[0,1,0]
    v_cvt_pk_bf16_f32 v15, v28, -v29
    v_pk_mul_f32 v[46:47], v[44:45], v[38:39] op_sel_hi:[1,0]
    s_mov_b32 m0, s69
    s_nop 0
    buffer_load_dwordx4 v255, s[56:59], s48 offen offset:0 lds
    s_nop 0
    s_mov_b32 m0, s7
    v_cvt_pk_bf16_f32 v60, v56, v57
    ds_write_addtid_b32 v15 offset:54432
    v_pk_fma_f32 v[46:47], v[44:45], v[38:39], v[46:47] op_sel:[1,1,0] op_sel_hi:[0,1,1] neg_lo:[0,1,0]
    ds_read_b64_tr_b16 a[6:7], v7 offset:34816
    ds_write_addtid_b32 v60 offset:13728
    v_pk_mul_f32 v[26:27], v[28:29], v[40:41] op_sel_hi:[1,0]
    v_cvt_pk_bf16_f32 v48, v46, v47
    ds_read_b64_tr_b16 a[8:9], v6 offset:33280
    v_pk_mul_f32 v[58:59], v[56:57], v[38:39] op_sel_hi:[1,0]
    v_pk_fma_f32 v[26:27], v[28:29], v[40:41], v[26:27] op_sel:[1,1,0] op_sel_hi:[0,1,1] neg_lo:[0,1,0]
    ds_write_addtid_b32 v48 offset:5808
    ds_read_b64_tr_b16 a[10:11], v6 offset:35328
    v_pk_fma_f32 v[58:59], v[56:57], v[38:39], v[58:59] op_sel:[1,1,0] op_sel_hi:[0,1,1] neg_lo:[0,1,0]
    v_cvt_pk_bf16_f32 v15, v26, -v27
    v_pk_mul_f32 v[44:45], v[46:47], v[38:39] op_sel_hi:[1,0]
    ds_read_b64_tr_b16 a[12:13], v7 offset:33280
    v_cvt_pk_bf16_f32 v60, v58, v59
    ds_write_addtid_b32 v15 offset:56016
    v_pk_fma_f32 v[44:45], v[46:47], v[38:39], v[44:45] op_sel:[1,1,0] op_sel_hi:[0,1,1] neg_lo:[0,1,0]
    s_mov_b32 m0, s69
    s_nop 0
    buffer_load_dwordx4 v254, s[56:59], s48 offen offset:1024 lds
    s_mov_b32 m0, s7
    s_nop 0
    ds_write_addtid_b32 v60 offset:14256
    v_pk_mul_f32 v[28:29], v[26:27], v[40:41] op_sel_hi:[1,0]
    v_cvt_pk_bf16_f32 v48, v44, v45
    ds_read_b64_tr_b16 a[14:15], v7 offset:35328
    v_pk_mul_f32 v[56:57], v[58:59], v[38:39] op_sel_hi:[1,0]
    v_pk_fma_f32 v[28:29], v[26:27], v[40:41], v[28:29] op_sel:[1,1,0] op_sel_hi:[0,1,1] neg_lo:[0,1,0]
    ds_write_addtid_b32 v48 offset:6336
    v_pk_fma_f32 v[56:57], v[58:59], v[38:39], v[56:57] op_sel:[1,1,0] op_sel_hi:[0,1,1] neg_lo:[0,1,0]
    v_cvt_pk_bf16_f32 v15, v28, -v29
    v_pk_mul_f32 v[46:47], v[44:45], v[38:39] op_sel_hi:[1,0]
    v_cvt_pk_bf16_f32 v60, v56, v57
    ds_write_addtid_b32 v15 offset:57072
    v_pk_fma_f32 v[46:47], v[44:45], v[38:39], v[46:47] op_sel:[1,1,0] op_sel_hi:[0,1,1] neg_lo:[0,1,0]
    ds_write_addtid_b32 v60 offset:14784
    v_cvt_pk_bf16_f32 v48, v46, v47
    v_pk_mul_f32 v[58:59], v[56:57], v[38:39] op_sel_hi:[1,0]
    s_mov_b32 m0, s69
    s_nop 0
    buffer_load_dwordx4 v253, s[56:59], s48 offen offset:2048 lds
    s_mov_b32 m0, s7
    s_nop 0
    ds_write_addtid_b32 v48 offset:6864
    v_pk_fma_f32 v[58:59], v[56:57], v[38:39], v[58:59] op_sel:[1,1,0] op_sel_hi:[0,1,1] neg_lo:[0,1,0]
    v_pk_mul_f32 v[44:45], v[46:47], v[38:39] op_sel_hi:[1,0]
    v_cvt_pk_bf16_f32 v60, v58, v59
    v_pk_fma_f32 v[44:45], v[46:47], v[38:39], v[44:45] op_sel:[1,1,0] op_sel_hi:[0,1,1] neg_lo:[0,1,0]
    ds_write_addtid_b32 v60 offset:15312
    v_cvt_pk_bf16_f32 v48, v44, v45
    v_pk_mul_f32 v[56:57], v[58:59], v[38:39] op_sel_hi:[1,0]
    ds_write_addtid_b32 v48 offset:7392
    v_pk_fma_f32 v[56:57], v[58:59], v[38:39], v[56:57] op_sel:[1,1,0] op_sel_hi:[0,1,1] neg_lo:[0,1,0]
    v_pk_mul_f32 v[46:47], v[44:45], v[38:39] op_sel_hi:[1,0]
    v_cvt_pk_bf16_f32 v60, v56, v57
    v_pk_fma_f32 v[46:47], v[44:45], v[38:39], v[46:47] op_sel:[1,1,0] op_sel_hi:[0,1,1] neg_lo:[0,1,0]
    ds_write_addtid_b32 v60 offset:15840
    v_cvt_pk_bf16_f32 v48, v46, v47
    s_mov_b32 m0, s69
    s_nop 0
    buffer_load_dwordx4 v252, s[56:59], s48 offen offset:3072 lds
    s_mov_b32 m0, s7
    v_pk_mul_f32 v[58:59], v[56:57], v[38:39] op_sel_hi:[1,0]
    ds_write_addtid_b32 v48 offset:7920
    v_pk_fma_f32 v[58:59], v[56:57], v[38:39], v[58:59] op_sel:[1,1,0] op_sel_hi:[0,1,1] neg_lo:[0,1,0]
    s_bfe_u32 s48, s64, 0x4000c
    v_cvt_pk_bf16_f32 v60, v58, v59
    ds_write_addtid_b32 v60 offset:16368
    s_nop 0
    s_waitcnt lgkmcnt(0)
    s_barrier
    ds_read_b128 v[116:119], v245 offset:49152
    ds_read_b128 v[52:55], v244 offset:0
    ds_read_b128 v[112:115], v245 offset:49184
    ds_read_b128 v[48:51], v244 offset:32
    ds_read_b128 v[60:63], v245 offset:49216
    ds_read_b128 v[44:47], v244 offset:64
    ds_read_b128 v[56:59], v245 offset:49248
    ds_read_b128 v[40:43], v244 offset:96
    s_waitcnt lgkmcnt(6)
    v_mfma_f32_32x32x16_bf16 v[64:79], v[116:119], v[52:55], 0
    ds_read_b128 v[116:119], v245 offset:49280
    ds_read_b128 v[52:55], v244 offset:128
    s_mul_i32 s48, s48, 114688
    s_add_u32 s48, s48, s5
    s_waitcnt lgkmcnt(6)
    v_mfma_f32_32x32x16_bf16 v[64:79], v[112:115], v[48:51], v[64:79]
    ds_read_b128 v[112:115], v245 offset:49312
    ds_read_b128 v[48:51], v244 offset:160
    s_add_u32 m0, s4, 81920
    s_nop 0
    buffer_load_dwordx4 v255, s[56:59], s48 offen offset:0 lds
    s_waitcnt lgkmcnt(6)
    v_mfma_f32_32x32x16_bf16 v[64:79], v[60:63], v[44:47], v[64:79]
    ds_read_b128 v[60:63], v245 offset:49344
    ds_read_b128 v[44:47], v244 offset:192
    s_waitcnt lgkmcnt(6)
    v_mfma_f32_32x32x16_bf16 v[64:79], v[56:59], v[40:43], v[64:79]
    ds_read_b128 v[56:59], v245 offset:49376
    ds_read_b128 v[40:43], v244 offset:224
    buffer_load_dwordx4 v254, s[56:59], s48 offen offset:1024 lds
    s_waitcnt lgkmcnt(6)
    v_mfma_f32_32x32x16_bf16 v[64:79], v[116:119], v[52:55], v[64:79]
    ds_read_b128 v[116:119], v245 offset:49408
    ds_read_b128 v[52:55], v244 offset:256
    s_waitcnt lgkmcnt(6)
    v_mfma_f32_32x32x16_bf16 v[64:79], v[112:115], v[48:51], v[64:79]
    ds_read_b128 v[112:115], v245 offset:49440
    ds_read_b128 v[48:51], v244 offset:288
    buffer_load_dwordx4 v253, s[56:59], s48 offen offset:2048 lds
    s_waitcnt lgkmcnt(6)
    v_mfma_f32_32x32x16_bf16 v[64:79], v[60:63], v[44:47], v[64:79]
    ds_read_b128 v[60:63], v245 offset:49472
    ds_read_b128 v[44:47], v244 offset:320
    s_waitcnt lgkmcnt(6)
    v_mfma_f32_32x32x16_bf16 v[64:79], v[56:59], v[40:43], v[64:79]
    ds_read_b128 v[56:59], v245 offset:49504
    ds_read_b128 v[40:43], v244 offset:352
    buffer_load_dwordx4 v252, s[56:59], s48 offen offset:3072 lds
    s_bfe_u32 s48, s64, 0x40010
    s_waitcnt lgkmcnt(6)
    v_mfma_f32_32x32x16_bf16 v[64:79], v[116:119], v[52:55], v[64:79]
    ds_read_b128 v[116:119], v245 offset:49536
    ds_read_b128 v[52:55], v244 offset:384
    s_mul_i32 s48, s48, 114688
    s_add_u32 s48, s48, s5
    s_waitcnt lgkmcnt(6)
    v_mfma_f32_32x32x16_bf16 v[64:79], v[112:115], v[48:51], v[64:79]
    ds_read_b128 v[112:115], v245 offset:49568
    ds_read_b128 v[48:51], v244 offset:416
    s_add_u32 m0, s4, 98304
    s_nop 0
    buffer_load_dwordx4 v255, s[56:59], s48 offen offset:0 lds
    s_waitcnt lgkmcnt(6)
    v_mfma_f32_32x32x16_bf16 v[64:79], v[60:63], v[44:47], v[64:79]
    ds_read_b128 v[60:63], v245 offset:49600
    ds_read_b128 v[44:47], v244 offset:448
    s_waitcnt lgkmcnt(6)
    v_mfma_f32_32x32x16_bf16 v[64:79], v[56:59], v[40:43], v[64:79]
    ds_read_b128 v[56:59], v245 offset:49632
    ds_read_b128 v[40:43], v244 offset:480
    buffer_load_dwordx4 v254, s[56:59], s48 offen offset:1024 lds
    s_waitcnt lgkmcnt(6)
    v_mfma_f32_32x32x16_bf16 v[64:79], v[116:119], v[52:55], v[64:79]
    s_waitcnt lgkmcnt(4)
    v_mfma_f32_32x32x16_bf16 v[64:79], v[112:115], v[48:51], v[64:79]
    buffer_load_dwordx4 v253, s[56:59], s48 offen offset:2048 lds
    s_waitcnt lgkmcnt(2)
    v_mfma_f32_32x32x16_bf16 v[64:79], v[60:63], v[44:47], v[64:79]
    s_waitcnt lgkmcnt(0)
    v_mfma_f32_32x32x16_bf16 v[64:79], v[56:59], v[40:43], v[64:79]
    buffer_load_dwordx4 v252, s[56:59], s48 offen offset:3072 lds
    buffer_load_dword v246, v247, s[52:55], s10 offen sc1
    s_nop 0
    s_nop 9
    v_cvt_pk_bf16_f32 v116, v71, v70
    v_cvt_pk_bf16_f32 v117, v69, v68
    v_cvt_pk_bf16_f32 v118, v67, v66
    v_cvt_pk_bf16_f32 v119, v65, v64
    v_cvt_pk_bf16_f32 v112, v72, v73
    v_cvt_pk_bf16_f32 v113, v76, v77
    v_cvt_pk_bf16_f32 v114, v71, v71
    ds_write_b128 v243, v[116:119]
    ds_write_b16 v242, v112 offset:128
    ds_write_b16_d16_hi v242, v112
    ds_write_b16 v241, v113 offset:32
    ds_write_b16_d16_hi v241, v113
    s_mov_b32 exec_lo, 0
    s_mov_b32 exec_hi, 0x80000000
    ds_write_b16 v240, v114 offset:3066
    ds_write_b32 v240, v114 offset:3068
    ds_write_b16_d16_hi v240, v112 offset:2040
    ds_write_b16_d16_hi v240, v112 offset:2038
    s_mov_b64 exec, -1
    s_waitcnt lgkmcnt(0)
    s_barrier
    ds_read_b128 v[240:243], v234 offset:0
    ds_read_b64 v[244:245], v234 offset:16
    ds_read_b128 v[228:231], v234 offset:16896
    ds_read_b64 v[232:233], v234 offset:16912
    ds_write_b128 v235, v[236:239] offset:4096
    s_waitcnt vmcnt(0)
    v_cmp_ne_u32_e64 vcc, s68, v246
    s_cbranch_vccnz interleave_layers__ssm_conv_s4d__mixer_token_mlp__prompt_kernel_frt3
interleave_layers__ssm_conv_s4d__mixer_token_mlp__prompt_kernel_fok4:
    buffer_load_dwordx4 v[80:83], v88, s[52:55], s8 offen sc1
    buffer_load_dwordx4 v[84:87], v88, s[52:55], s9 offen sc1
    s_add_u32 s49, s47, 7077888
    buffer_store_dwordx4 v[136:139], v1, s[52:55], s49 offen sc1
    s_add_u32 s49, s47, 7081984
    ds_read_b64_tr_b16 a[16:17], v6 offset:49152
    ds_read_b64_tr_b16 a[18:19], v6 offset:51200
    ds_read_b64_tr_b16 a[20:21], v7 offset:49152
    s_nop 0
    s_waitcnt lgkmcnt(6)
    ds_write_b128 v1, v[240:243] offset:0
    v_alignbit_b32 v116, v241, v240, 16
    v_alignbit_b32 v117, v242, v241, 16
    v_alignbit_b32 v118, v243, v242, 16
    v_alignbit_b32 v119, v244, v243, 16
    ds_write_b128 v1, v[116:119] offset:4160
    buffer_store_dwordx4 v[136:139], v1, s[52:55], s49 offen sc1
    s_add_u32 s49, s46, 9437184
    ds_read_b64_tr_b16 a[22:23], v7 offset:51200
    v_mov_b32 v112, v241
    v_mov_b32 v113, v242
    v_mov_b32 v114, v243
    v_mov_b32 v115, v244
    ds_write_b128 v1, v[112:115] offset:8320
    buffer_store_dwordx4 v[136:139], v1, s[52:55], s49 offen sc1
    s_add_u32 s49, s46, 9441280
    ds_read_b64_tr_b16 a[24:25], v6 offset:49664
    v_alignbit_b32 v76, v242, v241, 16
    v_alignbit_b32 v77, v243, v242, 16
    v_alignbit_b32 v78, v244, v243, 16
    v_alignbit_b32 v79, v245, v244, 16
    ds_write_b128 v1, v[76:79] offset:12480
    buffer_store_dwordx4 v[136:139], v1, s[52:55], s49 offen sc1
    s_add_u32 s49, s46, 11796480
    ds_read_b64_tr_b16 a[26:27], v6 offset:51712
    s_nop 0
    s_waitcnt lgkmcnt(11)
    ds_write_b128 v1, v[228:231] offset:16640
    v_alignbit_b32 v116, v229, v228, 16
    v_alignbit_b32 v117, v230, v229, 16
    v_alignbit_b32 v118, v231, v230, 16
    v_alignbit_b32 v119, v232, v231, 16
    ds_write_b128 v1, v[116:119] offset:20800
    buffer_store_dwordx4 v[136:139], v1, s[52:55], s49 offen sc1
    s_add_u32 s49, s46, 11800576
    ds_read_b64_tr_b16 a[28:29], v7 offset:49664
    v_mov_b32 v112, v229
    v_mov_b32 v113, v230
    v_mov_b32 v114, v231
    v_mov_b32 v115, v232
    ds_write_b128 v1, v[112:115] offset:24960
    buffer_store_dwordx4 v[136:139], v1, s[52:55], s49 offen sc1
    s_bfe_u32 s48, s64, 0x40014
    s_mul_i32 s48, s48, 114688
    v_alignbit_b32 v76, v230, v229, 16
    v_alignbit_b32 v77, v231, v230, 16
    v_alignbit_b32 v78, v232, v231, 16
    v_alignbit_b32 v79, v233, v232, 16
    ds_write_b128 v1, v[76:79] offset:29120
    s_add_u32 s48, s48, s5
    s_add_u32 m0, s4, 32768
    s_nop 0
    buffer_load_dwordx4 v255, s[56:59], s48 offen offset:0 lds
    s_lshr_b32 s39, s3, 1
    s_andn2_b32 s40, 1, s3
    s_lshl_b32 s40, s40, 8
    v_and_b32 v91, 1, v0
    v_mul_u32_u24 v89, 4664, v91
    v_lshl_add_u32 v89, v0, 3, v89
    s_mul_i32 s41, s39, 16640
    s_add_u32 s41, s41, s40
    v_not_b32 v12, v0
    v_and_b32 v91, 12, v12
    v_and_b32 v12, 3, v12
    v_mul_u32_u24 v10, 4160, v12
    v_lshl_add_u32 v10, v91, 1, v10
    v_and_b32_e64 v91, 48, v0
    v_add3_u32 v10, v10, v91, s41
    s_mul_i32 s41, s39, 4672
    s_add_u32 s41, s41, s40
    v_and_b32 v12, 15, v0
    v_lshl_add_u32 v11, v12, 5, v91
    v_add_u32 v11, s41, v11
    v_lshrrev_b32 v13, 1, v91
    v_sub_u32 v13, v10, v13
    s_and_b32 s41, s3, 1
    s_mul_i32 s41, s41, 240
    v_add_u32_e64 v14, s41, v11
    s_mul_i32 s7, s39, 18448
    s_and_b32 s41, s3, 1
    s_mul_i32 s41, s41, 9216
    s_add_u32 s7, s7, s41
    s_mul_i32 s41, s3, 1152
    v_bfe_u32 v91, v0, 2, 2
    v_lshl_add_u32 v12, v91, 8, s41
    v_bfe_u32 v91, v0, 3, 1
    v_lshl_add_u32 v12, v91, 7, v12
    v_bfe_u32 v91, v0, 4, 2
    v_lshl_add_u32 v12, v91, 6, v12
    v_bfe_u32 v91, v0, 1, 1
    v_lshl_add_u32 v12, v91, 5, v12
    v_and_b32_e64 v91, 1, v0
    v_mul_u32_u24 v91, 18448, v91
    v_add_u32_e64 v12, v12, v91
    s_add_u32 s10, s46, 2359296
    s_add_u32 s11, s10, 4096
    buffer_load_dwordx4 v254, s[56:59], s48 offen offset:1024 lds
    ds_read_b64_tr_b16 a[30:31], v7 offset:51712
    ds_read_b64_tr_b16 a[32:33], v8 offset:0
    ds_read_b64_tr_b16 a[34:35], v8 offset:2048
    ds_read_b64_tr_b16 a[36:37], v9 offset:0
    ds_read_b64_tr_b16 a[38:39], v9 offset:2048
    buffer_load_dwordx4 v253, s[56:59], s48 offen offset:2048 lds
    buffer_load_dwordx4 v252, s[56:59], s48 offen offset:3072 lds
    ds_read_b64_tr_b16 a[40:41], v8 offset:512
    ds_read_b64_tr_b16 a[42:43], v8 offset:2560
    ds_read_b64_tr_b16 a[44:45], v9 offset:512
    ds_read_b64_tr_b16 a[46:47], v9 offset:2560
    ds_read_b64_tr_b16 a[48:49], v8 offset:16384
    ds_read_b64_tr_b16 a[50:51], v8 offset:18432
    ds_read_b64_tr_b16 a[52:53], v9 offset:16384
    ds_read_b64_tr_b16 a[54:55], v9 offset:18432
    ds_read_b64_tr_b16 a[56:57], v8 offset:16896
    ds_read_b64_tr_b16 a[58:59], v8 offset:18944
    ds_read_b64_tr_b16 a[60:61], v9 offset:16896
    ds_read_b64_tr_b16 a[62:63], v9 offset:18944
    ds_read_b64_tr_b16 a[64:65], v8 offset:32768
    ds_read_b64_tr_b16 a[66:67], v8 offset:34816
    ds_read_b64_tr_b16 a[68:69], v9 offset:32768
    ds_read_b64_tr_b16 a[70:71], v9 offset:34816
    ds_read_b64_tr_b16 a[72:73], v8 offset:33280
    ds_read_b64_tr_b16 a[74:75], v8 offset:35328
    ds_read_b64_tr_b16 a[76:77], v9 offset:33280
    ds_read_b64_tr_b16 a[78:79], v9 offset:35328
    s_waitcnt lgkmcnt(0)
    s_barrier
    ds_read_b64 v[64:65], v10 offset:984
    ds_read_b64 v[66:67], v10 offset:992
    ds_read_b64 v[60:61], v10 offset:912
    ds_read_b64 v[62:63], v10 offset:920
    ds_read_b64 v[56:57], v10 offset:832
    ds_read_b64 v[58:59], v10 offset:840
    ds_read_b64 v[52:53], v10 offset:1728
    ds_read_b64 v[54:55], v10 offset:1736
    ds_read_b64 v[48:49], v10 offset:2752
    ds_read_b64 v[50:51], v10 offset:2760
    ds_read_b64 v[44:45], v10 offset:3264
    ds_read_b64 v[46:47], v10 offset:3272
    ds_read_b64 v[40:41], v10 offset:3776
    ds_read_b64 v[42:43], v10 offset:3784
    ds_read_b64 v[36:37], v13 offset:2400
    ds_read_b64 v[38:39], v13 offset:2272
    ds_read_b64 v[32:33], v13 offset:2368
    ds_read_b64 v[34:35], v13 offset:2240
    ds_read_b64 v[28:29], v13 offset:2336
    ds_read_b64 v[30:31], v13 offset:2208
    s_waitcnt vmcnt(11)
    ds_write_b128 v89, v[80:83] offset:37504
    s_waitcnt vmcnt(10)
    ds_write_b128 v89, v[84:87] offset:39552
    s_waitcnt lgkmcnt(0)
    s_barrier
    ds_read_b128 v[24:27], v14 offset:37216
    ds_read_b128 v[20:23], v11 offset:37216
    ds_read_b128 v[16:19], v14 offset:37728
    ds_read_b128 v[140:143], v11 offset:37728
    s_waitcnt lgkmcnt(3)
    v_mfma_f32_16x16x32_bf16 v[116:119], v[24:27], v[64:67], 0
    s_bfe_u32 s48, s66, 0x40000
    v_mfma_f32_16x16x32_bf16 v[112:115], v[24:27], v[60:63], 0
    s_lshl_b32 s48, s48, 17
    v_mfma_f32_16x16x32_bf16 v[76:79], v[24:27], v[56:59], 0
    ds_read_b128 v[24:27], v14 offset:38240
    s_waitcnt lgkmcnt(3)
    v_mfma_f32_16x16x32_bf16 v[96:99], v[20:23], v[52:55], 0
    v_cvt_pk_bf16_f32 v116, v116, v117
    v_cvt_pk_bf16_f32 v117, v118, v119
    v_mfma_f32_16x16x32_bf16 v[88:91], v[20:23], v[48:51], 0
    v_cvt_pk_bf16_f32 v118, v112, v113
    v_cvt_pk_bf16_f32 v119, v114, v115
    v_mfma_f32_16x16x32_bf16 v[84:87], v[20:23], v[44:47], 0
    v_cvt_pk_bf16_f32 v76, v76, v77
    v_cvt_pk_bf16_f32 v77, v78, v79
    v_mfma_f32_16x16x32_bf16 v[80:83], v[20:23], v[40:43], 0
    ds_read_b128 v[20:23], v11 offset:38240
    v_mfma_f32_16x16x32_bf16 v[88:91], v[36:39], v[116:119], v[88:91]
    s_add_u32 s48, s48, s6
    v_mfma_f32_16x16x32_bf16 v[92:95], v[32:35], v[116:119], 0
    s_add_u32 m0, s4, 0
    v_mfma_f32_16x16x32_bf16 v[96:99], v[28:31], v[116:119], v[96:99]
    buffer_load_dwordx4 v2, s[60:63], s48 offen offset:0 lds
    s_waitcnt lgkmcnt(3)
    v_mfma_f32_16x16x32_bf16 v[72:75], v[16:19], v[64:67], 0
    v_mfma_f32_16x16x32_bf16 v[68:71], v[16:19], v[60:63], 0
    v_mfma_f32_16x16x32_bf16 v[112:115], v[16:19], v[56:59], 0
    ds_read_b128 v[16:19], v14 offset:38752
    s_waitcnt lgkmcnt(3)
    v_mfma_f32_16x16x32_bf16 v[100:103], v[140:143], v[52:55], 0
    v_cvt_pk_bf16_f32 v72, v72, v73
    v_cvt_pk_bf16_f32 v73, v74, v75
    v_mfma_f32_16x16x32_bf16 v[92:95], v[140:143], v[48:51], v[92:95]
    v_cvt_pk_bf16_f32 v74, v68, v69
    v_cvt_pk_bf16_f32 v75, v70, v71
    v_mfma_f32_16x16x32_bf16 v[88:91], v[140:143], v[44:47], v[88:91]
    v_cvt_pk_bf16_f32 v78, v112, v113
    v_cvt_pk_bf16_f32 v79, v114, v115
    v_mfma_f32_16x16x32_bf16 v[84:87], v[140:143], v[40:43], v[84:87]
    ds_read_b128 v[140:143], v11 offset:38752
    v_mfma_f32_16x16x32_bf16 v[92:95], v[36:39], v[72:75], v[92:95]
    buffer_load_dwordx4 v3, s[60:63], s48 offen offset:1024 lds
    v_mfma_f32_16x16x32_bf16 v[96:99], v[32:35], v[72:75], v[96:99]
    v_mfma_f32_16x16x32_bf16 v[100:103], v[28:31], v[72:75], v[100:103]
    s_waitcnt lgkmcnt(3)
    v_mfma_f32_16x16x32_bf16 v[116:119], v[24:27], v[64:67], 0
    v_mfma_f32_16x16x32_bf16 v[68:71], v[24:27], v[60:63], 0
    buffer_load_dwordx4 v4, s[60:63], s48 offen offset:2048 lds
    v_mfma_f32_16x16x32_bf16 v[112:115], v[24:27], v[56:59], 0
    ds_read_b128 v[24:27], v14 offset:39264
    s_waitcnt lgkmcnt(3)
    v_mfma_f32_16x16x32_bf16 v[104:107], v[20:23], v[52:55], 0
    v_cvt_pk_bf16_f32 v116, v116, v117
    v_cvt_pk_bf16_f32 v117, v118, v119
    v_mfma_f32_16x16x32_bf16 v[96:99], v[20:23], v[48:51], v[96:99]
    v_cvt_pk_bf16_f32 v118, v68, v69
    v_cvt_pk_bf16_f32 v119, v70, v71
    v_mfma_f32_16x16x32_bf16 v[92:95], v[20:23], v[44:47], v[92:95]
    v_cvt_pk_bf16_f32 v112, v112, v113
    v_cvt_pk_bf16_f32 v113, v114, v115
    v_mfma_f32_16x16x32_bf16 v[88:91], v[20:23], v[40:43], v[88:91]
    ds_read_b128 v[20:23], v11 offset:39264
    v_mfma_f32_16x16x32_bf16 v[96:99], v[36:39], v[116:119], v[96:99]
    buffer_load_dwordx4 v5, s[60:63], s48 offen offset:3072 lds
    v_mfma_f32_16x16x32_bf16 v[100:103], v[32:35], v[116:119], v[100:103]
    s_bfe_u32 s48, s66, 0x40004
    v_mfma_f32_16x16x32_bf16 v[104:107], v[28:31], v[116:119], v[104:107]
    s_lshl_b32 s48, s48, 17
    s_waitcnt lgkmcnt(3)
    v_mfma_f32_16x16x32_bf16 v[72:75], v[16:19], v[64:67], 0
    s_add_u32 s48, s48, s6
    v_mfma_f32_16x16x32_bf16 v[68:71], v[16:19], v[60:63], 0
    s_add_u32 m0, s4, 16384
    v_mfma_f32_16x16x32_bf16 v[116:119], v[16:19], v[56:59], 0
    ds_read_b64 v[16:17], v13 offset:1440
    ds_read_b64 v[18:19], v13 offset:1472
    s_waitcnt lgkmcnt(4)
    v_mfma_f32_16x16x32_bf16 v[108:111], v[140:143], v[52:55], 0
    v_cvt_pk_bf16_f32 v72, v72, v73
    v_cvt_pk_bf16_f32 v73, v74, v75
    v_mfma_f32_16x16x32_bf16 v[100:103], v[140:143], v[48:51], v[100:103]
    v_cvt_pk_bf16_f32 v74, v68, v69
    v_cvt_pk_bf16_f32 v75, v70, v71
    v_mfma_f32_16x16x32_bf16 v[96:99], v[140:143], v[44:47], v[96:99]
    v_cvt_pk_bf16_f32 v114, v116, v117
    v_cvt_pk_bf16_f32 v115, v118, v119
    v_mfma_f32_16x16x32_bf16 v[92:95], v[140:143], v[40:43], v[92:95]
    ds_read_b128 v[56:59], v14 offset:39776
    v_mfma_f32_16x16x32_bf16 v[100:103], v[36:39], v[72:75], v[100:103]
    ds_read_b128 v[52:55], v11 offset:39776
    v_mfma_f32_16x16x32_bf16 v[104:107], v[32:35], v[72:75], v[104:107]
    ds_read_b128 v[140:143], v11 offset:40288
    v_mfma_f32_16x16x32_bf16 v[108:111], v[28:31], v[72:75], v[108:111]
    ds_read_b64 v[28:29], v13 offset:1408
    ds_read_b64 v[30:31], v13 offset:1440
    s_waitcnt lgkmcnt(8)
    v_mfma_f32_16x16x32_bf16 v[68:71], v[24:27], v[64:67], 0
    ds_read_b128 v[72:75], v11 offset:40800
    v_mfma_f32_16x16x32_bf16 v[116:119], v[24:27], v[60:63], 0
    ds_read_b64 v[24:25], v13 offset:1376
    ds_read_b64 v[26:27], v13 offset:1408
    s_waitcnt lgkmcnt(10)
    v_mfma_f32_16x16x32_bf16 v[104:107], v[20:23], v[48:51], v[104:107]
    buffer_load_dwordx4 v2, s[60:63], s48 offen offset:0 lds
    v_mfma_f32_16x16x32_bf16 v[100:103], v[20:23], v[44:47], v[100:103]
    v_cvt_pk_bf16_f32 v68, v68, v69
    v_cvt_pk_bf16_f32 v69, v70, v71
    v_mfma_f32_16x16x32_bf16 v[96:99], v[20:23], v[40:43], v[96:99]
    v_cvt_pk_bf16_f32 v70, v116, v117
    v_cvt_pk_bf16_f32 v71, v118, v119
    s_waitcnt lgkmcnt(8)
    v_mfma_f32_16x16x32_bf16 v[96:99], v[16:19], v[76:79], v[96:99]
    ds_read_b64 v[20:21], v13 offset:1344
    ds_read_b64 v[22:23], v13 offset:1376
    v_mfma_f32_16x16x32_bf16 v[104:107], v[36:39], v[68:71], v[104:107]
    buffer_load_dwordx4 v3, s[60:63], s48 offen offset:1024 lds
    v_mfma_f32_16x16x32_bf16 v[108:111], v[32:35], v[68:71], v[108:111]
    ds_read_b128 v[32:35], v11 offset:37152
    s_waitcnt lgkmcnt(10)
    v_mfma_f32_16x16x32_bf16 v[116:119], v[56:59], v[64:67], 0
    ds_read_b64 v[64:65], v10 offset:3200
    ds_read_b64 v[66:67], v10 offset:3208
    v_mfma_f32_16x16x32_bf16 v[68:71], v[56:59], v[60:63], 0
    ds_read_b64 v[56:57], v10 offset:3712
    ds_read_b64 v[58:59], v10 offset:3720
    s_waitcnt lgkmcnt(13)
    v_mfma_f32_16x16x32_bf16 v[108:111], v[52:55], v[48:51], v[108:111]
    ds_read_b128 v[60:63], v11 offset:37088
    v_mfma_f32_16x16x32_bf16 v[104:107], v[52:55], v[44:47], v[104:107]
    v_cvt_pk_bf16_f32 v116, v116, v117
    v_cvt_pk_bf16_f32 v117, v118, v119
    v_mfma_f32_16x16x32_bf16 v[100:103], v[52:55], v[40:43], v[100:103]
    v_cvt_pk_bf16_f32 v118, v68, v69
    v_cvt_pk_bf16_f32 v119, v70, v71
    v_mfma_f32_16x16x32_bf16 v[104:107], v[16:19], v[112:115], v[104:107]
    ds_read_b64 v[48:49], v10 offset:3136
    ds_read_b64 v[50:51], v10 offset:3144
    v_mfma_f32_16x16x32_bf16 v[108:111], v[36:39], v[116:119], v[108:111]
    ds_read_b64 v[52:53], v10 offset:3648
    ds_read_b64 v[54:55], v10 offset:3656
    s_waitcnt lgkmcnt(15)
    v_mfma_f32_16x16x32_bf16 v[108:111], v[140:143], v[44:47], v[108:111]
    ds_read_b128 v[68:71], v11 offset:37024
    v_mfma_f32_16x16x32_bf16 v[104:107], v[140:143], v[40:43], v[104:107]
    ds_read_b64 v[16:17], v10 offset:3072
    ds_read_b64 v[18:19], v10 offset:3080
    v_mfma_f32_16x16x32_bf16 v[100:103], v[28:31], v[76:79], v[100:103]
    ds_read_b64 v[36:37], v10 offset:3584
    ds_read_b64 v[38:39], v10 offset:3592
    v_mfma_f32_16x16x32_bf16 v[108:111], v[28:31], v[112:115], v[108:111]
    ds_read_b128 v[116:119], v11 offset:37664
    s_waitcnt lgkmcnt(15)
    v_mfma_f32_16x16x32_bf16 v[108:111], v[72:75], v[40:43], v[108:111]
    ds_read_b128 v[44:47], v11 offset:37600
    v_mfma_f32_16x16x32_bf16 v[104:107], v[24:27], v[76:79], v[104:107]
    ds_read_b128 v[140:143], v11 offset:37536
    v_mfma_f32_16x16x32_bf16 v[108:111], v[20:23], v[76:79], v[108:111]
    ds_read_b128 v[28:31], v11 offset:38176
    s_waitcnt lgkmcnt(15)
    v_mfma_f32_16x16x32_bf16 v[84:87], v[32:35], v[64:67], v[84:87]
    ds_read_b128 v[112:115], v11 offset:38112
    s_waitcnt lgkmcnt(15)
    v_mfma_f32_16x16x32_bf16 v[80:83], v[32:35], v[56:59], v[80:83]
    ds_read_b128 v[72:75], v11 offset:38048
    s_waitcnt lgkmcnt(13)
    v_mfma_f32_16x16x32_bf16 v[84:87], v[60:63], v[48:51], v[84:87]
    ds_read_b128 v[40:43], v11 offset:38688
    s_waitcnt lgkmcnt(12)
    v_mfma_f32_16x16x32_bf16 v[80:83], v[60:63], v[52:55], v[80:83]
    ds_read_b128 v[24:27], v11 offset:38624
    s_waitcnt lgkmcnt(10)
    v_mfma_f32_16x16x32_bf16 v[84:87], v[68:71], v[16:19], v[84:87]
    ds_read_b128 v[20:23], v11 offset:38560
    s_waitcnt lgkmcnt(9)
    v_mfma_f32_16x16x32_bf16 v[80:83], v[68:71], v[36:39], v[80:83]
    ds_read_b128 v[76:79], v11 offset:39200
    s_waitcnt lgkmcnt(9)
    v_mfma_f32_16x16x32_bf16 v[88:91], v[116:119], v[64:67], v[88:91]
    ds_read_b128 v[32:35], v11 offset:39136
    buffer_load_dwordx4 v4, s[60:63], s48 offen offset:2048 lds
    buffer_load_dwordx4 v5, s[60:63], s48 offen offset:3072 lds
    s_mov_b32 m0, s7
    s_barrier
    v_mfma_f32_16x16x32_bf16 v[84:87], v[116:119], v[56:59], v[84:87]
    ds_read_b128 v[60:63], v11 offset:39072
    s_waitcnt lgkmcnt(10)
    v_mfma_f32_16x16x32_bf16 v[88:91], v[44:47], v[48:51], v[88:91]
    ds_read_b128 v[68:71], v11 offset:39712
    ds_write_addtid_b32 v80 offset:0
    v_mfma_f32_16x16x32_bf16 v[84:87], v[44:47], v[52:55], v[84:87]
    ds_read_b128 v[116:119], v11 offset:39648
    ds_write_addtid_b32 v81 offset:256
    s_waitcnt lgkmcnt(13)
    v_mfma_f32_16x16x32_bf16 v[88:91], v[140:143], v[16:19], v[88:91]
    ds_read_b128 v[44:47], v11 offset:39584
    ds_write_addtid_b32 v82 offset:640
    v_mfma_f32_16x16x32_bf16 v[84:87], v[140:143], v[36:39], v[84:87]
    ds_read_b128 v[140:143], v11 offset:40224
    ds_write_addtid_b32 v83 offset:896
    s_waitcnt lgkmcnt(15)
    v_mfma_f32_16x16x32_bf16 v[92:95], v[28:31], v[64:67], v[92:95]
    v_mfma_f32_16x16x32_bf16 v[88:91], v[28:31], v[56:59], v[88:91]
    ds_read_b128 v[28:31], v11 offset:40160
    v_mfma_f32_16x16x32_bf16 v[92:95], v[112:115], v[48:51], v[92:95]
    ds_write_addtid_b32 v84 offset:1152
    v_mfma_f32_16x16x32_bf16 v[88:91], v[112:115], v[52:55], v[88:91]
    ds_read_b128 v[112:115], v11 offset:40096
    ds_write_addtid_b32 v85 offset:1408
    s_waitcnt lgkmcnt(15)
    v_mfma_f32_16x16x32_bf16 v[92:95], v[72:75], v[16:19], v[92:95]
    ds_write_addtid_b32 v86 offset:1792
    v_mfma_f32_16x16x32_bf16 v[88:91], v[72:75], v[36:39], v[88:91]
    ds_read_b128 v[72:75], v11 offset:40736
    ds_write_addtid_b32 v87 offset:2048
    v_mfma_f32_16x16x32_bf16 v[96:99], v[40:43], v[64:67], v[96:99]
    v_mfma_f32_16x16x32_bf16 v[92:95], v[40:43], v[56:59], v[92:95]
    ds_read_b128 v[40:43], v11 offset:40672
    v_mfma_f32_16x16x32_bf16 v[96:99], v[24:27], v[48:51], v[96:99]
    s_waitcnt vmcnt(8)
    ds_read_b64_tr_b16 a[80:81], v6 offset:32768
    ds_write_addtid_b32 v88 offset:2304
    v_mfma_f32_16x16x32_bf16 v[92:95], v[24:27], v[52:55], v[92:95]
    ds_read_b128 v[24:27], v11 offset:40608
    ds_write_addtid_b32 v89 offset:2560
    v_mfma_f32_16x16x32_bf16 v[96:99], v[20:23], v[16:19], v[96:99]
    ds_read_b64_tr_b16 a[82:83], v6 offset:34816
    ds_write_addtid_b32 v90 offset:2944
    v_mfma_f32_16x16x32_bf16 v[92:95], v[20:23], v[36:39], v[92:95]
    ds_read_b64_tr_b16 a[84:85], v7 offset:32768
    ds_write_addtid_b32 v91 offset:3200
    s_waitcnt lgkmcnt(15)
    v_mfma_f32_16x16x32_bf16 v[100:103], v[76:79], v[64:67], v[100:103]
    ds_read_b64_tr_b16 a[86:87], v7 offset:34816
    v_mfma_f32_16x16x32_bf16 v[96:99], v[76:79], v[56:59], v[96:99]
    ds_read_b64_tr_b16 a[88:89], v6 offset:33280
    v_mfma_f32_16x16x32_bf16 v[100:103], v[32:35], v[48:51], v[100:103]
    ds_read_b64_tr_b16 a[90:91], v6 offset:35328
    ds_write_addtid_b32 v92 offset:3456
    v_mfma_f32_16x16x32_bf16 v[96:99], v[32:35], v[52:55], v[96:99]
    ds_read_b64_tr_b16 a[92:93], v7 offset:33280
    ds_write_addtid_b32 v93 offset:3712
    v_mfma_f32_16x16x32_bf16 v[100:103], v[60:63], v[16:19], v[100:103]
    ds_read_b64_tr_b16 a[94:95], v7 offset:35328
    ds_write_addtid_b32 v94 offset:4096
    v_mfma_f32_16x16x32_bf16 v[96:99], v[60:63], v[36:39], v[96:99]
    ds_write_addtid_b32 v95 offset:4352
    v_mfma_f32_16x16x32_bf16 v[104:107], v[68:71], v[64:67], v[104:107]
    v_mfma_f32_16x16x32_bf16 v[100:103], v[68:71], v[56:59], v[100:103]
    v_mfma_f32_16x16x32_bf16 v[104:107], v[116:119], v[48:51], v[104:107]
    ds_write_addtid_b32 v96 offset:4608
    v_mfma_f32_16x16x32_bf16 v[100:103], v[116:119], v[52:55], v[100:103]
    ds_write_addtid_b32 v97 offset:4864
    v_mfma_f32_16x16x32_bf16 v[104:107], v[44:47], v[16:19], v[104:107]
    ds_write_addtid_b32 v98 offset:5248
    v_mfma_f32_16x16x32_bf16 v[100:103], v[44:47], v[36:39], v[100:103]
    ds_write_addtid_b32 v99 offset:5504
    v_mfma_f32_16x16x32_bf16 v[104:107], v[140:143], v[56:59], v[104:107]
    v_mfma_f32_16x16x32_bf16 v[104:107], v[28:31], v[52:55], v[104:107]
    s_waitcnt lgkmcnt(15)
    v_mfma_f32_16x16x32_bf16 v[104:107], v[112:115], v[36:39], v[104:107]
    ds_write_addtid_b32 v100 offset:5760
    v_mfma_f32_16x16x32_bf16 v[108:111], v[140:143], v[64:67], v[108:111]
    ds_write_addtid_b32 v101 offset:6016
    v_mfma_f32_16x16x32_bf16 v[108:111], v[28:31], v[48:51], v[108:111]
    ds_write_addtid_b32 v102 offset:6400
    v_mfma_f32_16x16x32_bf16 v[108:111], v[112:115], v[16:19], v[108:111]
    ds_write_addtid_b32 v103 offset:6656
    v_mfma_f32_16x16x32_bf16 v[108:111], v[72:75], v[56:59], v[108:111]
    ds_write_addtid_b32 v104 offset:6912
    ds_write_addtid_b32 v105 offset:7168
    v_mfma_f32_16x16x32_bf16 v[108:111], v[40:43], v[52:55], v[108:111]
    ds_write_addtid_b32 v106 offset:7552
    ds_write_addtid_b32 v107 offset:7808
    v_mfma_f32_16x16x32_bf16 v[108:111], v[24:27], v[36:39], v[108:111]
    s_nop 7
    ds_write_addtid_b32 v108 offset:8064
    ds_write_addtid_b32 v109 offset:8320
    ds_write_addtid_b32 v110 offset:8704
    ds_write_addtid_b32 v111 offset:8960
    s_nop 0
    s_waitcnt lgkmcnt(0)
    s_barrier
    ds_read_b128 v[48:51], v12 offset:0
    ds_read_b128 v[56:59], v12 offset:9216
    ds_read_b128 v[52:55], v12 offset:16
    ds_read_b128 v[60:63], v12 offset:9232
    ds_read_b128 v[64:67], v12 offset:4608
    ds_read_b128 v[72:75], v12 offset:13824
    ds_read_b128 v[68:71], v12 offset:4624
    ds_read_b128 v[76:79], v12 offset:13840
    s_waitcnt lgkmcnt(6)
    v_pk_add_f32 v[48:49], v[48:49], v[56:57]
    v_pk_add_f32 v[50:51], v[50:51], v[58:59]
    v_cvt_pk_bf16_f32 v80, v48, v49
    v_cvt_pk_bf16_f32 v81, v50, v51
    s_waitcnt lgkmcnt(4)
    v_pk_add_f32 v[52:53], v[52:53], v[60:61]
    v_pk_add_f32 v[54:55], v[54:55], v[62:63]
    v_cvt_pk_bf16_f32 v82, v52, v53
    v_cvt_pk_bf16_f32 v83, v54, v55
    buffer_store_dwordx4 v[80:83], v1, s[52:55], s10 offen sc1
    s_waitcnt lgkmcnt(2)
    v_pk_add_f32 v[64:65], v[64:65], v[72:73]
    v_pk_add_f32 v[66:67], v[66:67], v[74:75]
    v_cvt_pk_bf16_f32 v84, v64, v65
    v_cvt_pk_bf16_f32 v85, v66, v67
    s_waitcnt lgkmcnt(0)
    v_pk_add_f32 v[68:69], v[68:69], v[76:77]
    v_pk_add_f32 v[70:71], v[70:71], v[78:79]
    v_cvt_pk_bf16_f32 v86, v68, v69
    v_cvt_pk_bf16_f32 v87, v70, v71
    buffer_store_dwordx4 v[84:87], v1, s[52:55], s11 offen sc1
    s_nop 0
    ds_write_b128 v1, v[240:243] offset:36992
    ds_write_b64 v1, v[244:245] offset:37008
    ds_write_b128 v1, v[228:231] offset:41664
    ds_write_b64 v1, v[232:233] offset:41680
    s_waitcnt vmcnt(6)
    ds_read_b64_tr_b16 v[144:145], v6 offset:0
    ds_read_b64_tr_b16 v[146:147], v6 offset:2048
    ds_read_b64_tr_b16 v[148:149], v7 offset:0
    ds_read_b64_tr_b16 v[150:151], v7 offset:2048
    ds_read_b64_tr_b16 v[152:153], v6 offset:512
    ds_read_b64_tr_b16 v[154:155], v6 offset:2560
    v_lshrrev_b32_e64 v10, 1, v0
    v_mul_u32_u24 v106, 8320, v10
    v_and_b32_e64 v10, 1, v0
    v_lshl_add_u32 v106, v10, 4, v106
    s_lshl_b32 s10, s34, 5
    s_add_u32 s10, s10, 2359296
    s_add_u32 s11, s10, 1064960
    ds_read_b64_tr_b16 v[156:157], v7 offset:512
    ds_read_b64_tr_b16 v[158:159], v7 offset:2560
    v_and_b32 v108, 60, v0
    v_add_lshl_u32 v108, v108, s3, 2
    v_and_b32 v109, 0x70, v1
    v_lshrrev_b32_e64 v104, 5, v0
    v_and_b32 v105, 0x1f0, v1
    v_lshl_add_u32 v105, v104, 18, v105
    s_lshl_b32 s8, s34, 9
    s_add_u32 s8, s8, 4718592
    s_add_u32 s9, s8, 131072
    s_bfe_u32 s48, s64, 0x40018
    s_mul_i32 s48, s48, 114688
    s_add_u32 s48, s48, s5
    s_add_u32 m0, s4, 49152
    s_nop 0
    buffer_load_dwordx4 v255, s[56:59], s48 offen offset:0 lds
    buffer_load_dwordx4 v254, s[56:59], s48 offen offset:1024 lds
    buffer_load_dwordx4 v253, s[56:59], s48 offen offset:2048 lds
    buffer_load_dwordx4 v252, s[56:59], s48 offen offset:3072 lds
    s_bfe_u32 s48, s64, 0x4001c
    s_mul_i32 s48, s48, 114688
    s_add_u32 s48, s48, s5
    s_add_u32 m0, s4, 65536
    s_nop 0
    buffer_load_dwordx4 v255, s[56:59], s48 offen offset:0 lds
    buffer_load_dwordx4 v254, s[56:59], s48 offen offset:1024 lds
    buffer_load_dwordx4 v253, s[56:59], s48 offen offset:2048 lds
    buffer_load_dwordx4 v252, s[56:59], s48 offen offset:3072 lds
    s_bfe_u32 s48, s65, 0x40000
    s_mul_i32 s48, s48, 114688
    s_add_u32 s48, s48, s5
    s_add_u32 m0, s4, 81920
    s_nop 0
    buffer_load_dwordx4 v255, s[56:59], s48 offen offset:0 lds
    buffer_load_dwordx4 v254, s[56:59], s48 offen offset:1024 lds
    buffer_load_dwordx4 v253, s[56:59], s48 offen offset:2048 lds
    buffer_load_dwordx4 v252, s[56:59], s48 offen offset:3072 lds
    s_bfe_u32 s48, s65, 0x40004
    s_mul_i32 s48, s48, 114688
    s_add_u32 s48, s48, s5
    s_add_u32 m0, s4, 98304
    s_nop 0
    buffer_load_dwordx4 v255, s[56:59], s48 offen offset:0 lds
    buffer_load_dwordx4 v254, s[56:59], s48 offen offset:1024 lds
    buffer_load_dwordx4 v253, s[56:59], s48 offen offset:2048 lds
    buffer_load_dwordx4 v252, s[56:59], s48 offen offset:3072 lds
    s_bfe_u32 s48, s65, 0x40008
    s_mul_i32 s48, s48, 114688
    s_add_u32 s48, s48, s5
    s_add_u32 m0, s4, 32768
    s_nop 0
    buffer_load_dwordx4 v255, s[56:59], s48 offen offset:0 lds
    buffer_load_dwordx4 v254, s[56:59], s48 offen offset:1024 lds
    buffer_load_dwordx4 v253, s[56:59], s48 offen offset:2048 lds
    buffer_load_dwordx4 v252, s[56:59], s48 offen offset:3072 lds
    s_bfe_u32 s48, s65, 0x4000c
    s_mul_i32 s48, s48, 114688
    s_add_u32 s48, s48, s5
    s_add_u32 m0, s4, 0
    s_waitcnt lgkmcnt(0)
    buffer_load_dwordx4 v255, s[56:59], s48 offen offset:0 lds
    buffer_load_dwordx4 v254, s[56:59], s48 offen offset:1024 lds
    buffer_load_dwordx4 v253, s[56:59], s48 offen offset:2048 lds
    buffer_load_dwordx4 v252, s[56:59], s48 offen offset:3072 lds
    s_nop 0
    s_waitcnt vmcnt(26)
    ds_read_b64_tr_b16 v[160:161], v6 offset:16384
    ds_read_b64_tr_b16 v[162:163], v6 offset:18432
    ds_read_b64_tr_b16 v[164:165], v7 offset:16384
    ds_read_b64_tr_b16 v[166:167], v7 offset:18432
    ds_read_b64_tr_b16 v[168:169], v6 offset:16896
    ds_read_b64_tr_b16 v[170:171], v6 offset:18944
    ds_read_b64_tr_b16 v[172:173], v7 offset:16896
    ds_read_b64_tr_b16 v[174:175], v7 offset:18944
    s_bfe_u32 s48, s65, 0x40010
    s_mul_i32 s48, s48, 114688
    s_add_u32 s48, s48, s5
    s_add_u32 m0, s4, 16384
    s_waitcnt lgkmcnt(0)
    buffer_load_dwordx4 v255, s[56:59], s48 offen offset:0 lds
    buffer_load_dwordx4 v254, s[56:59], s48 offen offset:1024 lds
    buffer_load_dwordx4 v253, s[56:59], s48 offen offset:2048 lds
    buffer_load_dwordx4 v252, s[56:59], s48 offen offset:3072 lds
    s_waitcnt vmcnt(28)
    s_barrier
    buffer_load_dwordx4 v[112:115], v106, s[52:55], s10 offen sc1
    buffer_load_dwordx4 v[116:119], v106, s[52:55], s11 offen sc1
    s_nop 0
    s_waitcnt vmcnt(26)
    ds_read_b64_tr_b16 a[96:97], v6 offset:49152
    ds_read_b64_tr_b16 a[98:99], v6 offset:51200
    ds_read_b64_tr_b16 a[100:101], v7 offset:49152
    ds_read_b64_tr_b16 a[102:103], v7 offset:51200
    ds_read_b64_tr_b16 a[104:105], v6 offset:49664
    ds_read_b64_tr_b16 a[106:107], v6 offset:51712
    ds_read_b64_tr_b16 a[108:109], v7 offset:49664
    ds_read_b64_tr_b16 a[110:111], v7 offset:51712
    s_bfe_u32 s48, s65, 0x40014
    s_mul_i32 s48, s48, 114688
    s_add_u32 s48, s48, s5
    s_add_u32 m0, s4, 49152
    s_waitcnt lgkmcnt(0)
    buffer_load_dwordx4 v255, s[56:59], s48 offen offset:0 lds
    buffer_load_dwordx4 v254, s[56:59], s48 offen offset:1024 lds
    buffer_load_dwordx4 v253, s[56:59], s48 offen offset:2048 lds
    buffer_load_dwordx4 v252, s[56:59], s48 offen offset:3072 lds
    s_nop 0
    s_waitcnt vmcnt(26)
    ds_read_b64_tr_b16 a[112:113], v8 offset:0
    ds_read_b64_tr_b16 a[114:115], v8 offset:2048
    ds_read_b64_tr_b16 a[116:117], v9 offset:0
    ds_read_b64_tr_b16 a[118:119], v9 offset:2048
    ds_read_b64_tr_b16 a[120:121], v8 offset:512
    ds_read_b64_tr_b16 a[122:123], v8 offset:2560
    ds_read_b64_tr_b16 a[124:125], v9 offset:512
    ds_read_b64_tr_b16 a[126:127], v9 offset:2560
    s_bfe_u32 s48, s65, 0x40018
    s_mul_i32 s48, s48, 114688
    s_add_u32 s48, s48, s5
    s_add_u32 m0, s4, 65536
    s_waitcnt lgkmcnt(0)
    buffer_load_dwordx4 v255, s[56:59], s48 offen offset:0 lds
    buffer_load_dwordx4 v254, s[56:59], s48 offen offset:1024 lds
    buffer_load_dwordx4 v253, s[56:59], s48 offen offset:2048 lds
    buffer_load_dwordx4 v252, s[56:59], s48 offen offset:3072 lds
    s_waitcnt vmcnt(9)
    v_max3_u32 v107, v112, v113, v114
    v_cmp_u_f32_e64 vcc, v107, v115
    s_cbranch_vccnz interleave_layers__ssm_conv_s4d__mixer_token_mlp__prompt_kernel_gretry11
interleave_layers__ssm_conv_s4d__mixer_token_mlp__prompt_kernel_gok12:
    v_dot2c_f32_bf16 v120, s18, v112
    v_dot2c_f32_bf16 v121, s19, v112
    v_dot2c_f32_bf16 v122, s18, v113
    v_dot2c_f32_bf16 v123, s19, v113
    v_dot2c_f32_bf16 v124, s18, v114
    v_dot2c_f32_bf16 v125, s19, v114
    v_dot2c_f32_bf16 v126, s18, v115
    v_dot2c_f32_bf16 v127, s19, v115
    v_pk_mul_f32 v[96:97], v[120:121], v[120:121]
    v_pk_mul_f32 v[98:99], v[122:123], v[122:123]
    v_pk_mul_f32 v[100:101], v[124:125], v[124:125]
    v_pk_mul_f32 v[102:103], v[126:127], v[126:127]
    s_waitcnt vmcnt(8)
    v_max3_u32 v107, v116, v117, v118
    v_cmp_u_f32_e64 vcc, v107, v119
    s_cbranch_vccnz interleave_layers__ssm_conv_s4d__mixer_token_mlp__prompt_kernel_gretry16
interleave_layers__ssm_conv_s4d__mixer_token_mlp__prompt_kernel_gok17:
    v_dot2c_f32_bf16 v128, s18, v116
    v_dot2c_f32_bf16 v129, s19, v116
    v_dot2c_f32_bf16 v130, s18, v117
    v_dot2c_f32_bf16 v131, s19, v117
    v_dot2c_f32_bf16 v132, s18, v118
    v_dot2c_f32_bf16 v133, s19, v118
    v_dot2c_f32_bf16 v134, s18, v119
    v_dot2c_f32_bf16 v135, s19, v119
    v_pk_add_f32 v[88:89], v[120:121], v[128:129]
    v_pk_add_f32 v[90:91], v[122:123], v[130:131]
    v_pk_add_f32 v[92:93], v[124:125], v[132:133]
    v_pk_add_f32 v[94:95], v[126:127], v[134:135]
    v_pk_fma_f32 v[96:97], v[128:129], v[128:129], v[96:97]
    v_pk_fma_f32 v[98:99], v[130:131], v[130:131], v[98:99]
    v_pk_fma_f32 v[100:101], v[132:133], v[132:133], v[100:101]
    v_pk_fma_f32 v[102:103], v[134:135], v[134:135], v[102:103]
    v_permlane32_swap_b32 v88, v96
    v_permlane32_swap_b32 v89, v97
    v_permlane32_swap_b32 v90, v98
    v_permlane32_swap_b32 v91, v99
    v_permlane32_swap_b32 v92, v100
    v_permlane32_swap_b32 v93, v101
    v_permlane32_swap_b32 v94, v102
    v_permlane32_swap_b32 v95, v103
    v_pk_add_f32 v[88:89], v[88:89], v[96:97]
    v_pk_add_f32 v[92:93], v[92:93], v[100:101]
    v_pk_add_f32 v[90:91], v[90:91], v[98:99]
    v_pk_add_f32 v[94:95], v[94:95], v[102:103]
    v_permlane16_swap_b32 v88, v92
    v_permlane16_swap_b32 v89, v93
    v_permlane16_swap_b32 v90, v94
    v_permlane16_swap_b32 v91, v95
    v_pk_add_f32 v[88:89], v[88:89], v[92:93]
    v_pk_add_f32 v[90:91], v[90:91], v[94:95]
    v_cvt_pk_bf16_f32 v136, v120, v121
    v_add_f32_dpp v96, v88, v88 row_ror:8 row_mask:0xf bank_mask:0x3
    v_add_f32_dpp v97, v89, v89 row_ror:8 row_mask:0xf bank_mask:0x3
    v_cvt_pk_bf16_f32 v137, v122, v123
    v_add_f32_dpp v96, v90, v90 row_ror:8 row_mask:0xf bank_mask:0xc
    v_add_f32_dpp v97, v91, v91 row_ror:8 row_mask:0xf bank_mask:0xc
    v_cvt_pk_bf16_f32 v138, v124, v125
    v_add_f32_dpp v88, v96, v96 row_shl:4 row_mask:0xf bank_mask:0x5
    v_cvt_pk_bf16_f32 v139, v126, v127
    v_cvt_pk_bf16_f32 v140, v128, v129
    v_add_f32_dpp v88, v97, v97 row_shr:4 row_mask:0xf bank_mask:0xa
    v_cvt_pk_bf16_f32 v141, v130, v131
    v_cvt_pk_bf16_f32 v142, v132, v133
    v_add_f32_dpp v88, v88, v88 quad_perm:[1,0,3,2] row_mask:0xf bank_mask:0xf
    v_cvt_pk_bf16_f32 v143, v134, v135
    s_nop 0
    v_add_f32_dpp v88, v88, v88 quad_perm:[2,3,0,1] row_mask:0xf bank_mask:0xf
    ds_write_b32 v108, v88 offset:46592
    v_mov_b32 v95, v95
    v_mov_b32 v95, v95
    v_mov_b32 v95, v95
    v_mov_b32_e64 v95, v95
    s_waitcnt lgkmcnt(0)
    s_barrier
    ds_read_b128 v[88:91], v109 offset:46592
    ds_read_b128 v[96:99], v109 offset:46720
    v_mov_b32 v95, v95
    v_mov_b32 v95, v95
    v_mov_b32 v95, v95
    v_mov_b32 v95, v95
    v_mov_b32_e64 v95, v95
    v_mov_b32 v95, v95
    s_waitcnt lgkmcnt(0)
    v_pk_add_f32 v[88:89], v[88:89], v[90:91]
    v_pk_add_f32 v[96:97], v[96:97], v[98:99]
    v_add_f32 v72, v88, v89
    v_add_f32 v73, v96, v97
    v_mul_f32 v72, 0x3b000000, v72
    v_mul_f32 v73, 0x3b000000, v73
    v_fma_f32 v73, -v72, v72, v73
    v_max_f32_e64 v73, 0, v73
    v_add_f32 v74, 0x3727c5ac, v73
    v_fmamk_f32 v74, v74, 0x3727c5ac, v73
    v_rsq_f32 v74, v74
    s_nop 0
    v_mul_f32 v72, -v72, v74
    v_mov_b32_dpp v88, v74 row_newbcast:0 row_mask:0xf bank_mask:0xf
    v_mov_b32_dpp v89, v74 row_newbcast:1 row_mask:0xf bank_mask:0xf
    v_mov_b32_dpp v90, v74 row_newbcast:2 row_mask:0xf bank_mask:0xf
    v_mov_b32_dpp v91, v74 row_newbcast:3 row_mask:0xf bank_mask:0xf
    v_mov_b32_dpp v92, v74 row_newbcast:4 row_mask:0xf bank_mask:0xf
    v_mov_b32_dpp v93, v74 row_newbcast:5 row_mask:0xf bank_mask:0xf
    v_mov_b32_dpp v94, v74 row_newbcast:6 row_mask:0xf bank_mask:0xf
    v_mov_b32_dpp v95, v74 row_newbcast:7 row_mask:0xf bank_mask:0xf
    v_mov_b32_dpp v96, v72 row_newbcast:0 row_mask:0xf bank_mask:0xf
    v_mov_b32_dpp v97, v72 row_newbcast:1 row_mask:0xf bank_mask:0xf
    v_mov_b32_dpp v98, v72 row_newbcast:2 row_mask:0xf bank_mask:0xf
    v_mov_b32_dpp v99, v72 row_newbcast:3 row_mask:0xf bank_mask:0xf
    v_mov_b32_dpp v100, v72 row_newbcast:4 row_mask:0xf bank_mask:0xf
    v_mov_b32_dpp v101, v72 row_newbcast:5 row_mask:0xf bank_mask:0xf
    v_mov_b32_dpp v102, v72 row_newbcast:6 row_mask:0xf bank_mask:0xf
    v_mov_b32_dpp v103, v72 row_newbcast:7 row_mask:0xf bank_mask:0xf
    v_pk_fma_f32 v[72:73], v[120:121], v[88:89], v[96:97]
    v_pk_fma_f32 v[74:75], v[122:123], v[90:91], v[98:99]
    v_pk_fma_f32 v[76:77], v[124:125], v[92:93], v[100:101]
    v_pk_fma_f32 v[78:79], v[126:127], v[94:95], v[102:103]
    v_cvt_pk_bf16_f32 v112, v72, v73
    v_cvt_pk_bf16_f32 v113, v74, v75
    v_cvt_pk_bf16_f32 v114, v76, v77
    v_cvt_pk_bf16_f32 v115, v78, v79
    buffer_store_dwordx4 v[112:115], v105, s[52:55], s8 offen sc1
    v_pk_fma_f32 v[80:81], v[128:129], v[88:89], v[96:97]
    v_pk_fma_f32 v[82:83], v[130:131], v[90:91], v[98:99]
    v_pk_fma_f32 v[84:85], v[132:133], v[92:93], v[100:101]
    v_pk_fma_f32 v[86:87], v[134:135], v[94:95], v[102:103]
    v_cvt_pk_bf16_f32 v116, v80, v81
    v_cvt_pk_bf16_f32 v117, v82, v83
    v_cvt_pk_bf16_f32 v118, v84, v85
    v_cvt_pk_bf16_f32 v119, v86, v87
    buffer_store_dwordx4 v[116:119], v105, s[52:55], s9 offen sc1
    ds_write_b128 v1, v[136:139] offset:24576
    ds_write_b128 v1, v[140:143] offset:28672
    s_nop 0
    v_and_b32 v12, 63, v0
    v_lshrrev_b32 v24, 4, v12
    v_and_b32 v25, 15, v12
    s_lshr_b32 s39, s3, 1
    s_lshl_b32 s39, s39, 6
    s_lshl_b32 s40, s36, 7
    s_add_u32 s39, s39, s40
    v_lshl_add_u32 v13, v24, 3, s39
    global_load_dwordx2 v[16:17], v13, s[22:23] offset:0
    global_load_dwordx2 v[18:19], v13, s[22:23] offset:32
    s_xor_b32 s76, s3, 0
    s_mul_i32 s76, s76, 6144
    s_xor_b32 s77, s3, 1
    s_mul_i32 s77, s77, 6144
    s_xor_b32 s78, s3, 2
    s_mul_i32 s78, s78, 6144
    s_xor_b32 s79, s3, 3
    s_mul_i32 s79, s79, 6144
    s_and_b32 s41, s3, 1
    s_lshl_b32 s40, s41, 8
    v_lshl_add_u32 v14, v12, 2, s76
    v_lshl_add_u32 v10, v25, 4, s40
    v_lshl_add_u32 v10, v24, 9, v10
    v_xor_b32 v11, 0x100, v10
    v_and_b32 v13, 15, v12
    v_lshlrev_b32 v13, 2, v13
    v_lshrrev_b64 v[26:27], v13, s[64:65]
    v_lshrrev_b64 v[28:29], v13, s[66:67]
    v_cmp_gt_u32 vcc, 32, v12
    s_lshl_b32 s39, s35, 18
    s_lshl_b32 s40, s3, 15
    s_add_u32 s39, s39, s40
    s_add_u32 s39, s39, 4718592
    s_mul_i32 s41, s35, 229376
    s_add_u32 s41, s41, 7077888
    s_mul_i32 s40, s3, 28672
    s_add_u32 s40, s40, s41
    v_cndmask_b32 v26, v28, v26, vcc
    v_and_b32 v26, 15, v26
    v_mov_b32 v30, s39
    v_mov_b32 v27, s40
    v_cndmask_b32 v30, v27, v30, vcc
    v_mov_b32 v31, 131072
    v_mov_b32 v27, 114688
    v_cndmask_b32_e64 v31, v27, v31, vcc
    v_bfe_u32 v13, v12, 4, 1
    v_mad_u32_u24 v30, v31, v13, v30
    v_lshl_add_u32 v12, v26, 11, v30
    s_nop 0
    s_lshl_b32 s39, s36, 1
    s_lshr_b32 s40, s3, 1
    s_add_u32 s39, s39, s40
    s_lshl_b32 s39, s39, 11
    s_add_u32 s80, s39, s41
    s_add_u32 s81, s80, 114688
    s_mov_b32 s82, 0xbdd2d3e8
    s_mov_b32 s83, 0xbdd2d3e8
    v_mov_b32 v20, 0xc0135761
    v_mov_b32 v21, 0xc0135761
    v_readlane_b32 s7, v12, 0
    v_readlane_b32 s12, v12, 1
    v_readlane_b32 s13, v12, 2
    v_readlane_b32 s14, v12, 3
    v_readlane_b32 s15, v12, 4
    v_readlane_b32 s70, v12, 5
    ds_read_b64_tr_b16 a[128:129], v8 offset:16384
    ds_read_b64_tr_b16 a[130:131], v8 offset:18432
    ds_read_b64_tr_b16 a[132:133], v9 offset:16384
    ds_read_b64_tr_b16 a[134:135], v9 offset:18432
    ds_read_b64_tr_b16 a[136:137], v8 offset:16896
    ds_read_b64_tr_b16 a[138:139], v8 offset:18944
    ds_read_b64_tr_b16 a[140:141], v9 offset:16896
    ds_read_b64_tr_b16 a[142:143], v9 offset:18944
    s_bfe_u32 s48, s65, 0x4001c
    s_mul_i32 s48, s48, 114688
    s_add_u32 s48, s48, s5
    s_add_u32 m0, s4, 81920
    s_waitcnt lgkmcnt(0)
    buffer_load_dwordx4 v255, s[56:59], s48 offen offset:0 lds
    buffer_load_dwordx4 v254, s[56:59], s48 offen offset:1024 lds
    buffer_load_dwordx4 v253, s[56:59], s48 offen offset:2048 lds
    buffer_load_dwordx4 v252, s[56:59], s48 offen offset:3072 lds
    ds_read_b64_tr_b16 a[144:145], v8 offset:32768
    ds_read_b64_tr_b16 a[146:147], v8 offset:34816
    ds_read_b64_tr_b16 a[148:149], v9 offset:32768
    ds_read_b64_tr_b16 a[150:151], v9 offset:34816
    ds_read_b64_tr_b16 a[152:153], v8 offset:33280
    ds_read_b64_tr_b16 a[154:155], v8 offset:35328
    ds_read_b64_tr_b16 a[156:157], v9 offset:33280
    ds_read_b64_tr_b16 a[158:159], v9 offset:35328
    s_bfe_u32 s48, s66, 0x40008
    s_lshl_b32 s48, s48, 17
    s_add_u32 s48, s48, s6
    s_add_u32 m0, s4, 98304
    s_nop 0
    s_waitcnt lgkmcnt(0)
    buffer_load_dwordx4 v2, s[60:63], s48 offen offset:0 lds
    buffer_load_dwordx4 v3, s[60:63], s48 offen offset:1024 lds
    buffer_load_dwordx4 v4, s[60:63], s48 offen offset:2048 lds
    buffer_load_dwordx4 v5, s[60:63], s48 offen offset:3072 lds
    ds_read_b64_tr_b16 a[160:161], v6 offset:32768
    ds_read_b64_tr_b16 a[162:163], v6 offset:34816
    ds_read_b64_tr_b16 a[164:165], v7 offset:32768
    ds_read_b64_tr_b16 a[166:167], v7 offset:34816
    ds_read_b64_tr_b16 a[168:169], v6 offset:33280
    ds_read_b64_tr_b16 a[170:171], v6 offset:35328
    ds_read_b64_tr_b16 a[172:173], v7 offset:33280
    ds_read_b64_tr_b16 a[174:175], v7 offset:35328
    s_bfe_u32 s48, s66, 0x4000c
    s_lshl_b32 s48, s48, 17
    s_add_u32 s48, s48, s6
    s_add_u32 m0, s4, 32768
    s_nop 0
    s_waitcnt lgkmcnt(0)
    buffer_load_dwordx4 v2, s[60:63], s48 offen offset:0 lds
    buffer_load_dwordx4 v3, s[60:63], s48 offen offset:1024 lds
    buffer_load_dwordx4 v4, s[60:63], s48 offen offset:2048 lds
    buffer_load_dwordx4 v5, s[60:63], s48 offen offset:3072 lds
    ds_read_b64_tr_b16 a[176:177], v6 offset:0
    ds_read_b64_tr_b16 a[178:179], v6 offset:2048
    ds_read_b64_tr_b16 a[180:181], v7 offset:0
    ds_read_b64_tr_b16 a[182:183], v7 offset:2048
    ds_read_b64_tr_b16 a[184:185], v6 offset:512
    ds_read_b64_tr_b16 a[186:187], v6 offset:2560
    ds_read_b64_tr_b16 a[188:189], v7 offset:512
    ds_read_b64_tr_b16 a[190:191], v7 offset:2560
    s_bfe_u32 s48, s66, 0x40010
    s_lshl_b32 s48, s48, 17
    s_add_u32 s48, s48, s6
    s_add_u32 m0, s4, 0
    s_waitcnt lgkmcnt(0)
    buffer_load_dwordx4 v2, s[60:63], s48 offen offset:0 lds
    buffer_load_dwordx4 v3, s[60:63], s48 offen offset:1024 lds
    buffer_load_dwordx4 v4, s[60:63], s48 offen offset:2048 lds
    buffer_load_dwordx4 v5, s[60:63], s48 offen offset:3072 lds
    ds_read_b64_tr_b16 a[192:193], v6 offset:16384
    ds_read_b64_tr_b16 a[194:195], v6 offset:18432
    ds_read_b64_tr_b16 a[196:197], v7 offset:16384
    ds_read_b64_tr_b16 a[198:199], v7 offset:18432
    ds_read_b64_tr_b16 a[200:201], v6 offset:16896
    ds_read_b64_tr_b16 a[202:203], v6 offset:18944
    ds_read_b64_tr_b16 a[204:205], v7 offset:16896
    ds_read_b64_tr_b16 a[206:207], v7 offset:18944
    s_bfe_u32 s48, s66, 0x40014
    s_lshl_b32 s48, s48, 17
    s_add_u32 s48, s48, s6
    s_add_u32 m0, s4, 16384
    s_waitcnt lgkmcnt(0)
    buffer_load_dwordx4 v2, s[60:63], s48 offen offset:0 lds
    buffer_load_dwordx4 v3, s[60:63], s48 offen offset:1024 lds
    buffer_load_dwordx4 v4, s[60:63], s48 offen offset:2048 lds
    buffer_load_dwordx4 v5, s[60:63], s48 offen offset:3072 lds
    s_waitcnt vmcnt(28)
    ds_read_b64_tr_b16 a[208:209], v6 offset:49152
    ds_read_b64_tr_b16 a[210:211], v6 offset:51200
    ds_read_b64_tr_b16 a[212:213], v7 offset:49152
    ds_read_b64_tr_b16 a[214:215], v7 offset:51200
    ds_read_b64_tr_b16 a[216:217], v6 offset:49664
    ds_read_b64_tr_b16 a[218:219], v6 offset:51712
    ds_read_b64_tr_b16 a[220:221], v7 offset:49664
    ds_read_b64_tr_b16 a[222:223], v7 offset:51712
    s_bfe_u32 s48, s66, 0x40018
    s_lshl_b32 s48, s48, 17
    s_add_u32 s48, s48, s6
    s_add_u32 m0, s4, 49152
    s_waitcnt lgkmcnt(0)
    buffer_load_dwordx4 v2, s[60:63], s48 offen offset:0 lds
    buffer_load_dwordx4 v3, s[60:63], s48 offen offset:1024 lds
    buffer_load_dwordx4 v4, s[60:63], s48 offen offset:2048 lds
    buffer_load_dwordx4 v5, s[60:63], s48 offen offset:3072 lds
    s_waitcnt vmcnt(28)
    ds_read_b64_tr_b16 a[224:225], v8 offset:0
    ds_read_b64_tr_b16 a[226:227], v8 offset:2048
    ds_read_b64_tr_b16 a[228:229], v9 offset:0
    ds_read_b64_tr_b16 a[230:231], v9 offset:2048
    ds_read_b64_tr_b16 a[232:233], v8 offset:512
    ds_read_b64_tr_b16 a[234:235], v8 offset:2560
    ds_read_b64_tr_b16 a[236:237], v9 offset:512
    ds_read_b64_tr_b16 a[238:239], v9 offset:2560
    s_nop 0
    s_waitcnt vmcnt(20)
    ds_read_b64_tr_b16 a[240:241], v8 offset:16384
    ds_read_b64_tr_b16 a[242:243], v8 offset:18432
    ds_read_b64_tr_b16 a[244:245], v9 offset:16384
    ds_read_b64_tr_b16 a[246:247], v9 offset:18432
    ds_read_b64_tr_b16 a[248:249], v8 offset:16896
    ds_read_b64_tr_b16 a[250:251], v8 offset:18944
    ds_read_b64_tr_b16 a[252:253], v9 offset:16896
    ds_read_b64_tr_b16 a[254:255], v9 offset:18944
    s_waitcnt lgkmcnt(0)
    s_barrier
    buffer_load_dwordx4 v[68:71], v11, s[52:55], s7 offen sc1
    buffer_load_dwordx4 v[64:67], v10, s[52:55], s7 offen sc1
    buffer_load_dwordx4 v[60:63], v11, s[52:55], s12 offen sc1
    buffer_load_dwordx4 v[56:59], v10, s[52:55], s12 offen sc1
    buffer_load_dwordx4 v[52:55], v11, s[52:55], s13 offen sc1
    buffer_load_dwordx4 v[48:51], v10, s[52:55], s13 offen sc1
    buffer_load_dwordx4 v[44:47], v11, s[52:55], s14 offen sc1
    buffer_load_dwordx4 v[40:43], v10, s[52:55], s14 offen sc1
    buffer_load_dwordx4 v[36:39], v11, s[52:55], s15 offen sc1
    buffer_load_dwordx4 v[32:35], v10, s[52:55], s15 offen sc1
    v_lshlrev_b32_e64 v72, 16, v16
    v_and_b32 v73, 0xffff0000, v16
    v_lshlrev_b32_e64 v74, 16, v17
    v_and_b32 v75, 0xffff0000, v17
    v_lshlrev_b32_e64 v76, 16, v18
    v_and_b32 v77, 0xffff0000, v18
    v_lshlrev_b32_e64 v78, 16, v19
    v_and_b32 v79, 0xffff0000, v19
    v_lshlrev_b32_e64 v104, 16, v16
    v_and_b32 v105, 0xffff0000, v16
    v_lshlrev_b32_e64 v106, 16, v17
    v_and_b32 v107, 0xffff0000, v17
    v_lshlrev_b32_e64 v108, 16, v18
    v_and_b32 v109, 0xffff0000, v18
    v_lshlrev_b32_e64 v110, 16, v19
    v_and_b32 v111, 0xffff0000, v19
    s_cmp_ge_u32 s38, 7
    s_cbranch_scc1 interleave_layers__ssm_conv_s4d__mixer_token_mlp__prompt_kernel_g1idle32
    s_mov_b32 s43, 0
    s_waitcnt vmcnt(8)
    v_cmp_u_f32 vcc, v64, v68
    s_cbranch_vccnz interleave_layers__ssm_conv_s4d__mixer_token_mlp__prompt_kernel_rt40
interleave_layers__ssm_conv_s4d__mixer_token_mlp__prompt_kernel_ok41:
    v_mfma_f32_16x16x32_bf16 v[100:103], a[12:15], v[68:71], 0
    buffer_load_dwordx4 v[28:31], v11, s[52:55], s70 offen sc1
    ds_read_b64_tr_b16 v[176:177], v8 offset:32768
    v_mfma_f32_16x16x32_bf16 v[92:95], a[12:15], v[64:67], 0
    ds_read_b64_tr_b16 v[178:179], v8 offset:34816
    v_mfma_f32_16x16x32_bf16 v[96:99], a[8:11], v[68:71], 0
    buffer_load_dwordx4 v[24:27], v10, s[52:55], s70 offen sc1
    ds_read_b64_tr_b16 v[180:181], v9 offset:32768
    v_mfma_f32_16x16x32_bf16 v[88:91], a[8:11], v[64:67], 0
    ds_read_b64_tr_b16 v[182:183], v9 offset:34816
    v_mfma_f32_16x16x32_bf16 v[84:87], a[4:7], v[68:71], 0
    v_readlane_b32 s7, v12, 6
    ds_read_b64_tr_b16 v[184:185], v8 offset:33280
    v_mfma_f32_16x16x32_bf16 v[76:79], a[4:7], v[64:67], v[76:79]
    s_waitcnt vmcnt(8)
    v_cmp_u_f32 vcc, v56, v60
    v_mfma_f32_16x16x32_bf16 v[80:83], a[0:3], v[68:71], 0
    ds_read_b64_tr_b16 v[186:187], v8 offset:35328
    v_mfma_f32_16x16x32_bf16 v[72:75], a[0:3], v[64:67], v[72:75]
    s_nop 0
    s_cbranch_vccnz interleave_layers__ssm_conv_s4d__mixer_token_mlp__prompt_kernel_rt42
interleave_layers__ssm_conv_s4d__mixer_token_mlp__prompt_kernel_ok43:
    ds_read_b64_tr_b16 v[188:189], v9 offset:33280
    v_mfma_f32_16x16x32_bf16 v[100:103], a[28:31], v[60:63], v[100:103]
    buffer_load_dwordx4 v[68:71], v11, s[52:55], s7 offen sc1
    ds_read_b64_tr_b16 v[190:191], v9 offset:35328
    v_mfma_f32_16x16x32_bf16 v[92:95], a[28:31], v[56:59], v[92:95]
    ds_read_b64_tr_b16 v[192:193], v6 offset:32768
    v_mfma_f32_16x16x32_bf16 v[96:99], a[24:27], v[60:63], v[96:99]
    buffer_load_dwordx4 v[64:67], v10, s[52:55], s7 offen sc1
    ds_read_b64_tr_b16 v[194:195], v6 offset:34816
    v_mfma_f32_16x16x32_bf16 v[88:91], a[24:27], v[56:59], v[88:91]
    ds_read_b64_tr_b16 v[196:197], v7 offset:32768
    v_mfma_f32_16x16x32_bf16 v[84:87], a[20:23], v[60:63], v[84:87]
    v_readlane_b32 s12, v12, 7
    ds_read_b64_tr_b16 v[198:199], v7 offset:34816
    v_mfma_f32_16x16x32_bf16 v[76:79], a[20:23], v[56:59], v[76:79]
    s_waitcnt vmcnt(8)
    v_cmp_u_f32 vcc, v48, v52
    v_mfma_f32_16x16x32_bf16 v[80:83], a[16:19], v[60:63], v[80:83]
    ds_read_b64_tr_b16 v[200:201], v6 offset:33280
    v_mfma_f32_16x16x32_bf16 v[72:75], a[16:19], v[56:59], v[72:75]
    s_nop 0
    s_cbranch_vccnz interleave_layers__ssm_conv_s4d__mixer_token_mlp__prompt_kernel_rt44
interleave_layers__ssm_conv_s4d__mixer_token_mlp__prompt_kernel_ok45:
    ds_read_b64_tr_b16 v[202:203], v6 offset:35328
    v_mfma_f32_16x16x32_bf16 v[100:103], a[44:47], v[52:55], v[100:103]
    buffer_load_dwordx4 v[60:63], v11, s[52:55], s12 offen sc1
    ds_read_b64_tr_b16 v[204:205], v7 offset:33280
    v_mfma_f32_16x16x32_bf16 v[92:95], a[44:47], v[48:51], v[92:95]
    ds_read_b64_tr_b16 v[206:207], v7 offset:35328
    v_mfma_f32_16x16x32_bf16 v[96:99], a[40:43], v[52:55], v[96:99]
    buffer_load_dwordx4 v[56:59], v10, s[52:55], s12 offen sc1
    ds_read_b64_tr_b16 v[208:209], v6 offset:0
    v_mfma_f32_16x16x32_bf16 v[88:91], a[40:43], v[48:51], v[88:91]
    ds_read_b64_tr_b16 v[210:211], v6 offset:2048
    v_mfma_f32_16x16x32_bf16 v[84:87], a[36:39], v[52:55], v[84:87]
    v_readlane_b32 s13, v12, 8
    ds_read_b64_tr_b16 v[212:213], v7 offset:0
    v_mfma_f32_16x16x32_bf16 v[76:79], a[36:39], v[48:51], v[76:79]
    s_waitcnt vmcnt(8)
    v_cmp_u_f32 vcc, v40, v44
    v_mfma_f32_16x16x32_bf16 v[80:83], a[32:35], v[52:55], v[80:83]
    ds_read_b64_tr_b16 v[214:215], v7 offset:2048
    v_mfma_f32_16x16x32_bf16 v[72:75], a[32:35], v[48:51], v[72:75]
    s_nop 0
    s_cbranch_vccnz interleave_layers__ssm_conv_s4d__mixer_token_mlp__prompt_kernel_rt46
interleave_layers__ssm_conv_s4d__mixer_token_mlp__prompt_kernel_ok47:
    ds_read_b64_tr_b16 v[216:217], v6 offset:512
    v_mfma_f32_16x16x32_bf16 v[100:103], a[60:63], v[44:47], v[100:103]
    buffer_load_dwordx4 v[52:55], v11, s[52:55], s13 offen sc1
    ds_read_b64_tr_b16 v[218:219], v6 offset:2560
    v_mfma_f32_16x16x32_bf16 v[92:95], a[60:63], v[40:43], v[92:95]
    ds_read_b64_tr_b16 v[220:221], v7 offset:512
    v_mfma_f32_16x16x32_bf16 v[96:99], a[56:59], v[44:47], v[96:99]
    buffer_load_dwordx4 v[48:51], v10, s[52:55], s13 offen sc1
    ds_read_b64_tr_b16 v[222:223], v7 offset:2560
    v_mfma_f32_16x16x32_bf16 v[88:91], a[56:59], v[40:43], v[88:91]
    ds_read_b64_tr_b16 v[224:225], v6 offset:16384
    v_mfma_f32_16x16x32_bf16 v[84:87], a[52:55], v[44:47], v[84:87]
    v_readlane_b32 s14, v12, 9
    ds_read_b64_tr_b16 v[226:227], v6 offset:18432
    v_mfma_f32_16x16x32_bf16 v[76:79], a[52:55], v[40:43], v[76:79]
    s_waitcnt vmcnt(8)
    v_cmp_u_f32 vcc, v32, v36
    v_mfma_f32_16x16x32_bf16 v[80:83], a[48:51], v[44:47], v[80:83]
    ds_read_b64_tr_b16 v[228:229], v7 offset:16384
    v_mfma_f32_16x16x32_bf16 v[72:75], a[48:51], v[40:43], v[72:75]
    s_nop 0
    s_cbranch_vccnz interleave_layers__ssm_conv_s4d__mixer_token_mlp__prompt_kernel_rt48
interleave_layers__ssm_conv_s4d__mixer_token_mlp__prompt_kernel_ok49:
    ds_read_b64_tr_b16 v[230:231], v7 offset:18432
    v_mfma_f32_16x16x32_bf16 v[100:103], a[76:79], v[36:39], v[100:103]
    buffer_load_dwordx4 v[44:47], v11, s[52:55], s14 offen sc1
    ds_read_b64_tr_b16 v[232:233], v6 offset:16896
    v_mfma_f32_16x16x32_bf16 v[92:95], a[76:79], v[32:35], v[92:95]
    ds_read_b64_tr_b16 v[234:235], v6 offset:18944
    v_mfma_f32_16x16x32_bf16 v[96:99], a[72:75], v[36:39], v[96:99]
    buffer_load_dwordx4 v[40:43], v10, s[52:55], s14 offen sc1
    ds_read_b64_tr_b16 v[236:237], v7 offset:16896
    v_mfma_f32_16x16x32_bf16 v[88:91], a[72:75], v[32:35], v[88:91]
    ds_read_b64_tr_b16 v[238:239], v7 offset:18944
    v_mfma_f32_16x16x32_bf16 v[84:87], a[68:71], v[36:39], v[84:87]
    v_readlane_b32 s15, v12, 10
    ds_read_b64_tr_b16 v[240:241], v6 offset:49152
    v_mfma_f32_16x16x32_bf16 v[76:79], a[68:71], v[32:35], v[76:79]
    s_waitcnt vmcnt(8)
    v_cmp_u_f32 vcc, v24, v28
    v_mfma_f32_16x16x32_bf16 v[80:83], a[64:67], v[36:39], v[80:83]
    ds_read_b64_tr_b16 v[242:243], v6 offset:51200
    v_mfma_f32_16x16x32_bf16 v[72:75], a[64:67], v[32:35], v[72:75]
    s_nop 0
    s_cbranch_vccnz interleave_layers__ssm_conv_s4d__mixer_token_mlp__prompt_kernel_rt50
interleave_layers__ssm_conv_s4d__mixer_token_mlp__prompt_kernel_ok51:
    ds_read_b64_tr_b16 v[244:245], v7 offset:49152
    v_mfma_f32_16x16x32_bf16 v[100:103], a[92:95], v[28:31], v[100:103]
    buffer_load_dwordx4 v[36:39], v11, s[52:55], s15 offen sc1
    ds_read_b64_tr_b16 v[246:247], v7 offset:51200
    v_mfma_f32_16x16x32_bf16 v[92:95], a[92:95], v[24:27], v[92:95]
    ds_read_b64_tr_b16 v[248:249], v6 offset:49664
    v_mfma_f32_16x16x32_bf16 v[96:99], a[88:91], v[28:31], v[96:99]
    buffer_load_dwordx4 v[32:35], v10, s[52:55], s15 offen sc1
    ds_read_b64_tr_b16 v[250:251], v6 offset:51712
    v_mfma_f32_16x16x32_bf16 v[88:91], a[88:91], v[24:27], v[88:91]
    ds_read_b64_tr_b16 v[252:253], v7 offset:49664
    v_mfma_f32_16x16x32_bf16 v[84:87], a[84:87], v[28:31], v[84:87]
    v_readlane_b32 s70, v12, 11
    ds_read_b64_tr_b16 v[254:255], v7 offset:51712
    v_mfma_f32_16x16x32_bf16 v[76:79], a[84:87], v[24:27], v[76:79]
    s_waitcnt vmcnt(8)
    v_cmp_u_f32 vcc, v64, v68
    v_mfma_f32_16x16x32_bf16 v[80:83], a[80:83], v[28:31], v[80:83]
    v_mfma_f32_16x16x32_bf16 v[72:75], a[80:83], v[24:27], v[72:75]
    s_nop 0
    s_cbranch_vccnz interleave_layers__ssm_conv_s4d__mixer_token_mlp__prompt_kernel_rt52
interleave_layers__ssm_conv_s4d__mixer_token_mlp__prompt_kernel_ok53:
    v_mfma_f32_16x16x32_bf16 v[100:103], a[108:111], v[68:71], v[100:103]
    buffer_load_dwordx4 v[28:31], v11, s[52:55], s70 offen sc1
    v_mfma_f32_16x16x32_bf16 v[92:95], a[108:111], v[64:67], v[92:95]
    v_mfma_f32_16x16x32_bf16 v[96:99], a[104:107], v[68:71], v[96:99]
    buffer_load_dwordx4 v[24:27], v10, s[52:55], s70 offen sc1
    v_mfma_f32_16x16x32_bf16 v[88:91], a[104:107], v[64:67], v[88:91]
    v_mfma_f32_16x16x32_bf16 v[84:87], a[100:103], v[68:71], v[84:87]
    v_readlane_b32 s7, v12, 12
    v_mfma_f32_16x16x32_bf16 v[76:79], a[100:103], v[64:67], v[76:79]
    s_waitcnt vmcnt(8)
    v_cmp_u_f32 vcc, v56, v60
    v_mfma_f32_16x16x32_bf16 v[80:83], a[96:99], v[68:71], v[80:83]
    v_mfma_f32_16x16x32_bf16 v[72:75], a[96:99], v[64:67], v[72:75]
    s_nop 0
    s_cbranch_vccnz interleave_layers__ssm_conv_s4d__mixer_token_mlp__prompt_kernel_rt54
interleave_layers__ssm_conv_s4d__mixer_token_mlp__prompt_kernel_ok55:
    v_mfma_f32_16x16x32_bf16 v[100:103], a[124:127], v[60:63], v[100:103]
    buffer_load_dwordx4 v[68:71], v11, s[52:55], s7 offen sc1
    v_mfma_f32_16x16x32_bf16 v[92:95], a[124:127], v[56:59], v[92:95]
    v_mfma_f32_16x16x32_bf16 v[96:99], a[120:123], v[60:63], v[96:99]
    buffer_load_dwordx4 v[64:67], v10, s[52:55], s7 offen sc1
    v_mfma_f32_16x16x32_bf16 v[88:91], a[120:123], v[56:59], v[88:91]
    v_mfma_f32_16x16x32_bf16 v[84:87], a[116:119], v[60:63], v[84:87]
    v_readlane_b32 s12, v12, 13
    v_mfma_f32_16x16x32_bf16 v[76:79], a[116:119], v[56:59], v[76:79]
    s_waitcnt vmcnt(8)
    v_cmp_u_f32 vcc, v48, v52
    v_mfma_f32_16x16x32_bf16 v[80:83], a[112:115], v[60:63], v[80:83]
    v_mfma_f32_16x16x32_bf16 v[72:75], a[112:115], v[56:59], v[72:75]
    s_nop 0
    s_cbranch_vccnz interleave_layers__ssm_conv_s4d__mixer_token_mlp__prompt_kernel_rt56
interleave_layers__ssm_conv_s4d__mixer_token_mlp__prompt_kernel_ok57:
    v_mfma_f32_16x16x32_bf16 v[100:103], a[140:143], v[52:55], v[100:103]
    buffer_load_dwordx4 v[60:63], v11, s[52:55], s12 offen sc1
    v_mfma_f32_16x16x32_bf16 v[92:95], a[140:143], v[48:51], v[92:95]
    v_mfma_f32_16x16x32_bf16 v[96:99], a[136:139], v[52:55], v[96:99]
    buffer_load_dwordx4 v[56:59], v10, s[52:55], s12 offen sc1
    v_mfma_f32_16x16x32_bf16 v[88:91], a[136:139], v[48:51], v[88:91]
    v_mfma_f32_16x16x32_bf16 v[84:87], a[132:135], v[52:55], v[84:87]
    v_readlane_b32 s13, v12, 14
    v_mfma_f32_16x16x32_bf16 v[76:79], a[132:135], v[48:51], v[76:79]
    s_waitcnt vmcnt(8)
    v_cmp_u_f32 vcc, v40, v44
    v_mfma_f32_16x16x32_bf16 v[80:83], a[128:131], v[52:55], v[80:83]
    v_mfma_f32_16x16x32_bf16 v[72:75], a[128:131], v[48:51], v[72:75]
    s_nop 0
    s_cbranch_vccnz interleave_layers__ssm_conv_s4d__mixer_token_mlp__prompt_kernel_rt58
interleave_layers__ssm_conv_s4d__mixer_token_mlp__prompt_kernel_ok59:
    v_mfma_f32_16x16x32_bf16 v[100:103], a[156:159], v[44:47], v[100:103]
    buffer_load_dwordx4 v[52:55], v11, s[52:55], s13 offen sc1
    v_mfma_f32_16x16x32_bf16 v[92:95], a[156:159], v[40:43], v[92:95]
    v_mfma_f32_16x16x32_bf16 v[96:99], a[152:155], v[44:47], v[96:99]
    buffer_load_dwordx4 v[48:51], v10, s[52:55], s13 offen sc1
    v_mfma_f32_16x16x32_bf16 v[88:91], a[152:155], v[40:43], v[88:91]
    v_mfma_f32_16x16x32_bf16 v[84:87], a[148:151], v[44:47], v[84:87]
    v_readlane_b32 s14, v12, 15
    v_mfma_f32_16x16x32_bf16 v[76:79], a[148:151], v[40:43], v[76:79]
    s_waitcnt vmcnt(8)
    v_cmp_u_f32 vcc, v32, v36
    v_mfma_f32_16x16x32_bf16 v[80:83], a[144:147], v[44:47], v[80:83]
    v_mfma_f32_16x16x32_bf16 v[72:75], a[144:147], v[40:43], v[72:75]
    s_nop 0
    s_cbranch_vccnz interleave_layers__ssm_conv_s4d__mixer_token_mlp__prompt_kernel_rt60
interleave_layers__ssm_conv_s4d__mixer_token_mlp__prompt_kernel_ok61:
    v_mfma_f32_16x16x32_bf16 v[100:103], a[172:175], v[36:39], v[100:103]
    buffer_load_dwordx4 v[44:47], v11, s[52:55], s14 offen sc1
    v_mfma_f32_16x16x32_bf16 v[92:95], a[172:175], v[32:35], v[92:95]
    v_mfma_f32_16x16x32_bf16 v[96:99], a[168:171], v[36:39], v[96:99]
    buffer_load_dwordx4 v[40:43], v10, s[52:55], s14 offen sc1
    v_mfma_f32_16x16x32_bf16 v[88:91], a[168:171], v[32:35], v[88:91]
    v_mfma_f32_16x16x32_bf16 v[84:87], a[164:167], v[36:39], v[84:87]
    v_readlane_b32 s15, v12, 16
    v_mfma_f32_16x16x32_bf16 v[76:79], a[164:167], v[32:35], v[76:79]
    s_waitcnt vmcnt(8)
    v_cmp_u_f32 vcc, v24, v28
    v_mfma_f32_16x16x32_bf16 v[80:83], a[160:163], v[36:39], v[80:83]
    v_mfma_f32_16x16x32_bf16 v[72:75], a[160:163], v[32:35], v[72:75]
    s_nop 0
    s_cbranch_vccnz interleave_layers__ssm_conv_s4d__mixer_token_mlp__prompt_kernel_rt62
interleave_layers__ssm_conv_s4d__mixer_token_mlp__prompt_kernel_ok63:
    v_mfma_f32_16x16x32_bf16 v[100:103], a[188:191], v[28:31], v[100:103]
    buffer_load_dwordx4 v[36:39], v11, s[52:55], s15 offen sc1
    v_mfma_f32_16x16x32_bf16 v[92:95], a[188:191], v[24:27], v[92:95]
    v_mfma_f32_16x16x32_bf16 v[96:99], a[184:187], v[28:31], v[96:99]
    buffer_load_dwordx4 v[32:35], v10, s[52:55], s15 offen sc1
    v_mfma_f32_16x16x32_bf16 v[88:91], a[184:187], v[24:27], v[88:91]
    v_mfma_f32_16x16x32_bf16 v[84:87], a[180:183], v[28:31], v[84:87]
    v_readlane_b32 s70, v12, 17
    v_mfma_f32_16x16x32_bf16 v[76:79], a[180:183], v[24:27], v[76:79]
    s_waitcnt vmcnt(8)
    v_cmp_u_f32 vcc, v64, v68
    v_mfma_f32_16x16x32_bf16 v[80:83], a[176:179], v[28:31], v[80:83]
    v_mfma_f32_16x16x32_bf16 v[72:75], a[176:179], v[24:27], v[72:75]
    s_nop 0
    s_cbranch_vccnz interleave_layers__ssm_conv_s4d__mixer_token_mlp__prompt_kernel_rt64
interleave_layers__ssm_conv_s4d__mixer_token_mlp__prompt_kernel_ok65:
    v_mfma_f32_16x16x32_bf16 v[100:103], a[204:207], v[68:71], v[100:103]
    buffer_load_dwordx4 v[28:31], v11, s[52:55], s70 offen sc1
    v_mfma_f32_16x16x32_bf16 v[92:95], a[204:207], v[64:67], v[92:95]
    v_mfma_f32_16x16x32_bf16 v[96:99], a[200:203], v[68:71], v[96:99]
    buffer_load_dwordx4 v[24:27], v10, s[52:55], s70 offen sc1
    v_mfma_f32_16x16x32_bf16 v[88:91], a[200:203], v[64:67], v[88:91]
    v_mfma_f32_16x16x32_bf16 v[84:87], a[196:199], v[68:71], v[84:87]
    v_readlane_b32 s7, v12, 18
    v_mfma_f32_16x16x32_bf16 v[76:79], a[196:199], v[64:67], v[76:79]
    s_waitcnt vmcnt(8)
    v_cmp_u_f32 vcc, v56, v60
    v_mfma_f32_16x16x32_bf16 v[80:83], a[192:195], v[68:71], v[80:83]
    v_mfma_f32_16x16x32_bf16 v[72:75], a[192:195], v[64:67], v[72:75]
    s_nop 0
    s_cbranch_vccnz interleave_layers__ssm_conv_s4d__mixer_token_mlp__prompt_kernel_rt66
interleave_layers__ssm_conv_s4d__mixer_token_mlp__prompt_kernel_ok67:
    v_mfma_f32_16x16x32_bf16 v[100:103], a[220:223], v[60:63], v[100:103]
    buffer_load_dwordx4 v[68:71], v11, s[52:55], s7 offen sc1
    v_mfma_f32_16x16x32_bf16 v[92:95], a[220:223], v[56:59], v[92:95]
    v_mfma_f32_16x16x32_bf16 v[96:99], a[216:219], v[60:63], v[96:99]
    buffer_load_dwordx4 v[64:67], v10, s[52:55], s7 offen sc1
    v_mfma_f32_16x16x32_bf16 v[88:91], a[216:219], v[56:59], v[88:91]
    v_mfma_f32_16x16x32_bf16 v[84:87], a[212:215], v[60:63], v[84:87]
    v_readlane_b32 s12, v12, 19
    v_mfma_f32_16x16x32_bf16 v[76:79], a[212:215], v[56:59], v[76:79]
    s_waitcnt vmcnt(8)
    v_cmp_u_f32 vcc, v48, v52
    v_mfma_f32_16x16x32_bf16 v[80:83], a[208:211], v[60:63], v[80:83]
    v_mfma_f32_16x16x32_bf16 v[72:75], a[208:211], v[56:59], v[72:75]
    s_nop 0
    s_cbranch_vccnz interleave_layers__ssm_conv_s4d__mixer_token_mlp__prompt_kernel_rt68
interleave_layers__ssm_conv_s4d__mixer_token_mlp__prompt_kernel_ok69:
    v_mfma_f32_16x16x32_bf16 v[100:103], a[236:239], v[52:55], v[100:103]
    buffer_load_dwordx4 v[60:63], v11, s[52:55], s12 offen sc1
    v_mfma_f32_16x16x32_bf16 v[92:95], a[236:239], v[48:51], v[92:95]
    v_mfma_f32_16x16x32_bf16 v[96:99], a[232:235], v[52:55], v[96:99]
    buffer_load_dwordx4 v[56:59], v10, s[52:55], s12 offen sc1
    v_mfma_f32_16x16x32_bf16 v[88:91], a[232:235], v[48:51], v[88:91]
    v_mfma_f32_16x16x32_bf16 v[84:87], a[228:231], v[52:55], v[84:87]
    v_readlane_b32 s13, v12, 20
    v_mfma_f32_16x16x32_bf16 v[76:79], a[228:231], v[48:51], v[76:79]
    s_waitcnt vmcnt(8)
    v_cmp_u_f32 vcc, v40, v44
    v_mfma_f32_16x16x32_bf16 v[80:83], a[224:227], v[52:55], v[80:83]
    v_mfma_f32_16x16x32_bf16 v[72:75], a[224:227], v[48:51], v[72:75]
    s_nop 0
    s_cbranch_vccnz interleave_layers__ssm_conv_s4d__mixer_token_mlp__prompt_kernel_rt70
interleave_layers__ssm_conv_s4d__mixer_token_mlp__prompt_kernel_ok71:
    v_mfma_f32_16x16x32_bf16 v[100:103], a[252:255], v[44:47], v[100:103]
    buffer_load_dwordx4 v[52:55], v11, s[52:55], s13 offen sc1
    v_mfma_f32_16x16x32_bf16 v[92:95], a[252:255], v[40:43], v[92:95]
    v_mfma_f32_16x16x32_bf16 v[96:99], a[248:251], v[44:47], v[96:99]
    buffer_load_dwordx4 v[48:51], v10, s[52:55], s13 offen sc1
    v_mfma_f32_16x16x32_bf16 v[88:91], a[248:251], v[40:43], v[88:91]
    v_mfma_f32_16x16x32_bf16 v[84:87], a[244:247], v[44:47], v[84:87]
    v_readlane_b32 s14, v12, 21
    v_mfma_f32_16x16x32_bf16 v[76:79], a[244:247], v[40:43], v[76:79]
    s_waitcnt vmcnt(8)
    v_cmp_u_f32 vcc, v32, v36
    v_mfma_f32_16x16x32_bf16 v[80:83], a[240:243], v[44:47], v[80:83]
    v_mfma_f32_16x16x32_bf16 v[72:75], a[240:243], v[40:43], v[72:75]
    s_nop 0
    s_cbranch_vccnz interleave_layers__ssm_conv_s4d__mixer_token_mlp__prompt_kernel_rt72
interleave_layers__ssm_conv_s4d__mixer_token_mlp__prompt_kernel_ok73:
    v_mfma_f32_16x16x32_bf16 v[132:135], a[12:15], v[36:39], 0
    buffer_load_dwordx4 v[44:47], v11, s[52:55], s14 offen sc1
    v_mfma_f32_16x16x32_bf16 v[124:127], a[12:15], v[32:35], 0
    v_mfma_f32_16x16x32_bf16 v[128:131], a[8:11], v[36:39], 0
    buffer_load_dwordx4 v[40:43], v10, s[52:55], s14 offen sc1
    v_mfma_f32_16x16x32_bf16 v[120:123], a[8:11], v[32:35], 0
    s_barrier
    s_add_u32 m0, s79, 4096
    s_nop 0
    ds_write_addtid_b32 v96 offset:0
    v_mfma_f32_16x16x32_bf16 v[116:119], a[4:7], v[36:39], 0
    v_readlane_b32 s15, v12, 22
    ds_write_addtid_b32 v97 offset:256
    v_mfma_f32_16x16x32_bf16 v[108:111], a[4:7], v[32:35], v[108:111]
    s_waitcnt vmcnt(8)
    v_cmp_u_f32 vcc, v24, v28
    v_mfma_f32_16x16x32_bf16 v[112:115], a[0:3], v[36:39], 0
    ds_write_addtid_b32 v98 offset:512
    v_mfma_f32_16x16x32_bf16 v[104:107], a[0:3], v[32:35], v[104:107]
    s_nop 0
    s_cbranch_vccnz interleave_layers__ssm_conv_s4d__mixer_token_mlp__prompt_kernel_rt74
interleave_layers__ssm_conv_s4d__mixer_token_mlp__prompt_kernel_ok75:
    ds_write_addtid_b32 v99 offset:768
    v_mfma_f32_16x16x32_bf16 v[132:135], a[28:31], v[28:31], v[132:135]
    buffer_load_dwordx4 v[36:39], v11, s[52:55], s15 offen sc1
    ds_write_addtid_b32 v100 offset:1024
    v_mfma_f32_16x16x32_bf16 v[124:127], a[28:31], v[24:27], v[124:127]
    ds_write_addtid_b32 v101 offset:1280
    ds_write_addtid_b32 v102 offset:1536
    v_mfma_f32_16x16x32_bf16 v[128:131], a[24:27], v[28:31], v[128:131]
    buffer_load_dwordx4 v[32:35], v10, s[52:55], s15 offen sc1
    v_mfma_f32_16x16x32_bf16 v[120:123], a[24:27], v[24:27], v[120:123]
    ds_write_addtid_b32 v103 offset:1792
    s_add_u32 m0, s78, 2048
    v_mfma_f32_16x16x32_bf16 v[116:119], a[20:23], v[28:31], v[116:119]
    v_readlane_b32 s70, v12, 23
    ds_write_addtid_b32 v88 offset:0
    v_mfma_f32_16x16x32_bf16 v[108:111], a[20:23], v[24:27], v[108:111]
    s_waitcnt vmcnt(8)
    v_cmp_u_f32 vcc, v64, v68
    ds_write_addtid_b32 v89 offset:256
    v_mfma_f32_16x16x32_bf16 v[112:115], a[16:19], v[28:31], v[112:115]
    ds_write_addtid_b32 v90 offset:512
    v_mfma_f32_16x16x32_bf16 v[104:107], a[16:19], v[24:27], v[104:107]
    s_nop 0
    s_cbranch_vccnz interleave_layers__ssm_conv_s4d__mixer_token_mlp__prompt_kernel_rt76
interleave_layers__ssm_conv_s4d__mixer_token_mlp__prompt_kernel_ok77:
    ds_write_addtid_b32 v91 offset:768
    v_mfma_f32_16x16x32_bf16 v[132:135], a[44:47], v[68:71], v[132:135]
    buffer_load_dwordx4 v[28:31], v11, s[52:55], s70 offen sc1
    ds_write_addtid_b32 v92 offset:1024
    v_mfma_f32_16x16x32_bf16 v[124:127], a[44:47], v[64:67], v[124:127]
    ds_write_addtid_b32 v93 offset:1280
    v_mfma_f32_16x16x32_bf16 v[128:131], a[40:43], v[68:71], v[128:131]
    buffer_load_dwordx4 v[24:27], v10, s[52:55], s70 offen sc1
    ds_write_addtid_b32 v94 offset:1536
    v_mfma_f32_16x16x32_bf16 v[120:123], a[40:43], v[64:67], v[120:123]
    ds_write_addtid_b32 v95 offset:1792
    v_mfma_f32_16x16x32_bf16 v[116:119], a[36:39], v[68:71], v[116:119]
    v_readlane_b32 s7, v12, 24
    s_add_u32 m0, s77, 0
    s_nop 0
    ds_write_addtid_b32 v80 offset:0
    v_mfma_f32_16x16x32_bf16 v[108:111], a[36:39], v[64:67], v[108:111]
    s_waitcnt vmcnt(8)
    v_cmp_u_f32 vcc, v56, v60
    v_mfma_f32_16x16x32_bf16 v[112:115], a[32:35], v[68:71], v[112:115]
    ds_write_addtid_b32 v81 offset:256
    v_mfma_f32_16x16x32_bf16 v[104:107], a[32:35], v[64:67], v[104:107]
    s_nop 0
    s_cbranch_vccnz interleave_layers__ssm_conv_s4d__mixer_token_mlp__prompt_kernel_rt78
interleave_layers__ssm_conv_s4d__mixer_token_mlp__prompt_kernel_ok79:
    ds_write_addtid_b32 v82 offset:512
    v_mfma_f32_16x16x32_bf16 v[132:135], a[60:63], v[60:63], v[132:135]
    buffer_load_dwordx4 v[68:71], v11, s[52:55], s7 offen sc1
    ds_write_addtid_b32 v83 offset:768
    v_mfma_f32_16x16x32_bf16 v[124:127], a[60:63], v[56:59], v[124:127]
    ds_write_addtid_b32 v84 offset:1024
    ds_write_addtid_b32 v85 offset:1280
    v_mfma_f32_16x16x32_bf16 v[128:131], a[56:59], v[60:63], v[128:131]
    buffer_load_dwordx4 v[64:67], v10, s[52:55], s7 offen sc1
    v_mfma_f32_16x16x32_bf16 v[120:123], a[56:59], v[56:59], v[120:123]
    ds_write_addtid_b32 v86 offset:1536
    ds_write_addtid_b32 v87 offset:1792
    v_mfma_f32_16x16x32_bf16 v[116:119], a[52:55], v[60:63], v[116:119]
    v_readlane_b32 s12, v12, 25
    v_mfma_f32_16x16x32_bf16 v[108:111], a[52:55], v[56:59], v[108:111]
    s_waitcnt vmcnt(8)
    v_cmp_u_f32 vcc, v48, v52
    v_mfma_f32_16x16x32_bf16 v[112:115], a[48:51], v[60:63], v[112:115]
    v_mfma_f32_16x16x32_bf16 v[104:107], a[48:51], v[56:59], v[104:107]
    s_cbranch_vccnz interleave_layers__ssm_conv_s4d__mixer_token_mlp__prompt_kernel_rt80
interleave_layers__ssm_conv_s4d__mixer_token_mlp__prompt_kernel_ok81:
    v_mfma_f32_16x16x32_bf16 v[132:135], a[76:79], v[52:55], v[132:135]
    buffer_load_dwordx4 v[60:63], v11, s[52:55], s12 offen sc1
    s_nop 0
    s_waitcnt lgkmcnt(0)
    s_barrier
    v_mfma_f32_16x16x32_bf16 v[124:127], a[76:79], v[48:51], v[124:127]
    ds_read2st64_b32 v[80:81], v14 offset0:0 offset1:1
    ds_read2st64_b32 v[88:89], v14 offset0:8 offset1:9
    ds_read2st64_b32 v[96:97], v14 offset0:16 offset1:17
    v_mfma_f32_16x16x32_bf16 v[128:131], a[72:75], v[52:55], v[128:131]
    buffer_load_dwordx4 v[56:59], v10, s[52:55], s12 offen sc1
    ds_read2st64_b32 v[82:83], v14 offset0:2 offset1:3
    v_mfma_f32_16x16x32_bf16 v[120:123], a[72:75], v[48:51], v[120:123]
    ds_read2st64_b32 v[90:91], v14 offset0:10 offset1:11
    ds_read2st64_b32 v[98:99], v14 offset0:18 offset1:19
    ds_read2st64_b32 v[84:85], v14 offset0:4 offset1:5
    v_mfma_f32_16x16x32_bf16 v[116:119], a[68:71], v[52:55], v[116:119]
    v_readlane_b32 s13, v12, 26
    ds_read2st64_b32 v[92:93], v14 offset0:12 offset1:13
    ds_read2st64_b32 v[100:101], v14 offset0:20 offset1:21
    v_mfma_f32_16x16x32_bf16 v[108:111], a[68:71], v[48:51], v[108:111]
    s_waitcnt vmcnt(8)
    v_cmp_u_f32 vcc, v40, v44
    ds_read2st64_b32 v[86:87], v14 offset0:6 offset1:7
    v_mfma_f32_16x16x32_bf16 v[112:115], a[64:67], v[52:55], v[112:115]
    ds_read2st64_b32 v[94:95], v14 offset0:14 offset1:15
    ds_read2st64_b32 v[102:103], v14 offset0:22 offset1:23
    v_mfma_f32_16x16x32_bf16 v[104:107], a[64:67], v[48:51], v[104:107]
    s_cbranch_vccnz interleave_layers__ssm_conv_s4d__mixer_token_mlp__prompt_kernel_rt82
interleave_layers__ssm_conv_s4d__mixer_token_mlp__prompt_kernel_ok83:
    v_mfma_f32_16x16x32_bf16 v[132:135], a[92:95], v[44:47], v[132:135]
    buffer_load_dwordx4 v[52:55], v11, s[52:55], s13 offen sc1
    s_waitcnt lgkmcnt(9)
    v_add_f32_e64 v72, v80, v72
    v_mfma_f32_16x16x32_bf16 v[124:127], a[92:95], v[40:43], v[124:127]
    v_add_f32 v73, v81, v73
    v_add_f32 v88, v96, v88
    v_add_f32_e64 v89, v97, v89
    v_mfma_f32_16x16x32_bf16 v[128:131], a[88:91], v[44:47], v[128:131]
    buffer_load_dwordx4 v[48:51], v10, s[52:55], s13 offen sc1
    s_waitcnt lgkmcnt(6)
    v_add_f32 v74, v82, v74
    v_mfma_f32_16x16x32_bf16 v[120:123], a[88:91], v[40:43], v[120:123]
    v_add_f32 v75, v83, v75
    v_add_f32 v90, v98, v90
    v_mfma_f32_16x16x32_bf16 v[116:119], a[84:87], v[44:47], v[116:119]
    v_readlane_b32 s14, v12, 27
    v_add_f32 v91, v99, v91
    s_waitcnt lgkmcnt(3)
    v_add_f32_e64 v76, v84, v76
    v_mfma_f32_16x16x32_bf16 v[108:111], a[84:87], v[40:43], v[108:111]
    s_waitcnt vmcnt(8)
    v_cmp_u_f32 vcc, v32, v36
    v_mfma_f32_16x16x32_bf16 v[112:115], a[80:83], v[44:47], v[112:115]
    v_add_f32 v77, v85, v77
    v_add_f32 v92, v100, v92
    v_mfma_f32_16x16x32_bf16 v[104:107], a[80:83], v[40:43], v[104:107]
    s_cbranch_vccnz interleave_layers__ssm_conv_s4d__mixer_token_mlp__prompt_kernel_rt84
interleave_layers__ssm_conv_s4d__mixer_token_mlp__prompt_kernel_ok85:
    v_add_f32 v93, v101, v93
    s_waitcnt lgkmcnt(0)
    v_add_f32 v78, v86, v78
    v_mfma_f32_16x16x32_bf16 v[132:135], a[108:111], v[36:39], v[132:135]
    buffer_load_dwordx4 v[44:47], v11, s[52:55], s14 offen sc1
    v_add_f32_e64 v79, v87, v79
    v_mfma_f32_16x16x32_bf16 v[124:127], a[108:111], v[32:35], v[124:127]
    v_add_f32 v94, v102, v94
    v_add_f32 v95, v103, v95
    v_add_f32_e64 v72, v88, v72
    v_mfma_f32_16x16x32_bf16 v[128:131], a[104:107], v[36:39], v[128:131]
    buffer_load_dwordx4 v[40:43], v10, s[52:55], s14 offen sc1
    v_add_f32_e64 v73, v89, v73
    v_mfma_f32_16x16x32_bf16 v[120:123], a[104:107], v[32:35], v[120:123]
    v_add_f32 v74, v90, v74
    v_add_f32 v75, v91, v75
    v_add_f32_e64 v76, v92, v76
    v_mfma_f32_16x16x32_bf16 v[116:119], a[100:103], v[36:39], v[116:119]
    v_readlane_b32 s15, v12, 28
    v_add_f32 v77, v93, v77
    v_add_f32 v78, v94, v78
    v_mfma_f32_16x16x32_bf16 v[108:111], a[100:103], v[32:35], v[108:111]
    s_waitcnt vmcnt(8)
    v_cmp_u_f32 vcc, v24, v28
    v_add_f32_e64 v79, v95, v79
    v_mfma_f32_16x16x32_bf16 v[112:115], a[96:99], v[36:39], v[112:115]
    v_mul_f32 v80, v72, v72
    v_mul_f32 v81, v73, v73
    v_mfma_f32_16x16x32_bf16 v[104:107], a[96:99], v[32:35], v[104:107]
    s_cbranch_vccnz interleave_layers__ssm_conv_s4d__mixer_token_mlp__prompt_kernel_rt86
interleave_layers__ssm_conv_s4d__mixer_token_mlp__prompt_kernel_ok87:
    v_mul_f32 v82, v74, v74
    v_mul_f32_e64 v83, v75, v75
    v_mfma_f32_16x16x32_bf16 v[132:135], a[124:127], v[28:31], v[132:135]
    buffer_load_dwordx4 v[36:39], v11, s[52:55], s15 offen sc1
    v_mul_f32 v84, v76, v76
    v_mul_f32 v85, v77, v77
    v_mfma_f32_16x16x32_bf16 v[124:127], a[124:127], v[24:27], v[124:127]
    v_mul_f32 v86, v78, v78
    v_mul_f32 v87, v79, v79
    v_fma_f32 v80, v80, s82, v20
    v_mfma_f32_16x16x32_bf16 v[128:131], a[120:123], v[28:31], v[128:131]
    buffer_load_dwordx4 v[32:35], v10, s[52:55], s15 offen sc1
    v_fma_f32 v81, v81, s83, v21
    v_mfma_f32_16x16x32_bf16 v[120:123], a[120:123], v[24:27], v[120:123]
    v_fma_f32 v82, v82, s82, v20
    v_fma_f32 v83, v83, s83, v21
    v_fma_f32 v84, v84, s82, v20
    v_mfma_f32_16x16x32_bf16 v[116:119], a[116:119], v[28:31], v[116:119]
    v_readlane_b32 s70, v12, 29
    v_fma_f32 v85, v85, s83, v21
    v_fma_f32 v86, v86, s82, v20
    v_mfma_f32_16x16x32_bf16 v[108:111], a[116:119], v[24:27], v[108:111]
    s_waitcnt vmcnt(8)
    v_cmp_u_f32 vcc, v64, v68
    v_fma_f32 v87, v87, s83, v21
    v_mfma_f32_16x16x32_bf16 v[112:115], a[112:115], v[28:31], v[112:115]
    v_mul_f32 v80, v72, v80
    v_mul_f32 v81, v73, v81
    v_mfma_f32_16x16x32_bf16 v[104:107], a[112:115], v[24:27], v[104:107]
    s_cbranch_vccnz interleave_layers__ssm_conv_s4d__mixer_token_mlp__prompt_kernel_rt88
interleave_layers__ssm_conv_s4d__mixer_token_mlp__prompt_kernel_ok89:
    v_mul_f32 v82, v74, v82
    v_mul_f32_e64 v83, v75, v83
    v_mfma_f32_16x16x32_bf16 v[132:135], a[140:143], v[68:71], v[132:135]
    buffer_load_dwordx4 v[28:31], v11, s[52:55], s70 offen sc1
    v_mul_f32 v84, v76, v84
    v_mul_f32 v85, v77, v85
    v_mfma_f32_16x16x32_bf16 v[124:127], a[140:143], v[64:67], v[124:127]
    v_mul_f32 v86, v78, v86
    v_mul_f32 v87, v79, v87
    v_exp_f32_e64 v80, v80
    v_mfma_f32_16x16x32_bf16 v[128:131], a[136:139], v[68:71], v[128:131]
    buffer_load_dwordx4 v[24:27], v10, s[52:55], s70 offen sc1
    v_mfma_f32_16x16x32_bf16 v[120:123], a[136:139], v[64:67], v[120:123]
    v_exp_f32 v81, v81
    v_exp_f32 v82, v82
    v_mfma_f32_16x16x32_bf16 v[116:119], a[132:135], v[68:71], v[116:119]
    v_readlane_b32 s7, v12, 30
    v_exp_f32_e64 v83, v83
    v_mfma_f32_16x16x32_bf16 v[108:111], a[132:135], v[64:67], v[108:111]
    s_waitcnt vmcnt(8)
    v_cmp_u_f32 vcc, v56, v60
    v_mfma_f32_16x16x32_bf16 v[112:115], a[128:131], v[68:71], v[112:115]
    v_exp_f32_e64 v84, v84
    v_mfma_f32_16x16x32_bf16 v[104:107], a[128:131], v[64:67], v[104:107]
    s_cbranch_vccnz interleave_layers__ssm_conv_s4d__mixer_token_mlp__prompt_kernel_rt90
interleave_layers__ssm_conv_s4d__mixer_token_mlp__prompt_kernel_ok91:
    v_exp_f32 v85, v85
    v_mfma_f32_16x16x32_bf16 v[132:135], a[156:159], v[60:63], v[132:135]
    buffer_load_dwordx4 v[68:71], v11, s[52:55], s7 offen sc1
    v_exp_f32_e64 v86, v86
    v_mfma_f32_16x16x32_bf16 v[124:127], a[156:159], v[56:59], v[124:127]
    v_exp_f32 v87, v87
    v_add_f32 v80, 1.0, v80
    v_mfma_f32_16x16x32_bf16 v[128:131], a[152:155], v[60:63], v[128:131]
    buffer_load_dwordx4 v[64:67], v10, s[52:55], s7 offen sc1
    v_add_f32_e64 v81, 1.0, v81
    v_mfma_f32_16x16x32_bf16 v[120:123], a[152:155], v[56:59], v[120:123]
    v_add_f32 v82, 1.0, v82
    v_add_f32 v83, 1.0, v83
    v_add_f32_e64 v84, 1.0, v84
    v_mfma_f32_16x16x32_bf16 v[116:119], a[148:151], v[60:63], v[116:119]
    v_readlane_b32 s12, v12, 31
    v_add_f32 v85, 1.0, v85
    v_add_f32 v86, 1.0, v86
    v_mfma_f32_16x16x32_bf16 v[108:111], a[148:151], v[56:59], v[108:111]
    s_waitcnt vmcnt(8)
    v_cmp_u_f32 vcc, v48, v52
    v_add_f32_e64 v87, 1.0, v87
    v_mfma_f32_16x16x32_bf16 v[112:115], a[144:147], v[60:63], v[112:115]
    v_rcp_f32_e64 v80, v80
    v_mfma_f32_16x16x32_bf16 v[104:107], a[144:147], v[56:59], v[104:107]
    s_cbranch_vccnz interleave_layers__ssm_conv_s4d__mixer_token_mlp__prompt_kernel_rt92
interleave_layers__ssm_conv_s4d__mixer_token_mlp__prompt_kernel_ok93:
    v_rcp_f32 v81, v81
    v_mfma_f32_16x16x32_bf16 v[132:135], a[172:175], v[52:55], v[132:135]
    buffer_load_dwordx4 v[60:63], v11, s[52:55], s12 offen sc1
    v_rcp_f32_e64 v82, v82
    v_mfma_f32_16x16x32_bf16 v[124:127], a[172:175], v[48:51], v[124:127]
    v_rcp_f32 v83, v83
    v_rcp_f32 v84, v84
    v_mfma_f32_16x16x32_bf16 v[128:131], a[168:171], v[52:55], v[128:131]
    buffer_load_dwordx4 v[56:59], v10, s[52:55], s12 offen sc1
    v_mfma_f32_16x16x32_bf16 v[120:123], a[168:171], v[48:51], v[120:123]
    v_rcp_f32 v85, v85
    v_rcp_f32 v86, v86
    v_mfma_f32_16x16x32_bf16 v[116:119], a[164:167], v[52:55], v[116:119]
    v_rcp_f32_e64 v87, v87
    v_mfma_f32_16x16x32_bf16 v[108:111], a[164:167], v[48:51], v[108:111]
    s_waitcnt vmcnt(8)
    v_cmp_u_f32 vcc, v40, v44
    v_mul_f32_e64 v72, v80, v72
    v_mfma_f32_16x16x32_bf16 v[112:115], a[160:163], v[52:55], v[112:115]
    v_mul_f32 v73, v81, v73
    v_mul_f32 v74, v82, v74
    v_mfma_f32_16x16x32_bf16 v[104:107], a[160:163], v[48:51], v[104:107]
    s_cbranch_vccnz interleave_layers__ssm_conv_s4d__mixer_token_mlp__prompt_kernel_rt94
interleave_layers__ssm_conv_s4d__mixer_token_mlp__prompt_kernel_ok95:
    v_mul_f32 v75, v83, v75
    v_mul_f32_e64 v76, v84, v76
    v_mfma_f32_16x16x32_bf16 v[132:135], a[188:191], v[44:47], v[132:135]
    v_mul_f32 v77, v85, v77
    v_mul_f32 v78, v86, v78
    v_mul_f32_e64 v79, v87, v79
    v_mfma_f32_16x16x32_bf16 v[124:127], a[188:191], v[40:43], v[124:127]
    v_cvt_pk_bf16_f32 v88, v72, v73
    v_cvt_pk_bf16_f32 v89, v74, v75
    v_cvt_pk_bf16_f32 v90, v76, v77
    v_mfma_f32_16x16x32_bf16 v[128:131], a[184:187], v[44:47], v[128:131]
    v_cvt_pk_bf16_f32 v91, v78, v79
    v_mfma_f32_16x16x32_bf16 v[120:123], a[184:187], v[40:43], v[120:123]
    s_bfe_u32 s48, s66, 0x4001c
    v_mfma_f32_16x16x32_bf16 v[116:119], a[180:183], v[44:47], v[116:119]
    s_lshl_b32 s48, s48, 17
    v_mfma_f32_16x16x32_bf16 v[108:111], a[180:183], v[40:43], v[108:111]
    s_waitcnt vmcnt(6)
    v_cmp_u_f32_e64 vcc, v32, v36
    v_mfma_f32_16x16x32_bf16 v[112:115], a[176:179], v[44:47], v[112:115]
    s_add_u32 s48, s48, s6
    v_mfma_f32_16x16x32_bf16 v[104:107], a[176:179], v[40:43], v[104:107]
    s_cbranch_vccnz interleave_layers__ssm_conv_s4d__mixer_token_mlp__prompt_kernel_rt96
interleave_layers__ssm_conv_s4d__mixer_token_mlp__prompt_kernel_ok97:
    s_add_u32 m0, s4, 65536
    v_mfma_f32_16x16x32_bf16 v[132:135], a[204:207], v[36:39], v[132:135]
    buffer_store_dwordx4 v[88:91], v10, s[52:55], s80 offen sc1
    v_mfma_f32_16x16x32_bf16 v[124:127], a[204:207], v[32:35], v[124:127]
    buffer_load_dwordx4 v2, s[60:63], s48 offen offset:0 lds
    v_mfma_f32_16x16x32_bf16 v[128:131], a[200:203], v[36:39], v[128:131]
    v_mfma_f32_16x16x32_bf16 v[120:123], a[200:203], v[32:35], v[120:123]
    v_mfma_f32_16x16x32_bf16 v[116:119], a[196:199], v[36:39], v[116:119]
    v_mfma_f32_16x16x32_bf16 v[108:111], a[196:199], v[32:35], v[108:111]
    s_waitcnt vmcnt(6)
    v_cmp_u_f32 vcc, v24, v28
    v_mfma_f32_16x16x32_bf16 v[112:115], a[192:195], v[36:39], v[112:115]
    buffer_load_dwordx4 v3, s[60:63], s48 offen offset:1024 lds
    v_mfma_f32_16x16x32_bf16 v[104:107], a[192:195], v[32:35], v[104:107]
    s_nop 0
    s_cbranch_vccnz interleave_layers__ssm_conv_s4d__mixer_token_mlp__prompt_kernel_rt98
interleave_layers__ssm_conv_s4d__mixer_token_mlp__prompt_kernel_ok99:
    v_mfma_f32_16x16x32_bf16 v[132:135], a[220:223], v[28:31], v[132:135]
    v_mfma_f32_16x16x32_bf16 v[124:127], a[220:223], v[24:27], v[124:127]
    v_mfma_f32_16x16x32_bf16 v[128:131], a[216:219], v[28:31], v[128:131]
    buffer_load_dwordx4 v4, s[60:63], s48 offen offset:2048 lds
    v_mfma_f32_16x16x32_bf16 v[120:123], a[216:219], v[24:27], v[120:123]
    v_mfma_f32_16x16x32_bf16 v[116:119], a[212:215], v[28:31], v[116:119]
    v_mfma_f32_16x16x32_bf16 v[108:111], a[212:215], v[24:27], v[108:111]
    s_waitcnt vmcnt(6)
    v_cmp_u_f32 vcc, v64, v68
    v_mfma_f32_16x16x32_bf16 v[112:115], a[208:211], v[28:31], v[112:115]
    buffer_load_dwordx4 v5, s[60:63], s48 offen offset:3072 lds
    v_mfma_f32_16x16x32_bf16 v[104:107], a[208:211], v[24:27], v[104:107]
    s_cbranch_vccnz interleave_layers__ssm_conv_s4d__mixer_token_mlp__prompt_kernel_rt100
interleave_layers__ssm_conv_s4d__mixer_token_mlp__prompt_kernel_ok101:
    s_bfe_u32 s48, s67, 0x40000
    v_mfma_f32_16x16x32_bf16 v[132:135], a[236:239], v[68:71], v[132:135]
    s_lshl_b32 s48, s48, 17
    v_mfma_f32_16x16x32_bf16 v[124:127], a[236:239], v[64:67], v[124:127]
    s_nop 0
    s_add_u32 s48, s48, s6
    v_mfma_f32_16x16x32_bf16 v[128:131], a[232:235], v[68:71], v[128:131]
    s_add_u32 m0, s4, 81920
    v_mfma_f32_16x16x32_bf16 v[120:123], a[232:235], v[64:67], v[120:123]
    buffer_load_dwordx4 v2, s[60:63], s48 offen offset:0 lds
    v_mfma_f32_16x16x32_bf16 v[116:119], a[228:231], v[68:71], v[116:119]
    v_mfma_f32_16x16x32_bf16 v[108:111], a[228:231], v[64:67], v[108:111]
    s_waitcnt vmcnt(6)
    v_cmp_u_f32 vcc, v56, v60
    v_mfma_f32_16x16x32_bf16 v[112:115], a[224:227], v[68:71], v[112:115]
    v_mfma_f32_16x16x32_bf16 v[104:107], a[224:227], v[64:67], v[104:107]
    s_nop 0
    s_cbranch_vccnz interleave_layers__ssm_conv_s4d__mixer_token_mlp__prompt_kernel_rt102
interleave_layers__ssm_conv_s4d__mixer_token_mlp__prompt_kernel_ok103:
    buffer_load_dwordx4 v3, s[60:63], s48 offen offset:1024 lds
    buffer_load_dwordx4 v4, s[60:63], s48 offen offset:2048 lds
    buffer_load_dwordx4 v5, s[60:63], s48 offen offset:3072 lds
    v_mfma_f32_16x16x32_bf16 v[132:135], a[252:255], v[60:63], v[132:135]
    s_nop 0
    s_barrier
    v_mfma_f32_16x16x32_bf16 v[124:127], a[252:255], v[56:59], v[124:127]
    v_mfma_f32_16x16x32_bf16 v[128:131], a[248:251], v[60:63], v[128:131]
    v_mfma_f32_16x16x32_bf16 v[120:123], a[248:251], v[56:59], v[120:123]
    v_mfma_f32_16x16x32_bf16 v[116:119], a[244:247], v[60:63], v[116:119]
    s_add_u32 m0, s79, 4096
    v_mfma_f32_16x16x32_bf16 v[112:115], a[240:243], v[60:63], v[112:115]
    ds_write_addtid_b32 v128 offset:0
    ds_write_addtid_b32 v129 offset:256
    v_mfma_f32_16x16x32_bf16 v[108:111], a[244:247], v[56:59], v[108:111]
    ds_write_addtid_b32 v130 offset:512
    ds_write_addtid_b32 v131 offset:768
    v_mfma_f32_16x16x32_bf16 v[104:107], a[240:243], v[56:59], v[104:107]
    ds_write_addtid_b32 v132 offset:1024
    ds_write_addtid_b32 v133 offset:1280
    ds_write_addtid_b32 v134 offset:1536
    ds_write_addtid_b32 v135 offset:1792
    s_add_u32 m0, s78, 2048
    s_nop 0
    s_nop 0
    ds_write_addtid_b32 v120 offset:0
    ds_write_addtid_b32 v121 offset:256
    ds_write_addtid_b32 v122 offset:512
    ds_write_addtid_b32 v123 offset:768
    ds_write_addtid_b32 v124 offset:1024
    ds_write_addtid_b32 v125 offset:1280
    ds_write_addtid_b32 v126 offset:1536
    ds_write_addtid_b32 v127 offset:1792
    s_add_u32 m0, s77, 0
    s_nop 0
    ds_write_addtid_b32 v112 offset:0
    ds_write_addtid_b32 v113 offset:256
    ds_write_addtid_b32 v114 offset:512
    ds_write_addtid_b32 v115 offset:768
    ds_write_addtid_b32 v116 offset:1024
    ds_write_addtid_b32 v117 offset:1280
    ds_write_addtid_b32 v118 offset:1536
    ds_write_addtid_b32 v119 offset:1792
    s_waitcnt lgkmcnt(0)
    s_barrier
    ds_read2st64_b32 v[112:113], v14 offset0:0 offset1:1
    ds_read2st64_b32 v[120:121], v14 offset0:8 offset1:9
    ds_read2st64_b32 v[128:129], v14 offset0:16 offset1:17
    ds_read2st64_b32 v[114:115], v14 offset0:2 offset1:3
    ds_read2st64_b32 v[122:123], v14 offset0:10 offset1:11
    ds_read2st64_b32 v[130:131], v14 offset0:18 offset1:19
    ds_read2st64_b32 v[116:117], v14 offset0:4 offset1:5
    ds_read2st64_b32 v[124:125], v14 offset0:12 offset1:13
    ds_read2st64_b32 v[132:133], v14 offset0:20 offset1:21
    ds_read2st64_b32 v[118:119], v14 offset0:6 offset1:7
    ds_read2st64_b32 v[126:127], v14 offset0:14 offset1:15
    ds_read2st64_b32 v[134:135], v14 offset0:22 offset1:23
    s_bfe_u32 s48, s67, 0x40004
    s_lshl_b32 s48, s48, 17
    s_add_u32 s48, s48, s6
    s_add_u32 m0, s4, 98304
    s_waitcnt lgkmcnt(9)
    v_pk_add_f32 v[104:105], v[104:105], v[112:113]
    v_pk_add_f32 v[120:121], v[120:121], v[128:129]
    s_waitcnt lgkmcnt(6)
    v_pk_add_f32 v[106:107], v[106:107], v[114:115]
    v_pk_add_f32 v[122:123], v[122:123], v[130:131]
    s_waitcnt lgkmcnt(3)
    v_pk_add_f32 v[108:109], v[108:109], v[116:117]
    v_pk_add_f32 v[124:125], v[124:125], v[132:133]
    s_waitcnt lgkmcnt(0)
    v_pk_add_f32 v[110:111], v[110:111], v[118:119]
    v_pk_add_f32 v[126:127], v[126:127], v[134:135]
    v_pk_add_f32 v[104:105], v[104:105], v[120:121]
    v_pk_add_f32 v[106:107], v[106:107], v[122:123]
    buffer_load_dwordx4 v2, s[60:63], s48 offen offset:0 lds
    v_pk_add_f32 v[108:109], v[108:109], v[124:125]
    v_pk_add_f32 v[110:111], v[110:111], v[126:127]
    v_pk_mul_f32 v[112:113], v[104:105], v[104:105]
    v_pk_mul_f32 v[114:115], v[106:107], v[106:107]
    v_pk_mul_f32 v[116:117], v[108:109], v[108:109]
    v_pk_mul_f32 v[118:119], v[110:111], v[110:111]
    v_pk_fma_f32 v[112:113], v[112:113], s[82:83], v[20:21]
    v_pk_fma_f32 v[114:115], v[114:115], s[82:83], v[20:21]
    v_pk_fma_f32 v[116:117], v[116:117], s[82:83], v[20:21]
    v_pk_fma_f32 v[118:119], v[118:119], s[82:83], v[20:21]
    v_pk_mul_f32 v[112:113], v[112:113], v[104:105]
    v_pk_mul_f32 v[114:115], v[114:115], v[106:107]
    v_pk_mul_f32 v[116:117], v[116:117], v[108:109]
    v_pk_mul_f32 v[118:119], v[118:119], v[110:111]
    v_exp_f32 v112, v112
    v_exp_f32 v113, v113
    v_exp_f32 v114, v114
    v_exp_f32 v115, v115
    v_exp_f32 v116, v116
    v_exp_f32 v117, v117
    buffer_load_dwordx4 v3, s[60:63], s48 offen offset:1024 lds
    v_exp_f32 v118, v118
    v_exp_f32 v119, v119
    v_pk_add_f32 v[112:113], v[112:113], 1.0 op_sel_hi:[1,0]
    v_pk_add_f32 v[114:115], v[114:115], 1.0 op_sel_hi:[1,0]
    v_pk_add_f32 v[116:117], v[116:117], 1.0 op_sel_hi:[1,0]
    v_pk_add_f32 v[118:119], v[118:119], 1.0 op_sel_hi:[1,0]
    v_rcp_f32 v112, v112
    v_rcp_f32 v113, v113
    v_rcp_f32 v114, v114
    v_rcp_f32 v115, v115
    v_rcp_f32 v116, v116
    v_rcp_f32 v117, v117
    v_rcp_f32 v118, v118
    v_rcp_f32 v119, v119
    v_pk_mul_f32 v[104:105], v[104:105], v[112:113]
    v_pk_mul_f32 v[106:107], v[106:107], v[114:115]
    v_pk_mul_f32 v[108:109], v[108:109], v[116:117]
    v_pk_mul_f32 v[110:111], v[110:111], v[118:119]
    v_cvt_pk_bf16_f32 v120, v104, v105
    v_cvt_pk_bf16_f32 v121, v106, v107
    buffer_load_dwordx4 v4, s[60:63], s48 offen offset:2048 lds
    v_cvt_pk_bf16_f32 v122, v108, v109
    v_cvt_pk_bf16_f32 v123, v110, v111
    buffer_store_dwordx4 v[120:123], v10, s[52:55], s81 offen sc1
    buffer_load_dwordx4 v5, s[60:63], s48 offen offset:3072 lds
    s_bfe_u32 s48, s67, 0x40008
    s_lshl_b32 s48, s48, 17
    s_add_u32 s48, s48, s6
    s_add_u32 m0, s4, 32768
    s_nop 0
    buffer_load_dwordx4 v2, s[60:63], s48 offen offset:0 lds
    buffer_load_dwordx4 v3, s[60:63], s48 offen offset:1024 lds
    buffer_load_dwordx4 v4, s[60:63], s48 offen offset:2048 lds
    buffer_load_dwordx4 v5, s[60:63], s48 offen offset:3072 lds
    s_bfe_u32 s48, s67, 0x4000c
    s_lshl_b32 s48, s48, 17
    s_add_u32 s48, s48, s6
    s_add_u32 m0, s4, 0
    s_nop 0
    buffer_load_dwordx4 v2, s[60:63], s48 offen offset:0 lds
    buffer_load_dwordx4 v3, s[60:63], s48 offen offset:1024 lds
    buffer_load_dwordx4 v4, s[60:63], s48 offen offset:2048 lds
    buffer_load_dwordx4 v5, s[60:63], s48 offen offset:3072 lds
    s_bfe_u32 s48, s67, 0x40010
    s_lshl_b32 s48, s48, 17
    s_add_u32 s48, s48, s6
    s_add_u32 m0, s4, 16384
    s_nop 0
    buffer_load_dwordx4 v2, s[60:63], s48 offen offset:0 lds
    buffer_load_dwordx4 v3, s[60:63], s48 offen offset:1024 lds
    buffer_load_dwordx4 v4, s[60:63], s48 offen offset:2048 lds
    buffer_load_dwordx4 v5, s[60:63], s48 offen offset:3072 lds
interleave_layers__ssm_conv_s4d__mixer_token_mlp__prompt_kernel_g1skip33:
    s_lshl_b32 s39, s37, 1
    s_lshr_b32 s40, s3, 1
    s_add_u32 s39, s39, s40
    s_mul_i32 s39, s39, 33280
    s_lshl_b32 s40, s35, 9
    s_add_u32 s39, s39, s40
    s_add_u32 s80, s39, 9437184
    s_add_u32 s81, s80, 4096
    s_bfe_u32 s48, s67, 0x40014
    s_lshl_b32 s48, s48, 17
    s_add_u32 s48, s48, s6
    s_add_u32 m0, s4, 49152
    s_nop 0
    buffer_load_dwordx4 v2, s[60:63], s48 offen offset:0 lds
    buffer_load_dwordx4 v3, s[60:63], s48 offen offset:1024 lds
    buffer_load_dwordx4 v4, s[60:63], s48 offen offset:2048 lds
    buffer_load_dwordx4 v5, s[60:63], s48 offen offset:3072 lds
    v_readlane_b32 s7, v12, 32
    v_readlane_b32 s12, v12, 39
    v_readlane_b32 s13, v12, 33
    v_readlane_b32 s14, v12, 40
    v_readlane_b32 s15, v12, 34
    v_readlane_b32 s70, v12, 41
    buffer_load_dwordx4 v[68:71], v11, s[52:55], s7 offen sc1
    buffer_load_dwordx4 v[64:67], v10, s[52:55], s7 offen sc1
    buffer_load_dwordx4 v[52:55], v11, s[52:55], s12 offen sc1
    buffer_load_dwordx4 v[48:51], v10, s[52:55], s12 offen sc1
    buffer_load_dwordx4 v[44:47], v11, s[52:55], s13 offen sc1
    buffer_load_dwordx4 v[40:43], v10, s[52:55], s13 offen sc1
    buffer_load_dwordx4 v[36:39], v11, s[52:55], s14 offen sc1
    buffer_load_dwordx4 v[32:35], v10, s[52:55], s14 offen sc1
    buffer_load_dwordx4 v[28:31], v11, s[52:55], s15 offen sc1
    buffer_load_dwordx4 v[24:27], v10, s[52:55], s15 offen sc1
    s_waitcnt vmcnt(10)
    s_add_u32 s8, s46, 9437184
    s_add_u32 s9, s8, 4096
    s_mov_b32 s43, 0
    s_waitcnt vmcnt(8)
    v_cmp_u_f32_e64 vcc, v64, v68
    s_cbranch_vccnz interleave_layers__ssm_conv_s4d__mixer_token_mlp__prompt_kernel_rt112
interleave_layers__ssm_conv_s4d__mixer_token_mlp__prompt_kernel_ok113:
    v_mfma_f32_16x16x32_bf16 v[100:103], v[156:159], v[68:71], 0
    ds_read_b64_tr_b16 v[60:61], v9 offset:512
    buffer_load_dwordx4 v[140:143], v11, s[52:55], s70 offen sc1
    v_mfma_f32_16x16x32_bf16 v[92:95], v[156:159], v[64:67], 0
    ds_read_b64_tr_b16 v[62:63], v9 offset:2560
    v_mfma_f32_16x16x32_bf16 v[96:99], v[152:155], v[68:71], 0
    ds_read_b64_tr_b16 v[56:57], v8 offset:512
    buffer_load_dwordx4 v[136:139], v10, s[52:55], s70 offen sc1
    v_mfma_f32_16x16x32_bf16 v[88:91], v[152:155], v[64:67], 0
    ds_read_b64_tr_b16 v[58:59], v8 offset:2560
    v_mfma_f32_16x16x32_bf16 v[84:87], v[148:151], v[68:71], 0
    ds_read_b64_tr_b16 v[20:21], v9 offset:0
    v_readlane_b32 s7, v12, 35
    v_mfma_f32_16x16x32_bf16 v[76:79], v[148:151], v[64:67], 0
    ds_read_b64_tr_b16 v[22:23], v9 offset:2048
    s_waitcnt vmcnt(8)
    v_cmp_u_f32 vcc, v48, v52
    v_mfma_f32_16x16x32_bf16 v[80:83], v[144:147], v[68:71], 0
    ds_read_b64_tr_b16 v[16:17], v8 offset:0
    v_mfma_f32_16x16x32_bf16 v[72:75], v[144:147], v[64:67], 0
    ds_read_b64_tr_b16 v[18:19], v8 offset:2048
    s_cbranch_vccnz interleave_layers__ssm_conv_s4d__mixer_token_mlp__prompt_kernel_rt114
interleave_layers__ssm_conv_s4d__mixer_token_mlp__prompt_kernel_ok115:
    s_waitcnt lgkmcnt(4)
    v_mfma_f32_16x16x32_bf16 v[100:103], v[60:63], v[52:55], v[100:103]
    buffer_load_dwordx4 v[68:71], v11, s[52:55], s7 offen sc1
    v_mfma_f32_16x16x32_bf16 v[92:95], v[60:63], v[48:51], v[92:95]
    v_mfma_f32_16x16x32_bf16 v[96:99], v[56:59], v[52:55], v[96:99]
    buffer_load_dwordx4 v[64:67], v10, s[52:55], s7 offen sc1
    v_mfma_f32_16x16x32_bf16 v[88:91], v[56:59], v[48:51], v[88:91]
    s_waitcnt lgkmcnt(0)
    v_mfma_f32_16x16x32_bf16 v[84:87], v[20:23], v[52:55], v[84:87]
    v_readlane_b32 s12, v12, 42
    v_mfma_f32_16x16x32_bf16 v[76:79], v[20:23], v[48:51], v[76:79]
    s_waitcnt vmcnt(8)
    v_cmp_u_f32_e64 vcc, v40, v44
    v_mfma_f32_16x16x32_bf16 v[80:83], v[16:19], v[52:55], v[80:83]
    v_mfma_f32_16x16x32_bf16 v[72:75], v[16:19], v[48:51], v[72:75]
    s_nop 0
    s_cbranch_vccnz interleave_layers__ssm_conv_s4d__mixer_token_mlp__prompt_kernel_rt116
interleave_layers__ssm_conv_s4d__mixer_token_mlp__prompt_kernel_ok117:
    v_mfma_f32_16x16x32_bf16 v[100:103], v[172:175], v[44:47], v[100:103]
    ds_read_b64_tr_b16 v[60:61], v9 offset:16896
    buffer_load_dwordx4 v[52:55], v11, s[52:55], s12 offen sc1
    v_mfma_f32_16x16x32_bf16 v[92:95], v[172:175], v[40:43], v[92:95]
    ds_read_b64_tr_b16 v[62:63], v9 offset:18944
    v_mfma_f32_16x16x32_bf16 v[96:99], v[168:171], v[44:47], v[96:99]
    ds_read_b64_tr_b16 v[56:57], v8 offset:16896
    buffer_load_dwordx4 v[48:51], v10, s[52:55], s12 offen sc1
    v_mfma_f32_16x16x32_bf16 v[88:91], v[168:171], v[40:43], v[88:91]
    ds_read_b64_tr_b16 v[58:59], v8 offset:18944
    v_mfma_f32_16x16x32_bf16 v[84:87], v[164:167], v[44:47], v[84:87]
    ds_read_b64_tr_b16 v[20:21], v9 offset:16384
    v_readlane_b32 s13, v12, 36
    v_mfma_f32_16x16x32_bf16 v[76:79], v[164:167], v[40:43], v[76:79]
    ds_read_b64_tr_b16 v[22:23], v9 offset:18432
    s_waitcnt vmcnt(8)
    v_cmp_u_f32 vcc, v32, v36
    v_mfma_f32_16x16x32_bf16 v[80:83], v[160:163], v[44:47], v[80:83]
    ds_read_b64_tr_b16 v[16:17], v8 offset:16384
    v_mfma_f32_16x16x32_bf16 v[72:75], v[160:163], v[40:43], v[72:75]
    ds_read_b64_tr_b16 v[18:19], v8 offset:18432
    s_cbranch_vccnz interleave_layers__ssm_conv_s4d__mixer_token_mlp__prompt_kernel_rt118
interleave_layers__ssm_conv_s4d__mixer_token_mlp__prompt_kernel_ok119:
    s_waitcnt lgkmcnt(4)
    v_mfma_f32_16x16x32_bf16 v[100:103], v[60:63], v[36:39], v[100:103]
    buffer_load_dwordx4 v[44:47], v11, s[52:55], s13 offen sc1
    v_mfma_f32_16x16x32_bf16 v[92:95], v[60:63], v[32:35], v[92:95]
    v_mfma_f32_16x16x32_bf16 v[96:99], v[56:59], v[36:39], v[96:99]
    buffer_load_dwordx4 v[40:43], v10, s[52:55], s13 offen sc1
    v_mfma_f32_16x16x32_bf16 v[88:91], v[56:59], v[32:35], v[88:91]
    s_waitcnt lgkmcnt(0)
    v_mfma_f32_16x16x32_bf16 v[84:87], v[20:23], v[36:39], v[84:87]
    v_readlane_b32 s14, v12, 43
    v_mfma_f32_16x16x32_bf16 v[76:79], v[20:23], v[32:35], v[76:79]
    s_waitcnt vmcnt(8)
    v_cmp_u_f32_e64 vcc, v24, v28
    v_mfma_f32_16x16x32_bf16 v[80:83], v[16:19], v[36:39], v[80:83]
    v_mfma_f32_16x16x32_bf16 v[72:75], v[16:19], v[32:35], v[72:75]
    s_nop 0
    s_cbranch_vccnz interleave_layers__ssm_conv_s4d__mixer_token_mlp__prompt_kernel_rt120
interleave_layers__ssm_conv_s4d__mixer_token_mlp__prompt_kernel_ok121:
    v_mfma_f32_16x16x32_bf16 v[100:103], v[188:191], v[28:31], v[100:103]
    ds_read_b64_tr_b16 v[60:61], v9 offset:33280
    buffer_load_dwordx4 v[36:39], v11, s[52:55], s14 offen sc1
    v_mfma_f32_16x16x32_bf16 v[92:95], v[188:191], v[24:27], v[92:95]
    ds_read_b64_tr_b16 v[62:63], v9 offset:35328
    v_mfma_f32_16x16x32_bf16 v[96:99], v[184:187], v[28:31], v[96:99]
    ds_read_b64_tr_b16 v[56:57], v8 offset:33280
    buffer_load_dwordx4 v[32:35], v10, s[52:55], s14 offen sc1
    v_mfma_f32_16x16x32_bf16 v[88:91], v[184:187], v[24:27], v[88:91]
    ds_read_b64_tr_b16 v[58:59], v8 offset:35328
    v_mfma_f32_16x16x32_bf16 v[84:87], v[180:183], v[28:31], v[84:87]
    ds_read_b64_tr_b16 v[20:21], v9 offset:32768
    v_readlane_b32 s15, v12, 37
    v_mfma_f32_16x16x32_bf16 v[76:79], v[180:183], v[24:27], v[76:79]
    ds_read_b64_tr_b16 v[22:23], v9 offset:34816
    s_waitcnt vmcnt(8)
    v_cmp_u_f32 vcc, v136, v140
    v_mfma_f32_16x16x32_bf16 v[80:83], v[176:179], v[28:31], v[80:83]
    ds_read_b64_tr_b16 v[16:17], v8 offset:32768
    v_mfma_f32_16x16x32_bf16 v[72:75], v[176:179], v[24:27], v[72:75]
    ds_read_b64_tr_b16 v[18:19], v8 offset:34816
    s_cbranch_vccnz interleave_layers__ssm_conv_s4d__mixer_token_mlp__prompt_kernel_rt122
interleave_layers__ssm_conv_s4d__mixer_token_mlp__prompt_kernel_ok123:
    s_waitcnt lgkmcnt(4)
    v_mfma_f32_16x16x32_bf16 v[100:103], v[60:63], v[140:143], v[100:103]
    buffer_load_dwordx4 v[28:31], v11, s[52:55], s15 offen sc1
    v_mfma_f32_16x16x32_bf16 v[92:95], v[60:63], v[136:139], v[92:95]
    v_mfma_f32_16x16x32_bf16 v[96:99], v[56:59], v[140:143], v[96:99]
    buffer_load_dwordx4 v[24:27], v10, s[52:55], s15 offen sc1
    v_mfma_f32_16x16x32_bf16 v[88:91], v[56:59], v[136:139], v[88:91]
    s_waitcnt lgkmcnt(0)
    v_mfma_f32_16x16x32_bf16 v[84:87], v[20:23], v[140:143], v[84:87]
    v_readlane_b32 s70, v12, 44
    v_mfma_f32_16x16x32_bf16 v[76:79], v[20:23], v[136:139], v[76:79]
    s_waitcnt vmcnt(8)
    v_cmp_u_f32_e64 vcc, v64, v68
    v_mfma_f32_16x16x32_bf16 v[80:83], v[16:19], v[140:143], v[80:83]
    v_mfma_f32_16x16x32_bf16 v[72:75], v[16:19], v[136:139], v[72:75]
    s_nop 0
    s_cbranch_vccnz interleave_layers__ssm_conv_s4d__mixer_token_mlp__prompt_kernel_rt124
interleave_layers__ssm_conv_s4d__mixer_token_mlp__prompt_kernel_ok125:
    v_mfma_f32_16x16x32_bf16 v[100:103], v[204:207], v[68:71], v[100:103]
    ds_read_b64_tr_b16 v[60:61], v7 offset:33280
    buffer_load_dwordx4 v[140:143], v11, s[52:55], s70 offen sc1
    v_mfma_f32_16x16x32_bf16 v[92:95], v[204:207], v[64:67], v[92:95]
    ds_read_b64_tr_b16 v[62:63], v7 offset:35328
    v_mfma_f32_16x16x32_bf16 v[96:99], v[200:203], v[68:71], v[96:99]
    ds_read_b64_tr_b16 v[56:57], v6 offset:33280
    buffer_load_dwordx4 v[136:139], v10, s[52:55], s70 offen sc1
    v_mfma_f32_16x16x32_bf16 v[88:91], v[200:203], v[64:67], v[88:91]
    ds_read_b64_tr_b16 v[58:59], v6 offset:35328
    v_mfma_f32_16x16x32_bf16 v[84:87], v[196:199], v[68:71], v[84:87]
    ds_read_b64_tr_b16 v[20:21], v7 offset:32768
    v_readlane_b32 s7, v12, 38
    v_mfma_f32_16x16x32_bf16 v[76:79], v[196:199], v[64:67], v[76:79]
    ds_read_b64_tr_b16 v[22:23], v7 offset:34816
    s_waitcnt vmcnt(8)
    v_cmp_u_f32 vcc, v48, v52
    v_mfma_f32_16x16x32_bf16 v[80:83], v[192:195], v[68:71], v[80:83]
    ds_read_b64_tr_b16 v[16:17], v6 offset:32768
    v_mfma_f32_16x16x32_bf16 v[72:75], v[192:195], v[64:67], v[72:75]
    ds_read_b64_tr_b16 v[18:19], v6 offset:34816
    s_cbranch_vccnz interleave_layers__ssm_conv_s4d__mixer_token_mlp__prompt_kernel_rt126
interleave_layers__ssm_conv_s4d__mixer_token_mlp__prompt_kernel_ok127:
    s_waitcnt lgkmcnt(4)
    v_mfma_f32_16x16x32_bf16 v[100:103], v[60:63], v[52:55], v[100:103]
    buffer_load_dwordx4 v[68:71], v11, s[52:55], s7 offen sc1
    v_mfma_f32_16x16x32_bf16 v[92:95], v[60:63], v[48:51], v[92:95]
    v_mfma_f32_16x16x32_bf16 v[96:99], v[56:59], v[52:55], v[96:99]
    buffer_load_dwordx4 v[64:67], v10, s[52:55], s7 offen sc1
    v_mfma_f32_16x16x32_bf16 v[88:91], v[56:59], v[48:51], v[88:91]
    s_waitcnt lgkmcnt(0)
    v_mfma_f32_16x16x32_bf16 v[84:87], v[20:23], v[52:55], v[84:87]
    v_readlane_b32 s12, v12, 45
    v_mfma_f32_16x16x32_bf16 v[76:79], v[20:23], v[48:51], v[76:79]
    s_waitcnt vmcnt(8)
    v_cmp_u_f32_e64 vcc, v40, v44
    v_mfma_f32_16x16x32_bf16 v[80:83], v[16:19], v[52:55], v[80:83]
    v_mfma_f32_16x16x32_bf16 v[72:75], v[16:19], v[48:51], v[72:75]
    s_nop 0
    s_cbranch_vccnz interleave_layers__ssm_conv_s4d__mixer_token_mlp__prompt_kernel_rt128
interleave_layers__ssm_conv_s4d__mixer_token_mlp__prompt_kernel_ok129:
    v_mfma_f32_16x16x32_bf16 v[100:103], v[220:223], v[44:47], v[100:103]
    ds_read_b64_tr_b16 v[60:61], v7 offset:512
    buffer_load_dwordx4 v[52:55], v11, s[52:55], s12 offen sc1
    v_mfma_f32_16x16x32_bf16 v[92:95], v[220:223], v[40:43], v[92:95]
    ds_read_b64_tr_b16 v[62:63], v7 offset:2560
    v_mfma_f32_16x16x32_bf16 v[96:99], v[216:219], v[44:47], v[96:99]
    ds_read_b64_tr_b16 v[56:57], v6 offset:512
    buffer_load_dwordx4 v[48:51], v10, s[52:55], s12 offen sc1
    v_mfma_f32_16x16x32_bf16 v[88:91], v[216:219], v[40:43], v[88:91]
    ds_read_b64_tr_b16 v[58:59], v6 offset:2560
    v_mfma_f32_16x16x32_bf16 v[84:87], v[212:215], v[44:47], v[84:87]
    ds_read_b64_tr_b16 v[20:21], v7 offset:0
    v_readlane_b32 s13, v12, 48
    v_mfma_f32_16x16x32_bf16 v[76:79], v[212:215], v[40:43], v[76:79]
    ds_read_b64_tr_b16 v[22:23], v7 offset:2048
    s_waitcnt vmcnt(8)
    v_cmp_u_f32 vcc, v32, v36
    v_mfma_f32_16x16x32_bf16 v[80:83], v[208:211], v[44:47], v[80:83]
    ds_read_b64_tr_b16 v[16:17], v6 offset:0
    v_mfma_f32_16x16x32_bf16 v[72:75], v[208:211], v[40:43], v[72:75]
    ds_read_b64_tr_b16 v[18:19], v6 offset:2048
    s_cbranch_vccnz interleave_layers__ssm_conv_s4d__mixer_token_mlp__prompt_kernel_rt130
interleave_layers__ssm_conv_s4d__mixer_token_mlp__prompt_kernel_ok131:
    s_waitcnt lgkmcnt(4)
    v_mfma_f32_16x16x32_bf16 v[100:103], v[60:63], v[36:39], v[100:103]
    buffer_load_dwordx4 v[44:47], v11, s[52:55], s13 offen sc1
    v_mfma_f32_16x16x32_bf16 v[92:95], v[60:63], v[32:35], v[92:95]
    v_mfma_f32_16x16x32_bf16 v[96:99], v[56:59], v[36:39], v[96:99]
    buffer_load_dwordx4 v[40:43], v10, s[52:55], s13 offen sc1
    v_mfma_f32_16x16x32_bf16 v[88:91], v[56:59], v[32:35], v[88:91]
    s_waitcnt lgkmcnt(0)
    v_mfma_f32_16x16x32_bf16 v[84:87], v[20:23], v[36:39], v[84:87]
    v_readlane_b32 s14, v12, 55
    v_mfma_f32_16x16x32_bf16 v[76:79], v[20:23], v[32:35], v[76:79]
    s_waitcnt vmcnt(8)
    v_cmp_u_f32_e64 vcc, v24, v28
    v_mfma_f32_16x16x32_bf16 v[80:83], v[16:19], v[36:39], v[80:83]
    v_mfma_f32_16x16x32_bf16 v[72:75], v[16:19], v[32:35], v[72:75]
    s_nop 0
    s_cbranch_vccnz interleave_layers__ssm_conv_s4d__mixer_token_mlp__prompt_kernel_rt132
interleave_layers__ssm_conv_s4d__mixer_token_mlp__prompt_kernel_ok133:
    v_mfma_f32_16x16x32_bf16 v[100:103], v[236:239], v[28:31], v[100:103]
    ds_read_b64_tr_b16 v[60:61], v7 offset:16896
    buffer_load_dwordx4 v[36:39], v11, s[52:55], s14 offen sc1
    v_mfma_f32_16x16x32_bf16 v[92:95], v[236:239], v[24:27], v[92:95]
    ds_read_b64_tr_b16 v[62:63], v7 offset:18944
    v_mfma_f32_16x16x32_bf16 v[96:99], v[232:235], v[28:31], v[96:99]
    ds_read_b64_tr_b16 v[56:57], v6 offset:16896
    buffer_load_dwordx4 v[32:35], v10, s[52:55], s14 offen sc1
    v_mfma_f32_16x16x32_bf16 v[88:91], v[232:235], v[24:27], v[88:91]
    ds_read_b64_tr_b16 v[58:59], v6 offset:18944
    v_mfma_f32_16x16x32_bf16 v[84:87], v[228:231], v[28:31], v[84:87]
    ds_read_b64_tr_b16 v[20:21], v7 offset:16384
    v_readlane_b32 s15, v12, 49
    v_mfma_f32_16x16x32_bf16 v[76:79], v[228:231], v[24:27], v[76:79]
    ds_read_b64_tr_b16 v[22:23], v7 offset:18432
    s_waitcnt vmcnt(8)
    v_cmp_u_f32 vcc, v136, v140
    v_mfma_f32_16x16x32_bf16 v[80:83], v[224:227], v[28:31], v[80:83]
    ds_read_b64_tr_b16 v[16:17], v6 offset:16384
    v_mfma_f32_16x16x32_bf16 v[72:75], v[224:227], v[24:27], v[72:75]
    ds_read_b64_tr_b16 v[18:19], v6 offset:18432
    s_cbranch_vccnz interleave_layers__ssm_conv_s4d__mixer_token_mlp__prompt_kernel_rt134
interleave_layers__ssm_conv_s4d__mixer_token_mlp__prompt_kernel_ok135:
    s_waitcnt lgkmcnt(4)
    v_mfma_f32_16x16x32_bf16 v[100:103], v[60:63], v[140:143], v[100:103]
    buffer_load_dwordx4 v[28:31], v11, s[52:55], s15 offen sc1
    v_mfma_f32_16x16x32_bf16 v[92:95], v[60:63], v[136:139], v[92:95]
    v_mfma_f32_16x16x32_bf16 v[96:99], v[56:59], v[140:143], v[96:99]
    buffer_load_dwordx4 v[24:27], v10, s[52:55], s15 offen sc1
    v_mfma_f32_16x16x32_bf16 v[88:91], v[56:59], v[136:139], v[88:91]
    s_waitcnt lgkmcnt(0)
    v_mfma_f32_16x16x32_bf16 v[84:87], v[20:23], v[140:143], v[84:87]
    v_readlane_b32 s70, v12, 56
    v_mfma_f32_16x16x32_bf16 v[76:79], v[20:23], v[136:139], v[76:79]
    s_waitcnt vmcnt(8)
    v_cmp_u_f32_e64 vcc, v64, v68
    v_mfma_f32_16x16x32_bf16 v[80:83], v[16:19], v[140:143], v[80:83]
    v_mfma_f32_16x16x32_bf16 v[72:75], v[16:19], v[136:139], v[72:75]
    s_nop 0
    s_cbranch_vccnz interleave_layers__ssm_conv_s4d__mixer_token_mlp__prompt_kernel_rt136
interleave_layers__ssm_conv_s4d__mixer_token_mlp__prompt_kernel_ok137:
    v_mfma_f32_16x16x32_bf16 v[100:103], v[252:255], v[68:71], v[100:103]
    ds_read_b64_tr_b16 v[60:61], v7 offset:49664
    buffer_load_dwordx4 v[140:143], v11, s[52:55], s70 offen sc1
    v_mfma_f32_16x16x32_bf16 v[92:95], v[252:255], v[64:67], v[92:95]
    ds_read_b64_tr_b16 v[62:63], v7 offset:51712
    v_mfma_f32_16x16x32_bf16 v[96:99], v[248:251], v[68:71], v[96:99]
    ds_read_b64_tr_b16 v[56:57], v6 offset:49664
    buffer_load_dwordx4 v[136:139], v10, s[52:55], s70 offen sc1
    v_mfma_f32_16x16x32_bf16 v[88:91], v[248:251], v[64:67], v[88:91]
    ds_read_b64_tr_b16 v[58:59], v6 offset:51712
    v_mfma_f32_16x16x32_bf16 v[84:87], v[244:247], v[68:71], v[84:87]
    ds_read_b64_tr_b16 v[20:21], v7 offset:49152
    v_readlane_b32 s7, v12, 50
    v_mfma_f32_16x16x32_bf16 v[76:79], v[244:247], v[64:67], v[76:79]
    ds_read_b64_tr_b16 v[22:23], v7 offset:51200
    s_waitcnt vmcnt(8)
    v_cmp_u_f32 vcc, v48, v52
    v_mfma_f32_16x16x32_bf16 v[80:83], v[240:243], v[68:71], v[80:83]
    ds_read_b64_tr_b16 v[16:17], v6 offset:49152
    v_mfma_f32_16x16x32_bf16 v[72:75], v[240:243], v[64:67], v[72:75]
    ds_read_b64_tr_b16 v[18:19], v6 offset:51200
    s_cbranch_vccnz interleave_layers__ssm_conv_s4d__mixer_token_mlp__prompt_kernel_rt138
interleave_layers__ssm_conv_s4d__mixer_token_mlp__prompt_kernel_ok139:
    s_waitcnt lgkmcnt(4)
    v_mfma_f32_16x16x32_bf16 v[100:103], v[60:63], v[52:55], v[100:103]
    buffer_load_dwordx4 v[68:71], v11, s[52:55], s7 offen sc1
    v_mfma_f32_16x16x32_bf16 v[92:95], v[60:63], v[48:51], v[92:95]
    v_mfma_f32_16x16x32_bf16 v[96:99], v[56:59], v[52:55], v[96:99]
    buffer_load_dwordx4 v[64:67], v10, s[52:55], s7 offen sc1
    v_mfma_f32_16x16x32_bf16 v[88:91], v[56:59], v[48:51], v[88:91]
    s_waitcnt lgkmcnt(0)
    v_mfma_f32_16x16x32_bf16 v[84:87], v[20:23], v[52:55], v[84:87]
    v_readlane_b32 s12, v12, 57
    v_mfma_f32_16x16x32_bf16 v[76:79], v[20:23], v[48:51], v[76:79]
    s_waitcnt vmcnt(8)
    v_cmp_u_f32_e64 vcc, v40, v44
    v_mfma_f32_16x16x32_bf16 v[80:83], v[16:19], v[52:55], v[80:83]
    v_mfma_f32_16x16x32_bf16 v[72:75], v[16:19], v[48:51], v[72:75]
    s_nop 0
    s_cbranch_vccnz interleave_layers__ssm_conv_s4d__mixer_token_mlp__prompt_kernel_rt140
interleave_layers__ssm_conv_s4d__mixer_token_mlp__prompt_kernel_ok141:
    v_mfma_f32_16x16x32_bf16 v[132:135], v[156:159], v[44:47], 0
    ds_read_b64_tr_b16 v[60:61], v9 offset:512
    buffer_load_dwordx4 v[52:55], v11, s[52:55], s12 offen sc1
    v_mfma_f32_16x16x32_bf16 v[124:127], v[156:159], v[40:43], 0
    ds_read_b64_tr_b16 v[62:63], v9 offset:2560
    v_mfma_f32_16x16x32_bf16 v[128:131], v[152:155], v[44:47], 0
    ds_read_b64_tr_b16 v[56:57], v8 offset:512
    buffer_load_dwordx4 v[48:51], v10, s[52:55], s12 offen sc1
    v_mfma_f32_16x16x32_bf16 v[120:123], v[152:155], v[40:43], 0
    ds_read_b64_tr_b16 v[58:59], v8 offset:2560
    s_nop 0
    s_barrier
    s_add_u32 m0, s79, 4096
    v_mfma_f32_16x16x32_bf16 v[116:119], v[148:151], v[44:47], 0
    ds_read_b64_tr_b16 v[20:21], v9 offset:0
    v_readlane_b32 s13, v12, 51
    ds_write_addtid_b32 v96 offset:0
    v_mfma_f32_16x16x32_bf16 v[108:111], v[148:151], v[40:43], 0
    ds_read_b64_tr_b16 v[22:23], v9 offset:2048
    s_waitcnt vmcnt(8)
    v_cmp_u_f32 vcc, v32, v36
    v_mfma_f32_16x16x32_bf16 v[112:115], v[144:147], v[44:47], 0
    ds_read_b64_tr_b16 v[16:17], v8 offset:0
    ds_write_addtid_b32 v97 offset:256
    v_mfma_f32_16x16x32_bf16 v[104:107], v[144:147], v[40:43], 0
    ds_read_b64_tr_b16 v[18:19], v8 offset:2048
    s_cbranch_vccnz interleave_layers__ssm_conv_s4d__mixer_token_mlp__prompt_kernel_rt142
interleave_layers__ssm_conv_s4d__mixer_token_mlp__prompt_kernel_ok143:
    s_waitcnt lgkmcnt(6)
    v_mfma_f32_16x16x32_bf16 v[132:135], v[60:63], v[36:39], v[132:135]
    buffer_load_dwordx4 v[44:47], v11, s[52:55], s13 offen sc1
    ds_write_addtid_b32 v98 offset:512
    v_mfma_f32_16x16x32_bf16 v[124:127], v[60:63], v[32:35], v[124:127]
    ds_write_addtid_b32 v99 offset:768
    v_mfma_f32_16x16x32_bf16 v[128:131], v[56:59], v[36:39], v[128:131]
    buffer_load_dwordx4 v[40:43], v10, s[52:55], s13 offen sc1
    ds_write_addtid_b32 v100 offset:1024
    v_mfma_f32_16x16x32_bf16 v[120:123], v[56:59], v[32:35], v[120:123]
    ds_write_addtid_b32 v101 offset:1280
    ds_write_addtid_b32 v102 offset:1536
    s_waitcnt lgkmcnt(5)
    v_mfma_f32_16x16x32_bf16 v[116:119], v[20:23], v[36:39], v[116:119]
    v_readlane_b32 s14, v12, 58
    v_mfma_f32_16x16x32_bf16 v[108:111], v[20:23], v[32:35], v[108:111]
    s_waitcnt vmcnt(8)
    v_cmp_u_f32_e64 vcc, v24, v28
    ds_write_addtid_b32 v103 offset:1792
    v_mfma_f32_16x16x32_bf16 v[112:115], v[16:19], v[36:39], v[112:115]
    s_add_u32 m0, s78, 2048
    s_nop 0
    ds_write_addtid_b32 v88 offset:0
    v_mfma_f32_16x16x32_bf16 v[104:107], v[16:19], v[32:35], v[104:107]
    s_cbranch_vccnz interleave_layers__ssm_conv_s4d__mixer_token_mlp__prompt_kernel_rt144
interleave_layers__ssm_conv_s4d__mixer_token_mlp__prompt_kernel_ok145:
    ds_write_addtid_b32 v89 offset:256
    v_mfma_f32_16x16x32_bf16 v[132:135], v[172:175], v[28:31], v[132:135]
    ds_read_b64_tr_b16 v[60:61], v9 offset:16896
    buffer_load_dwordx4 v[36:39], v11, s[52:55], s14 offen sc1
    v_mfma_f32_16x16x32_bf16 v[124:127], v[172:175], v[24:27], v[124:127]
    ds_read_b64_tr_b16 v[62:63], v9 offset:18944
    ds_write_addtid_b32 v90 offset:512
    v_mfma_f32_16x16x32_bf16 v[128:131], v[168:171], v[28:31], v[128:131]
    ds_read_b64_tr_b16 v[56:57], v8 offset:16896
    buffer_load_dwordx4 v[32:35], v10, s[52:55], s14 offen sc1
    ds_write_addtid_b32 v91 offset:768
    v_mfma_f32_16x16x32_bf16 v[120:123], v[168:171], v[24:27], v[120:123]
    ds_read_b64_tr_b16 v[58:59], v8 offset:18944
    ds_write_addtid_b32 v92 offset:1024
    v_mfma_f32_16x16x32_bf16 v[116:119], v[164:167], v[28:31], v[116:119]
    ds_read_b64_tr_b16 v[20:21], v9 offset:16384
    v_readlane_b32 s15, v12, 52
    v_mfma_f32_16x16x32_bf16 v[108:111], v[164:167], v[24:27], v[108:111]
    ds_read_b64_tr_b16 v[22:23], v9 offset:18432
    s_waitcnt vmcnt(8)
    v_cmp_u_f32 vcc, v136, v140
    v_mfma_f32_16x16x32_bf16 v[112:115], v[160:163], v[28:31], v[112:115]
    ds_read_b64_tr_b16 v[16:17], v8 offset:16384
    ds_write_addtid_b32 v93 offset:1280
    v_mfma_f32_16x16x32_bf16 v[104:107], v[160:163], v[24:27], v[104:107]
    ds_read_b64_tr_b16 v[18:19], v8 offset:18432
    s_cbranch_vccnz interleave_layers__ssm_conv_s4d__mixer_token_mlp__prompt_kernel_rt146
interleave_layers__ssm_conv_s4d__mixer_token_mlp__prompt_kernel_ok147:
    ds_write_addtid_b32 v94 offset:1536
    s_waitcnt lgkmcnt(7)
    v_mfma_f32_16x16x32_bf16 v[132:135], v[60:63], v[140:143], v[132:135]
    buffer_load_dwordx4 v[28:31], v11, s[52:55], s15 offen sc1
    v_mfma_f32_16x16x32_bf16 v[124:127], v[60:63], v[136:139], v[124:127]
    ds_write_addtid_b32 v95 offset:1792
    s_nop 0
    s_add_u32 m0, s77, 0
    v_mfma_f32_16x16x32_bf16 v[128:131], v[56:59], v[140:143], v[128:131]
    buffer_load_dwordx4 v[24:27], v10, s[52:55], s15 offen sc1
    ds_write_addtid_b32 v80 offset:0
    v_mfma_f32_16x16x32_bf16 v[120:123], v[56:59], v[136:139], v[120:123]
    ds_write_addtid_b32 v81 offset:256
    ds_write_addtid_b32 v82 offset:512
    s_waitcnt lgkmcnt(5)
    v_mfma_f32_16x16x32_bf16 v[116:119], v[20:23], v[140:143], v[116:119]
    v_readlane_b32 s70, v12, 59
    v_mfma_f32_16x16x32_bf16 v[108:111], v[20:23], v[136:139], v[108:111]
    s_waitcnt vmcnt(8)
    v_cmp_u_f32_e64 vcc, v64, v68
    ds_write_addtid_b32 v83 offset:768
    v_mfma_f32_16x16x32_bf16 v[112:115], v[16:19], v[140:143], v[112:115]
    ds_write_addtid_b32 v84 offset:1024
    v_mfma_f32_16x16x32_bf16 v[104:107], v[16:19], v[136:139], v[104:107]
    s_nop 0
    s_cbranch_vccnz interleave_layers__ssm_conv_s4d__mixer_token_mlp__prompt_kernel_rt148
interleave_layers__ssm_conv_s4d__mixer_token_mlp__prompt_kernel_ok149:
    ds_write_addtid_b32 v85 offset:1280
    v_mfma_f32_16x16x32_bf16 v[132:135], v[188:191], v[68:71], v[132:135]
    ds_read_b64_tr_b16 v[60:61], v9 offset:33280
    buffer_load_dwordx4 v[140:143], v11, s[52:55], s70 offen sc1
    ds_write_addtid_b32 v86 offset:1536
    v_mfma_f32_16x16x32_bf16 v[124:127], v[188:191], v[64:67], v[124:127]
    ds_read_b64_tr_b16 v[62:63], v9 offset:35328
    ds_write_addtid_b32 v87 offset:1792
    v_mfma_f32_16x16x32_bf16 v[128:131], v[184:187], v[68:71], v[128:131]
    ds_read_b64_tr_b16 v[56:57], v8 offset:33280
    buffer_load_dwordx4 v[136:139], v10, s[52:55], s70 offen sc1
    v_mfma_f32_16x16x32_bf16 v[120:123], v[184:187], v[64:67], v[120:123]
    ds_read_b64_tr_b16 v[58:59], v8 offset:35328
    v_mfma_f32_16x16x32_bf16 v[116:119], v[180:183], v[68:71], v[116:119]
    ds_read_b64_tr_b16 v[20:21], v9 offset:32768
    v_readlane_b32 s7, v12, 53
    v_mfma_f32_16x16x32_bf16 v[108:111], v[180:183], v[64:67], v[108:111]
    ds_read_b64_tr_b16 v[22:23], v9 offset:34816
    s_waitcnt vmcnt(8)
    v_cmp_u_f32 vcc, v48, v52
    v_mfma_f32_16x16x32_bf16 v[112:115], v[176:179], v[68:71], v[112:115]
    ds_read_b64_tr_b16 v[16:17], v8 offset:32768
    v_mfma_f32_16x16x32_bf16 v[104:107], v[176:179], v[64:67], v[104:107]
    ds_read_b64_tr_b16 v[18:19], v8 offset:34816
    s_cbranch_vccnz interleave_layers__ssm_conv_s4d__mixer_token_mlp__prompt_kernel_rt150
interleave_layers__ssm_conv_s4d__mixer_token_mlp__prompt_kernel_ok151:
    s_waitcnt lgkmcnt(4)
    v_mfma_f32_16x16x32_bf16 v[132:135], v[60:63], v[52:55], v[132:135]
    buffer_load_dwordx4 v[68:71], v11, s[52:55], s7 offen sc1
    s_waitcnt lgkmcnt(0)
    s_barrier
    v_mfma_f32_16x16x32_bf16 v[124:127], v[60:63], v[48:51], v[124:127]
    ds_read2st64_b32 v[80:81], v14 offset0:0 offset1:1
    ds_read2st64_b32 v[88:89], v14 offset0:8 offset1:9
    v_mfma_f32_16x16x32_bf16 v[128:131], v[56:59], v[52:55], v[128:131]
    buffer_load_dwordx4 v[64:67], v10, s[52:55], s7 offen sc1
    ds_read2st64_b32 v[96:97], v14 offset0:16 offset1:17
    ds_read2st64_b32 v[82:83], v14 offset0:2 offset1:3
    v_mfma_f32_16x16x32_bf16 v[120:123], v[56:59], v[48:51], v[120:123]
    ds_read2st64_b32 v[90:91], v14 offset0:10 offset1:11
    ds_read2st64_b32 v[98:99], v14 offset0:18 offset1:19
    ds_read2st64_b32 v[84:85], v14 offset0:4 offset1:5
    v_mfma_f32_16x16x32_bf16 v[116:119], v[20:23], v[52:55], v[116:119]
    v_readlane_b32 s12, v12, 60
    ds_read2st64_b32 v[92:93], v14 offset0:12 offset1:13
    ds_read2st64_b32 v[100:101], v14 offset0:20 offset1:21
    v_mfma_f32_16x16x32_bf16 v[108:111], v[20:23], v[48:51], v[108:111]
    s_waitcnt vmcnt(8)
    v_cmp_u_f32 vcc, v40, v44
    ds_read2st64_b32 v[86:87], v14 offset0:6 offset1:7
    v_mfma_f32_16x16x32_bf16 v[112:115], v[16:19], v[52:55], v[112:115]
    ds_read2st64_b32 v[94:95], v14 offset0:14 offset1:15
    ds_read2st64_b32 v[102:103], v14 offset0:22 offset1:23
    v_mfma_f32_16x16x32_bf16 v[104:107], v[16:19], v[48:51], v[104:107]
    s_cbranch_vccnz interleave_layers__ssm_conv_s4d__mixer_token_mlp__prompt_kernel_rt152
interleave_layers__ssm_conv_s4d__mixer_token_mlp__prompt_kernel_ok153:
    s_waitcnt lgkmcnt(9)
    v_add_f32_e64 v72, v80, v72
    v_mfma_f32_16x16x32_bf16 v[132:135], v[204:207], v[44:47], v[132:135]
    ds_read_b64_tr_b16 v[60:61], v7 offset:33280
    buffer_load_dwordx4 v[52:55], v11, s[52:55], s12 offen sc1
    v_mfma_f32_16x16x32_bf16 v[124:127], v[204:207], v[40:43], v[124:127]
    ds_read_b64_tr_b16 v[62:63], v7 offset:35328
    v_add_f32 v73, v81, v73
    v_add_f32 v88, v96, v88
    v_mfma_f32_16x16x32_bf16 v[128:131], v[200:203], v[44:47], v[128:131]
    ds_read_b64_tr_b16 v[56:57], v6 offset:33280
    buffer_load_dwordx4 v[48:51], v10, s[52:55], s12 offen sc1
    v_add_f32_e64 v89, v97, v89
    v_mfma_f32_16x16x32_bf16 v[120:123], v[200:203], v[40:43], v[120:123]
    ds_read_b64_tr_b16 v[58:59], v6 offset:35328
    s_waitcnt lgkmcnt(10)
    v_add_f32 v74, v82, v74
    v_mfma_f32_16x16x32_bf16 v[116:119], v[196:199], v[44:47], v[116:119]
    ds_read_b64_tr_b16 v[20:21], v7 offset:32768
    v_readlane_b32 s13, v12, 54
    v_add_f32_e64 v75, v83, v75
    v_mfma_f32_16x16x32_bf16 v[108:111], v[196:199], v[40:43], v[108:111]
    ds_read_b64_tr_b16 v[22:23], v7 offset:34816
    s_waitcnt vmcnt(8)
    v_cmp_u_f32 vcc, v32, v36
    v_mfma_f32_16x16x32_bf16 v[112:115], v[192:195], v[44:47], v[112:115]
    ds_read_b64_tr_b16 v[16:17], v6 offset:32768
    v_add_f32 v90, v98, v90
    v_add_f32 v91, v99, v91
    v_mfma_f32_16x16x32_bf16 v[104:107], v[192:195], v[40:43], v[104:107]
    ds_read_b64_tr_b16 v[18:19], v6 offset:34816
    s_cbranch_vccnz interleave_layers__ssm_conv_s4d__mixer_token_mlp__prompt_kernel_rt154
interleave_layers__ssm_conv_s4d__mixer_token_mlp__prompt_kernel_ok155:
    s_waitcnt lgkmcnt(11)
    v_add_f32 v76, v84, v76
    s_waitcnt lgkmcnt(4)
    v_mfma_f32_16x16x32_bf16 v[132:135], v[60:63], v[36:39], v[132:135]
    buffer_load_dwordx4 v[44:47], v11, s[52:55], s13 offen sc1
    v_mfma_f32_16x16x32_bf16 v[124:127], v[60:63], v[32:35], v[124:127]
    v_add_f32 v77, v85, v77
    v_add_f32 v92, v100, v92
    v_add_f32_e64 v93, v101, v93
    v_mfma_f32_16x16x32_bf16 v[128:131], v[56:59], v[36:39], v[128:131]
    buffer_load_dwordx4 v[40:43], v10, s[52:55], s13 offen sc1
    v_add_f32 v78, v86, v78
    v_add_f32 v79, v87, v79
    v_mfma_f32_16x16x32_bf16 v[120:123], v[56:59], v[32:35], v[120:123]
    v_add_f32 v94, v102, v94
    v_add_f32 v95, v103, v95
    v_add_f32 v72, v88, v72
    s_waitcnt lgkmcnt(0)
    v_mfma_f32_16x16x32_bf16 v[116:119], v[20:23], v[36:39], v[116:119]
    v_readlane_b32 s14, v12, 61
    v_add_f32_e64 v73, v89, v73
    v_mfma_f32_16x16x32_bf16 v[108:111], v[20:23], v[32:35], v[108:111]
    s_waitcnt vmcnt(8)
    v_cmp_u_f32 vcc, v24, v28
    v_add_f32_e64 v74, v90, v74
    v_mfma_f32_16x16x32_bf16 v[112:115], v[16:19], v[36:39], v[112:115]
    v_add_f32 v75, v91, v75
    v_add_f32 v76, v92, v76
    v_add_f32_e64 v77, v93, v77
    v_mfma_f32_16x16x32_bf16 v[104:107], v[16:19], v[32:35], v[104:107]
    s_cbranch_vccnz interleave_layers__ssm_conv_s4d__mixer_token_mlp__prompt_kernel_rt156
interleave_layers__ssm_conv_s4d__mixer_token_mlp__prompt_kernel_ok157:
    v_add_f32 v78, v94, v78
    v_add_f32_e64 v79, v95, v79
    v_mfma_f32_16x16x32_bf16 v[132:135], v[220:223], v[28:31], v[132:135]
    ds_read_b64_tr_b16 v[60:61], v7 offset:512
    buffer_load_dwordx4 v[36:39], v11, s[52:55], s14 offen sc1
    v_bfe_u32 v96, v0, 5, 1
    v_mfma_f32_16x16x32_bf16 v[124:127], v[220:223], v[24:27], v[124:127]
    ds_read_b64_tr_b16 v[62:63], v7 offset:2560
    v_bfe_u32 v97, v0, 4, 1
    v_lshl_add_u32 v96, v97, 1, v96
    v_mfma_f32_16x16x32_bf16 v[128:131], v[216:219], v[28:31], v[128:131]
    ds_read_b64_tr_b16 v[56:57], v6 offset:512
    buffer_load_dwordx4 v[32:35], v10, s[52:55], s14 offen sc1
    v_mul_u32_u24 v96, 8320, v96
    v_mfma_f32_16x16x32_bf16 v[120:123], v[216:219], v[24:27], v[120:123]
    ds_read_b64_tr_b16 v[58:59], v6 offset:2560
    v_and_b32 v97, 0x1ff, v10
    v_add_u32_e64 v96, v96, v97
    v_mfma_f32_16x16x32_bf16 v[116:119], v[212:215], v[28:31], v[116:119]
    ds_read_b64_tr_b16 v[20:21], v7 offset:0
    v_cvt_pk_bf16_f32 v88, v72, v73
    v_cvt_pk_bf16_f32 v89, v74, v75
    v_mfma_f32_16x16x32_bf16 v[108:111], v[212:215], v[24:27], v[108:111]
    ds_read_b64_tr_b16 v[22:23], v7 offset:2048
    s_waitcnt vmcnt(8)
    v_cmp_u_f32 vcc, v136, v140
    v_mfma_f32_16x16x32_bf16 v[112:115], v[208:211], v[28:31], v[112:115]
    ds_read_b64_tr_b16 v[16:17], v6 offset:0
    v_cvt_pk_bf16_f32 v90, v76, v77
    v_cvt_pk_bf16_f32 v91, v78, v79
    v_mfma_f32_16x16x32_bf16 v[104:107], v[208:211], v[24:27], v[104:107]
    ds_read_b64_tr_b16 v[18:19], v6 offset:2048
    s_cbranch_vccnz interleave_layers__ssm_conv_s4d__mixer_token_mlp__prompt_kernel_rt158
interleave_layers__ssm_conv_s4d__mixer_token_mlp__prompt_kernel_ok159:
    v_permlane16_swap_b32_e64 v88, v90
    s_waitcnt lgkmcnt(4)
    v_mfma_f32_16x16x32_bf16 v[132:135], v[60:63], v[140:143], v[132:135]
    v_permlane16_swap_b32_e64 v89, v91
    v_mfma_f32_16x16x32_bf16 v[124:127], v[60:63], v[136:139], v[124:127]
    v_mfma_f32_16x16x32_bf16 v[128:131], v[56:59], v[140:143], v[128:131]
    v_mfma_f32_16x16x32_bf16 v[120:123], v[56:59], v[136:139], v[120:123]
    s_waitcnt lgkmcnt(0)
    v_mfma_f32_16x16x32_bf16 v[116:119], v[20:23], v[140:143], v[116:119]
    v_mfma_f32_16x16x32_bf16 v[108:111], v[20:23], v[136:139], v[108:111]
    s_waitcnt vmcnt(6)
    v_cmp_u_f32_e64 vcc, v64, v68
    v_mfma_f32_16x16x32_bf16 v[112:115], v[16:19], v[140:143], v[112:115]
    v_mfma_f32_16x16x32_bf16 v[104:107], v[16:19], v[136:139], v[104:107]
    s_nop 0
    s_cbranch_vccnz interleave_layers__ssm_conv_s4d__mixer_token_mlp__prompt_kernel_rt160
interleave_layers__ssm_conv_s4d__mixer_token_mlp__prompt_kernel_ok161:
    v_mfma_f32_16x16x32_bf16 v[132:135], v[236:239], v[68:71], v[132:135]
    ds_read_b64_tr_b16 v[60:61], v7 offset:16896
    buffer_store_dwordx4 v[88:91], v96, s[52:55], s80 offen sc1
    v_mfma_f32_16x16x32_bf16 v[124:127], v[236:239], v[64:67], v[124:127]
    ds_read_b64_tr_b16 v[62:63], v7 offset:18944
    v_mfma_f32_16x16x32_bf16 v[128:131], v[232:235], v[68:71], v[128:131]
    ds_read_b64_tr_b16 v[56:57], v6 offset:16896
    v_mfma_f32_16x16x32_bf16 v[120:123], v[232:235], v[64:67], v[120:123]
    ds_read_b64_tr_b16 v[58:59], v6 offset:18944
    v_mfma_f32_16x16x32_bf16 v[116:119], v[228:231], v[68:71], v[116:119]
    ds_read_b64_tr_b16 v[20:21], v7 offset:16384
    v_mfma_f32_16x16x32_bf16 v[108:111], v[228:231], v[64:67], v[108:111]
    ds_read_b64_tr_b16 v[22:23], v7 offset:18432
    s_waitcnt vmcnt(5)
    v_cmp_u_f32 vcc, v48, v52
    v_mfma_f32_16x16x32_bf16 v[112:115], v[224:227], v[68:71], v[112:115]
    ds_read_b64_tr_b16 v[16:17], v6 offset:16384
    v_mfma_f32_16x16x32_bf16 v[104:107], v[224:227], v[64:67], v[104:107]
    ds_read_b64_tr_b16 v[18:19], v6 offset:18432
    s_cbranch_vccnz interleave_layers__ssm_conv_s4d__mixer_token_mlp__prompt_kernel_rt162
interleave_layers__ssm_conv_s4d__mixer_token_mlp__prompt_kernel_ok163:
    s_waitcnt lgkmcnt(4)
    v_mfma_f32_16x16x32_bf16 v[132:135], v[60:63], v[52:55], v[132:135]
    v_mfma_f32_16x16x32_bf16 v[124:127], v[60:63], v[48:51], v[124:127]
    v_mfma_f32_16x16x32_bf16 v[128:131], v[56:59], v[52:55], v[128:131]
    v_mfma_f32_16x16x32_bf16 v[120:123], v[56:59], v[48:51], v[120:123]
    s_waitcnt lgkmcnt(0)
    v_mfma_f32_16x16x32_bf16 v[116:119], v[20:23], v[52:55], v[116:119]
    v_mfma_f32_16x16x32_bf16 v[108:111], v[20:23], v[48:51], v[108:111]
    s_waitcnt vmcnt(3)
    v_cmp_u_f32_e64 vcc, v40, v44
    v_mfma_f32_16x16x32_bf16 v[112:115], v[16:19], v[52:55], v[112:115]
    v_mfma_f32_16x16x32_bf16 v[104:107], v[16:19], v[48:51], v[104:107]
    s_nop 0
    s_cbranch_vccnz interleave_layers__ssm_conv_s4d__mixer_token_mlp__prompt_kernel_rt164
interleave_layers__ssm_conv_s4d__mixer_token_mlp__prompt_kernel_ok165:
    v_mfma_f32_16x16x32_bf16 v[132:135], v[252:255], v[44:47], v[132:135]
    ds_read_b64_tr_b16 v[60:61], v7 offset:49664
    v_mfma_f32_16x16x32_bf16 v[124:127], v[252:255], v[40:43], v[124:127]
    ds_read_b64_tr_b16 v[62:63], v7 offset:51712
    v_mfma_f32_16x16x32_bf16 v[128:131], v[248:251], v[44:47], v[128:131]
    ds_read_b64_tr_b16 v[56:57], v6 offset:49664
    v_mfma_f32_16x16x32_bf16 v[120:123], v[248:251], v[40:43], v[120:123]
    ds_read_b64_tr_b16 v[58:59], v6 offset:51712
    v_mfma_f32_16x16x32_bf16 v[116:119], v[244:247], v[44:47], v[116:119]
    ds_read_b64_tr_b16 v[20:21], v7 offset:49152
    v_mfma_f32_16x16x32_bf16 v[108:111], v[244:247], v[40:43], v[108:111]
    ds_read_b64_tr_b16 v[22:23], v7 offset:51200
    s_waitcnt vmcnt(1)
    v_cmp_u_f32 vcc, v32, v36
    v_mfma_f32_16x16x32_bf16 v[112:115], v[240:243], v[44:47], v[112:115]
    ds_read_b64_tr_b16 v[16:17], v6 offset:49152
    v_mfma_f32_16x16x32_bf16 v[104:107], v[240:243], v[40:43], v[104:107]
    ds_read_b64_tr_b16 v[18:19], v6 offset:51200
    s_cbranch_vccnz interleave_layers__ssm_conv_s4d__mixer_token_mlp__prompt_kernel_rt166
interleave_layers__ssm_conv_s4d__mixer_token_mlp__prompt_kernel_ok167:
    s_waitcnt lgkmcnt(4)
    v_mfma_f32_16x16x32_bf16 v[132:135], v[60:63], v[36:39], v[132:135]
    s_barrier
    v_mfma_f32_16x16x32_bf16 v[124:127], v[60:63], v[32:35], v[124:127]
    v_mfma_f32_16x16x32_bf16 v[128:131], v[56:59], v[36:39], v[128:131]
    v_mfma_f32_16x16x32_bf16 v[120:123], v[56:59], v[32:35], v[120:123]
    s_waitcnt lgkmcnt(0)
    v_mfma_f32_16x16x32_bf16 v[116:119], v[20:23], v[36:39], v[116:119]
    s_add_u32 m0, s79, 4096
    v_mfma_f32_16x16x32_bf16 v[112:115], v[16:19], v[36:39], v[112:115]
    ds_write_addtid_b32 v128 offset:0
    ds_write_addtid_b32 v129 offset:256
    v_mfma_f32_16x16x32_bf16 v[108:111], v[20:23], v[32:35], v[108:111]
    ds_write_addtid_b32 v130 offset:512
    ds_write_addtid_b32 v131 offset:768
    v_mfma_f32_16x16x32_bf16 v[104:107], v[16:19], v[32:35], v[104:107]
    ds_write_addtid_b32 v132 offset:1024
    ds_write_addtid_b32 v133 offset:1280
    ds_write_addtid_b32 v134 offset:1536
    ds_write_addtid_b32 v135 offset:1792
    s_add_u32 m0, s78, 2048
    s_nop 0
    s_nop 0
    ds_write_addtid_b32 v120 offset:0
    ds_write_addtid_b32 v121 offset:256
    ds_write_addtid_b32 v122 offset:512
    ds_write_addtid_b32 v123 offset:768
    ds_write_addtid_b32 v124 offset:1024
    ds_write_addtid_b32 v125 offset:1280
    ds_write_addtid_b32 v126 offset:1536
    ds_write_addtid_b32 v127 offset:1792
    s_add_u32 m0, s77, 0
    s_nop 0
    ds_write_addtid_b32 v112 offset:0
    ds_write_addtid_b32 v113 offset:256
    ds_write_addtid_b32 v114 offset:512
    ds_write_addtid_b32 v115 offset:768
    ds_write_addtid_b32 v116 offset:1024
    ds_write_addtid_b32 v117 offset:1280
    ds_write_addtid_b32 v118 offset:1536
    ds_write_addtid_b32 v119 offset:1792
    s_waitcnt lgkmcnt(0)
    s_barrier
    ds_read2st64_b32 v[112:113], v14 offset0:0 offset1:1
    ds_read2st64_b32 v[120:121], v14 offset0:8 offset1:9
    ds_read2st64_b32 v[128:129], v14 offset0:16 offset1:17
    ds_read2st64_b32 v[114:115], v14 offset0:2 offset1:3
    ds_read2st64_b32 v[122:123], v14 offset0:10 offset1:11
    ds_read2st64_b32 v[130:131], v14 offset0:18 offset1:19
    ds_read2st64_b32 v[116:117], v14 offset0:4 offset1:5
    ds_read2st64_b32 v[124:125], v14 offset0:12 offset1:13
    ds_read2st64_b32 v[132:133], v14 offset0:20 offset1:21
    ds_read2st64_b32 v[118:119], v14 offset0:6 offset1:7
    ds_read2st64_b32 v[126:127], v14 offset0:14 offset1:15
    ds_read2st64_b32 v[134:135], v14 offset0:22 offset1:23
    buffer_load_dwordx4 v[48:51], v1, s[52:55], s8 offen sc1
    v_mov_b32 v13, v13
    v_mov_b32 v13, v13
    v_mov_b32 v13, v13
    s_waitcnt lgkmcnt(9)
    v_pk_add_f32 v[104:105], v[104:105], v[112:113]
    v_pk_add_f32 v[120:121], v[120:121], v[128:129]
    s_waitcnt lgkmcnt(6)
    v_pk_add_f32 v[106:107], v[106:107], v[114:115]
    v_pk_add_f32 v[122:123], v[122:123], v[130:131]
    s_waitcnt lgkmcnt(3)
    v_pk_add_f32 v[108:109], v[108:109], v[116:117]
    v_pk_add_f32 v[124:125], v[124:125], v[132:133]
    s_nop 0
    s_waitcnt lgkmcnt(0)
    v_pk_add_f32 v[110:111], v[110:111], v[118:119]
    v_pk_add_f32 v[126:127], v[126:127], v[134:135]
    v_pk_add_f32 v[104:105], v[104:105], v[120:121]
    v_pk_add_f32 v[106:107], v[106:107], v[122:123]
    v_pk_add_f32 v[108:109], v[108:109], v[124:125]
    v_pk_add_f32 v[110:111], v[110:111], v[126:127]
    v_cvt_pk_bf16_f32 v120, v104, v105
    v_cvt_pk_bf16_f32 v121, v106, v107
    v_cvt_pk_bf16_f32 v122, v108, v109
    v_cvt_pk_bf16_f32 v123, v110, v111
    s_nop 0
    v_permlane16_swap_b32 v120, v122
    v_permlane16_swap_b32_e64 v121, v123
    buffer_store_dwordx4 v[120:123], v96, s[52:55], s81 offen sc1
    s_nop 0
    ds_read_b128 v[136:139], v1 offset:24576
    ds_read_b128 v[140:143], v1 offset:28672
    s_waitcnt lgkmcnt(0)
    v_lshlrev_b32_e64 v120, 16, v136
    v_and_b32 v121, 0xffff0000, v136
    v_lshlrev_b32_e64 v122, 16, v137
    v_and_b32 v123, 0xffff0000, v137
    v_lshlrev_b32_e64 v124, 16, v138
    v_and_b32 v125, 0xffff0000, v138
    v_lshlrev_b32_e64 v126, 16, v139
    v_and_b32 v127, 0xffff0000, v139
    v_lshlrev_b32_e64 v128, 16, v140
    v_and_b32 v129, 0xffff0000, v140
    v_lshlrev_b32_e64 v130, 16, v141
    v_and_b32 v131, 0xffff0000, v141
    v_lshlrev_b32_e64 v132, 16, v142
    v_and_b32 v133, 0xffff0000, v142
    v_lshlrev_b32_e64 v134, 16, v143
    v_and_b32 v135, 0xffff0000, v143
    v_mov_b32 v136, -1
    v_mov_b32 v137, -1
    v_mov_b32 v138, -1
    v_mov_b32 v139, -1
    ds_read_b128 v[114:117], v1 offset:36992
    ds_read_b64 v[118:119], v1 offset:37008
    ds_read_b128 v[108:111], v1 offset:41664
    ds_read_b64 v[112:113], v1 offset:41680
    v_mov_b32 v12, 0
    v_mov_b32 v13, 0
    v_and_b32 v11, 0xf0, v0
    v_add_lshl_u32 v11, v11, v0, 1
    global_load_short_d16_hi v12, v11, s[16:17]
    global_load_short_d16_hi v13, v11, s[16:17] offset:32
    s_add_u32 s10, s46, 11796480
    s_add_u32 s11, s10, 4096
    v_and_b32_e64 v14, 60, v0
    v_add_lshl_u32 v14, v14, s3, 2
    v_and_b32 v15, 0x70, v1
    v_mov_b32 v104, 0
    v_mov_b32 v105, 0
    v_mov_b32 v106, 0
    v_mov_b32 v107, 0
    v_bfe_u32 v11, v0, 2, 3
    v_mul_u32_u24 v11, 4160, v11
    v_and_b32_e64 v16, 3, v0
    v_lshl_add_u32 v11, v16, 4, v11
    s_lshl_b32 s39, s72, 16
    v_add_f32 v120, s39, v120
    v_add_f32_e64 v128, s39, v128
    s_and_b32 s39, s72, 0xffff0000
    v_add_f32 v121, s39, v121
    v_add_f32 v129, s39, v129
    s_lshl_b32 s39, s73, 16
    v_add_f32 v122, s39, v122
    v_add_f32_e64 v130, s39, v130
    s_and_b32 s39, s73, 0xffff0000
    v_add_f32 v123, s39, v123
    v_add_f32 v131, s39, v131
    s_lshl_b32 s39, s74, 16
    v_add_f32 v124, s39, v124
    v_add_f32_e64 v132, s39, v132
    s_and_b32 s39, s74, 0xffff0000
    v_add_f32 v125, s39, v125
    v_add_f32 v133, s39, v133
    s_lshl_b32 s39, s75, 16
    v_add_f32 v126, s39, v126
    v_add_f32_e64 v134, s39, v134
    s_and_b32 s39, s75, 0xffff0000
    v_add_f32_e64 v127, s39, v127
    v_add_f32 v135, s39, v135
    s_waitcnt vmcnt(3)
    v_max3_u32 v16, v48, v49, v50
    v_cmp_u_f32 vcc, v16, v51
    s_cbranch_vccnz interleave_layers__ssm_conv_s4d__mixer_token_mlp__prompt_kernel_gretry168
interleave_layers__ssm_conv_s4d__mixer_token_mlp__prompt_kernel_gok169:
    v_dot2c_f32_bf16 v120, s18, v48
    v_dot2c_f32_bf16 v121, s19, v48
    v_dot2c_f32_bf16 v122, s18, v49
    v_dot2c_f32_bf16 v123, s19, v49
    v_dot2c_f32_bf16 v124, s18, v50
    v_dot2c_f32_bf16 v125, s19, v50
    v_dot2c_f32_bf16 v126, s18, v51
    v_dot2c_f32_bf16 v127, s19, v51
    v_pk_mul_f32 v[96:97], v[120:121], v[120:121]
    v_pk_mul_f32 v[98:99], v[122:123], v[122:123]
    v_pk_mul_f32 v[100:101], v[124:125], v[124:125]
    v_pk_mul_f32 v[102:103], v[126:127], v[126:127]
    s_nop 0
    s_waitcnt vmcnt(2)
    s_waitcnt lgkmcnt(0)
    s_barrier
    buffer_load_dwordx4 v[52:55], v1, s[52:55], s9 offen sc1
    s_add_u32 s49, s46, 14155776
    buffer_store_dwordx4 v[136:139], v1, s[52:55], s49 offen sc1
    s_add_u32 s49, s46, 14159872
    buffer_store_dwordx4 v[136:139], v1, s[52:55], s49 offen sc1
    v_bfe_u32 v17, v0, 5, 1
    v_mul_u32_u24 v17, 4672, v17
    v_and_b32_e64 v16, 31, v0
    v_lshl_add_u32 v17, v16, 4, v17
    ds_write_b128 v17, v[104:107] offset:36992
    ds_write_b128 v11, v[104:107] offset:4096
    s_waitcnt vmcnt(2)
    v_max3_u32 v11, v52, v53, v54
    v_cmp_u_f32_e64 vcc, v11, v55
    s_cbranch_vccnz interleave_layers__ssm_conv_s4d__mixer_token_mlp__prompt_kernel_gretry172
interleave_layers__ssm_conv_s4d__mixer_token_mlp__prompt_kernel_gok173:
    v_dot2c_f32_bf16 v128, s18, v52
    v_dot2c_f32_bf16 v129, s19, v52
    v_dot2c_f32_bf16 v130, s18, v53
    v_dot2c_f32_bf16 v131, s19, v53
    v_dot2c_f32_bf16 v132, s18, v54
    v_dot2c_f32_bf16 v133, s19, v54
    v_dot2c_f32_bf16 v134, s18, v55
    v_dot2c_f32_bf16 v135, s19, v55
    v_pk_add_f32 v[80:81], v[120:121], v[128:129]
    v_pk_add_f32 v[82:83], v[122:123], v[130:131]
    v_pk_add_f32 v[84:85], v[124:125], v[132:133]
    v_pk_add_f32 v[86:87], v[126:127], v[134:135]
    v_pk_fma_f32 v[96:97], v[128:129], v[128:129], v[96:97]
    v_pk_fma_f32 v[98:99], v[130:131], v[130:131], v[98:99]
    v_pk_fma_f32 v[100:101], v[132:133], v[132:133], v[100:101]
    v_pk_fma_f32 v[102:103], v[134:135], v[134:135], v[102:103]
    v_permlane32_swap_b32 v80, v96
    v_permlane32_swap_b32 v81, v97
    v_permlane32_swap_b32 v82, v98
    v_permlane32_swap_b32 v83, v99
    v_permlane32_swap_b32 v84, v100
    v_permlane32_swap_b32 v85, v101
    v_permlane32_swap_b32 v86, v102
    v_permlane32_swap_b32 v87, v103
    v_pk_add_f32 v[80:81], v[80:81], v[96:97]
    v_pk_add_f32 v[84:85], v[84:85], v[100:101]
    v_pk_add_f32 v[82:83], v[82:83], v[98:99]
    v_pk_add_f32 v[86:87], v[86:87], v[102:103]
    v_permlane16_swap_b32 v80, v84
    v_permlane16_swap_b32 v81, v85
    v_permlane16_swap_b32 v82, v86
    v_permlane16_swap_b32 v83, v87
    v_pk_add_f32 v[80:81], v[80:81], v[84:85]
    v_pk_add_f32 v[82:83], v[82:83], v[86:87]
    s_nop 0
    v_add_f32_dpp v96, v80, v80 row_ror:8 row_mask:0xf bank_mask:0x3
    v_add_f32_dpp v97, v81, v81 row_ror:8 row_mask:0xf bank_mask:0x3
    s_nop 0
    v_add_f32_dpp v96, v82, v82 row_ror:8 row_mask:0xf bank_mask:0xc
    v_add_f32_dpp v97, v83, v83 row_ror:8 row_mask:0xf bank_mask:0xc
    s_nop 0
    v_add_f32_dpp v80, v96, v96 row_shl:4 row_mask:0xf bank_mask:0x5
    s_nop 1
    v_add_f32_dpp v80, v97, v97 row_shr:4 row_mask:0xf bank_mask:0xa
    s_nop 1
    v_add_f32_dpp v80, v80, v80 quad_perm:[1,0,3,2] row_mask:0xf bank_mask:0xf
    s_nop 1
    v_add_f32_dpp v80, v80, v80 quad_perm:[2,3,0,1] row_mask:0xf bank_mask:0xf
    ds_write_b32 v14, v80 offset:46336
    v_mov_b32 v87, v87
    v_mov_b32 v87, v87
    v_mov_b32 v87, v87
    v_mov_b32 v87, v87
    s_waitcnt lgkmcnt(0)
    s_barrier
    ds_read_b128 v[80:83], v15 offset:46336
    ds_read_b128 v[96:99], v15 offset:46464
    v_mov_b32 v87, v87
    v_mov_b32 v87, v87
    v_mov_b32 v87, v87
    v_mov_b32 v87, v87
    v_mov_b32_e64 v87, v87
    v_mov_b32 v87, v87
    s_waitcnt lgkmcnt(0)
    v_pk_add_f32 v[80:81], v[80:81], v[82:83]
    v_pk_add_f32 v[96:97], v[96:97], v[98:99]
    v_add_f32 v64, v80, v81
    v_add_f32 v65, v96, v97
    v_mul_f32 v64, 0x3b000000, v64
    v_mul_f32 v65, 0x3b000000, v65
    v_fma_f32 v65, -v64, v64, v65
    v_max_f32_e64 v65, 0, v65
    v_add_f32 v66, 0x3727c5ac, v65
    v_rsq_f32 v66, v66
    s_nop 0
    v_mul_f32 v64, -v64, v66
    v_mov_b32_dpp v80, v66 row_newbcast:0 row_mask:0xf bank_mask:0xf
    v_mov_b32_dpp v81, v66 row_newbcast:1 row_mask:0xf bank_mask:0xf
    v_mov_b32_dpp v82, v66 row_newbcast:2 row_mask:0xf bank_mask:0xf
    v_mov_b32_dpp v83, v66 row_newbcast:3 row_mask:0xf bank_mask:0xf
    v_mov_b32_dpp v84, v66 row_newbcast:4 row_mask:0xf bank_mask:0xf
    v_mov_b32_dpp v85, v66 row_newbcast:5 row_mask:0xf bank_mask:0xf
    v_mov_b32_dpp v86, v66 row_newbcast:6 row_mask:0xf bank_mask:0xf
    v_mov_b32_dpp v87, v66 row_newbcast:7 row_mask:0xf bank_mask:0xf
    v_mov_b32_dpp v96, v64 row_newbcast:0 row_mask:0xf bank_mask:0xf
    v_mov_b32_dpp v97, v64 row_newbcast:1 row_mask:0xf bank_mask:0xf
    v_mov_b32_dpp v98, v64 row_newbcast:2 row_mask:0xf bank_mask:0xf
    v_mov_b32_dpp v99, v64 row_newbcast:3 row_mask:0xf bank_mask:0xf
    v_mov_b32_dpp v100, v64 row_newbcast:4 row_mask:0xf bank_mask:0xf
    v_mov_b32_dpp v101, v64 row_newbcast:5 row_mask:0xf bank_mask:0xf
    v_mov_b32_dpp v102, v64 row_newbcast:6 row_mask:0xf bank_mask:0xf
    v_mov_b32_dpp v103, v64 row_newbcast:7 row_mask:0xf bank_mask:0xf
    v_pk_fma_f32 v[64:65], v[120:121], v[80:81], v[96:97]
    v_pk_fma_f32 v[66:67], v[122:123], v[82:83], v[98:99]
    v_pk_fma_f32 v[68:69], v[124:125], v[84:85], v[100:101]
    v_pk_fma_f32 v[70:71], v[126:127], v[86:87], v[102:103]
    v_cvt_pk_bf16_f32 v88, v64, v65
    v_cvt_pk_bf16_f32 v89, v66, v67
    v_cvt_pk_bf16_f32 v90, v68, v69
    v_cvt_pk_bf16_f32 v91, v70, v71
    s_nop 0
    s_waitcnt vmcnt(0)
    buffer_store_dwordx4 v[88:91], v1, s[52:55], s10 offen sc1
    v_pk_fma_f32 v[72:73], v[128:129], v[80:81], v[96:97]
    v_pk_fma_f32 v[74:75], v[130:131], v[82:83], v[98:99]
    v_pk_fma_f32 v[76:77], v[132:133], v[84:85], v[100:101]
    v_pk_fma_f32 v[78:79], v[134:135], v[86:87], v[102:103]
    v_cvt_pk_bf16_f32 v92, v72, v73
    v_cvt_pk_bf16_f32 v93, v74, v75
    v_cvt_pk_bf16_f32 v94, v76, v77
    v_cvt_pk_bf16_f32 v95, v78, v79
    buffer_store_dwordx4 v[92:95], v1, s[52:55], s11 offen sc1
    v_pk_fma_f32 v[120:121], v[64:65], v[12:13], v[120:121] op_sel:[0,0,0] op_sel_hi:[1,0,1]
    v_pk_fma_f32 v[122:123], v[66:67], v[12:13], v[122:123] op_sel:[0,0,0] op_sel_hi:[1,0,1]
    v_pk_fma_f32 v[124:125], v[68:69], v[12:13], v[124:125] op_sel:[0,0,0] op_sel_hi:[1,0,1]
    v_pk_fma_f32 v[126:127], v[70:71], v[12:13], v[126:127] op_sel:[0,0,0] op_sel_hi:[1,0,1]
    v_pk_fma_f32 v[128:129], v[72:73], v[12:13], v[128:129] op_sel:[0,1,0] op_sel_hi:[1,1,1]
    v_pk_fma_f32 v[130:131], v[74:75], v[12:13], v[130:131] op_sel:[0,1,0] op_sel_hi:[1,1,1]
    v_pk_fma_f32 v[132:133], v[76:77], v[12:13], v[132:133] op_sel:[0,1,0] op_sel_hi:[1,1,1]
    v_pk_fma_f32 v[134:135], v[78:79], v[12:13], v[134:135] op_sel:[0,1,0] op_sel_hi:[1,1,1]
    ds_write_b128 v1, v[114:117] offset:0
    v_alignbit_b32 v104, v115, v114, 16
    v_alignbit_b32 v105, v116, v115, 16
    v_alignbit_b32 v106, v117, v116, 16
    v_alignbit_b32 v107, v118, v117, 16
    ds_write_b128 v1, v[104:107] offset:4160
    v_mov_b32 v100, v115
    v_mov_b32 v101, v116
    v_mov_b32 v102, v117
    v_mov_b32 v103, v118
    ds_write_b128 v1, v[100:103] offset:8320
    v_alignbit_b32 v96, v116, v115, 16
    v_alignbit_b32 v97, v117, v116, 16
    v_alignbit_b32 v98, v118, v117, 16
    v_alignbit_b32 v99, v119, v118, 16
    ds_write_b128 v1, v[96:99] offset:12480
    ds_write_b128 v1, v[108:111] offset:16640
    v_alignbit_b32 v104, v109, v108, 16
    v_alignbit_b32 v105, v110, v109, 16
    v_alignbit_b32 v106, v111, v110, 16
    v_alignbit_b32 v107, v112, v111, 16
    ds_write_b128 v1, v[104:107] offset:20800
    v_mov_b32 v100, v109
    v_mov_b32 v101, v110
    v_mov_b32 v102, v111
    v_mov_b32 v103, v112
    ds_write_b128 v1, v[100:103] offset:24960
    v_alignbit_b32 v96, v110, v109, 16
    v_alignbit_b32 v97, v111, v110, 16
    v_alignbit_b32 v98, v112, v111, 16
    v_alignbit_b32 v99, v113, v112, 16
    ds_write_b128 v1, v[96:99] offset:29120
    v_lshrrev_b32_e64 v12, 1, v0
    v_mul_u32_u24 v96, 8320, v12
    v_and_b32_e64 v12, 1, v0
    v_lshl_add_u32 v96, v12, 4, v96
    s_lshl_b32 s8, s34, 5
    s_add_u32 s8, s8, 11796480
    s_add_u32 s9, s8, 1064960
    s_lshr_b32 s39, s3, 1
    s_andn2_b32 s40, 1, s3
    s_lshl_b32 s40, s40, 8
    v_and_b32_e64 v99, 1, v0
    v_mul_u32_u24 v97, 4664, v99
    v_lshl_add_u32 v97, v0, 3, v97
    s_mul_i32 s41, s39, 16640
    s_add_u32 s41, s41, s40
    v_not_b32 v4, v0
    v_and_b32 v99, 12, v4
    v_and_b32 v4, 3, v4
    v_mul_u32_u24 v2, 4160, v4
    v_lshl_add_u32 v2, v99, 1, v2
    v_and_b32_e64 v99, 48, v0
    v_add3_u32 v2, v2, v99, s41
    s_mul_i32 s41, s39, 4672
    s_add_u32 s41, s41, s40
    v_and_b32 v4, 15, v0
    v_lshl_add_u32 v3, v4, 5, v99
    v_add_u32 v3, s41, v3
    v_lshrrev_b32 v5, 1, v99
    v_sub_u32 v5, v2, v5
    s_and_b32 s41, s3, 1
    s_mul_i32 s41, s41, 240
    v_add_u32_e64 v10, s41, v3
    s_mul_i32 s7, s39, 18448
    s_and_b32 s41, s3, 1
    s_mul_i32 s41, s41, 9216
    s_add_u32 s7, s7, s41
    s_mul_i32 s41, s3, 1152
    v_bfe_u32 v99, v0, 2, 2
    v_lshl_add_u32 v4, v99, 8, s41
    v_bfe_u32 v99, v0, 3, 1
    v_lshl_add_u32 v4, v99, 7, v4
    v_bfe_u32 v99, v0, 4, 2
    v_lshl_add_u32 v4, v99, 6, v4
    v_bfe_u32 v99, v0, 1, 1
    v_lshl_add_u32 v4, v99, 5, v4
    v_and_b32_e64 v99, 1, v0
    v_mul_u32_u24 v99, 18448, v99
    v_add_u32_e64 v4, v4, v99
    s_add_u32 s10, s46, 14155776
    s_add_u32 s11, s10, 4096
    s_nop 0
    s_waitcnt vmcnt(0)
    s_waitcnt lgkmcnt(0)
    s_barrier
    buffer_load_dwordx4 v[88:91], v96, s[52:55], s8 offen sc1
    buffer_load_dwordx4 v[92:95], v96, s[52:55], s9 offen sc1
    ds_read_b64 v[64:65], v2 offset:984
    ds_read_b64 v[66:67], v2 offset:992
    ds_read_b64 v[60:61], v2 offset:912
    ds_read_b64 v[62:63], v2 offset:920
    ds_read_b64 v[56:57], v2 offset:832
    ds_read_b64 v[58:59], v2 offset:840
    ds_read_b64 v[52:53], v2 offset:1728
    ds_read_b64 v[54:55], v2 offset:1736
    ds_read_b64 v[48:49], v2 offset:2752
    ds_read_b64 v[50:51], v2 offset:2760
    ds_read_b64 v[44:45], v2 offset:3264
    ds_read_b64 v[46:47], v2 offset:3272
    ds_read_b64 v[40:41], v2 offset:3776
    ds_read_b64 v[42:43], v2 offset:3784
    ds_read_b64 v[36:37], v5 offset:2400
    ds_read_b64 v[38:39], v5 offset:2272
    ds_read_b64 v[32:33], v5 offset:2368
    ds_read_b64 v[34:35], v5 offset:2240
    ds_read_b64 v[28:29], v5 offset:2336
    ds_read_b64 v[30:31], v5 offset:2208
    s_waitcnt vmcnt(1)
    v_max3_u32 v98, v88, v89, v90
    v_cmp_u_f32_e64 vcc, v98, v91
    s_cbranch_vccnz interleave_layers__ssm_conv_s4d__mixer_token_mlp__prompt_kernel_gretry176
interleave_layers__ssm_conv_s4d__mixer_token_mlp__prompt_kernel_gok177:
    ds_write_b128 v97, v[88:91] offset:37504
    s_waitcnt vmcnt(0)
    v_max3_u32 v98, v92, v93, v94
    v_cmp_u_f32_e64 vcc, v98, v95
    s_cbranch_vccnz interleave_layers__ssm_conv_s4d__mixer_token_mlp__prompt_kernel_gretry181
interleave_layers__ssm_conv_s4d__mixer_token_mlp__prompt_kernel_gok182:
    ds_write_b128 v97, v[92:95] offset:39552
    s_waitcnt lgkmcnt(0)
    s_barrier
    ds_read_b128 v[24:27], v10 offset:37216
    ds_read_b128 v[20:23], v3 offset:37216
    ds_read_b128 v[16:19], v10 offset:37728
    ds_read_b128 v[140:143], v3 offset:37728
    s_waitcnt lgkmcnt(3)
    v_mfma_f32_16x16x32_bf16 v[84:87], v[24:27], v[64:67], 0
    v_lshrrev_b32 v11, 3, v0
    v_mfma_f32_16x16x32_bf16 v[80:83], v[24:27], v[60:63], 0
    v_lshlrev_b32_e64 v11, 22, v11
    v_mfma_f32_16x16x32_bf16 v[76:79], v[24:27], v[56:59], 0
    ds_read_b128 v[24:27], v10 offset:38240
    s_waitcnt lgkmcnt(3)
    v_mfma_f32_16x16x32_bf16 v[104:107], v[20:23], v[52:55], 0
    v_cvt_pk_bf16_f32 v84, v84, v85
    v_cvt_pk_bf16_f32 v85, v86, v87
    v_mfma_f32_16x16x32_bf16 v[96:99], v[20:23], v[48:51], 0
    v_cvt_pk_bf16_f32 v86, v80, v81
    v_cvt_pk_bf16_f32 v87, v82, v83
    v_mfma_f32_16x16x32_bf16 v[92:95], v[20:23], v[44:47], 0
    v_cvt_pk_bf16_f32 v76, v76, v77
    v_cvt_pk_bf16_f32 v77, v78, v79
    v_mfma_f32_16x16x32_bf16 v[88:91], v[20:23], v[40:43], 0
    ds_read_b128 v[20:23], v3 offset:38240
    v_mfma_f32_16x16x32_bf16 v[96:99], v[36:39], v[84:87], v[96:99]
    v_add_lshl_u32 v11, v11, v0, 3
    v_mfma_f32_16x16x32_bf16 v[100:103], v[32:35], v[84:87], 0
    s_lshl_b32 s49, s34, 6
    v_mfma_f32_16x16x32_bf16 v[104:107], v[28:31], v[84:87], v[104:107]
    s_add_u32 s49, s49, 21233664
    s_waitcnt lgkmcnt(3)
    v_mfma_f32_16x16x32_bf16 v[72:75], v[16:19], v[64:67], 0
    buffer_store_dwordx2 v[136:137], v11, s[52:55], s49 offen sc1
    v_mfma_f32_16x16x32_bf16 v[68:71], v[16:19], v[60:63], 0
    s_add_u32 s49, s47, 16515072
    v_mfma_f32_16x16x32_bf16 v[80:83], v[16:19], v[56:59], 0
    ds_read_b128 v[16:19], v10 offset:38752
    s_waitcnt lgkmcnt(3)
    v_mfma_f32_16x16x32_bf16 v[108:111], v[140:143], v[52:55], 0
    v_cvt_pk_bf16_f32 v72, v72, v73
    v_cvt_pk_bf16_f32 v73, v74, v75
    v_mfma_f32_16x16x32_bf16 v[100:103], v[140:143], v[48:51], v[100:103]
    v_cvt_pk_bf16_f32 v74, v68, v69
    v_cvt_pk_bf16_f32 v75, v70, v71
    v_mfma_f32_16x16x32_bf16 v[96:99], v[140:143], v[44:47], v[96:99]
    v_cvt_pk_bf16_f32 v78, v80, v81
    v_cvt_pk_bf16_f32 v79, v82, v83
    v_mfma_f32_16x16x32_bf16 v[92:95], v[140:143], v[40:43], v[92:95]
    ds_read_b128 v[140:143], v3 offset:38752
    v_mfma_f32_16x16x32_bf16 v[100:103], v[36:39], v[72:75], v[100:103]
    buffer_store_dwordx4 v[136:139], v1, s[52:55], s49 offen sc1
    v_mfma_f32_16x16x32_bf16 v[104:107], v[32:35], v[72:75], v[104:107]
    s_add_u32 s49, s47, 16519168
    v_mfma_f32_16x16x32_bf16 v[108:111], v[28:31], v[72:75], v[108:111]
    s_waitcnt lgkmcnt(3)
    v_mfma_f32_16x16x32_bf16 v[84:87], v[24:27], v[64:67], 0
    v_mfma_f32_16x16x32_bf16 v[68:71], v[24:27], v[60:63], 0
    buffer_store_dwordx4 v[136:139], v1, s[52:55], s49 offen sc1
    v_mfma_f32_16x16x32_bf16 v[80:83], v[24:27], v[56:59], 0
    ds_read_b128 v[24:27], v10 offset:39264
    s_waitcnt lgkmcnt(3)
    v_mfma_f32_16x16x32_bf16 v[112:115], v[20:23], v[52:55], 0
    v_cvt_pk_bf16_f32 v84, v84, v85
    v_cvt_pk_bf16_f32 v85, v86, v87
    v_mfma_f32_16x16x32_bf16 v[104:107], v[20:23], v[48:51], v[104:107]
    v_cvt_pk_bf16_f32 v86, v68, v69
    v_cvt_pk_bf16_f32 v87, v70, v71
    v_mfma_f32_16x16x32_bf16 v[100:103], v[20:23], v[44:47], v[100:103]
    v_cvt_pk_bf16_f32 v80, v80, v81
    v_cvt_pk_bf16_f32 v81, v82, v83
    v_mfma_f32_16x16x32_bf16 v[96:99], v[20:23], v[40:43], v[96:99]
    ds_read_b128 v[20:23], v3 offset:39264
    v_mfma_f32_16x16x32_bf16 v[104:107], v[36:39], v[84:87], v[104:107]
    s_add_u32 s49, s47, 18874368
    v_mfma_f32_16x16x32_bf16 v[108:111], v[32:35], v[84:87], v[108:111]
    buffer_store_dwordx4 v[136:139], v1, s[52:55], s49 offen sc1
    v_mfma_f32_16x16x32_bf16 v[112:115], v[28:31], v[84:87], v[112:115]
    s_add_u32 s49, s47, 18878464
    s_waitcnt lgkmcnt(3)
    v_mfma_f32_16x16x32_bf16 v[72:75], v[16:19], v[64:67], 0
    v_mfma_f32_16x16x32_bf16 v[68:71], v[16:19], v[60:63], 0
    v_mfma_f32_16x16x32_bf16 v[84:87], v[16:19], v[56:59], 0
    ds_read_b64 v[16:17], v5 offset:1440
    ds_read_b64 v[18:19], v5 offset:1472
    s_waitcnt lgkmcnt(4)
    v_mfma_f32_16x16x32_bf16 v[116:119], v[140:143], v[52:55], 0
    v_cvt_pk_bf16_f32 v72, v72, v73
    v_cvt_pk_bf16_f32 v73, v74, v75
    v_mfma_f32_16x16x32_bf16 v[108:111], v[140:143], v[48:51], v[108:111]
    v_cvt_pk_bf16_f32 v74, v68, v69
    v_cvt_pk_bf16_f32 v75, v70, v71
    v_mfma_f32_16x16x32_bf16 v[104:107], v[140:143], v[44:47], v[104:107]
    v_cvt_pk_bf16_f32 v82, v84, v85
    v_cvt_pk_bf16_f32 v83, v86, v87
    v_mfma_f32_16x16x32_bf16 v[100:103], v[140:143], v[40:43], v[100:103]
    ds_read_b128 v[56:59], v10 offset:39776
    v_mfma_f32_16x16x32_bf16 v[108:111], v[36:39], v[72:75], v[108:111]
    ds_read_b128 v[52:55], v3 offset:39776
    v_mfma_f32_16x16x32_bf16 v[112:115], v[32:35], v[72:75], v[112:115]
    ds_read_b128 v[140:143], v3 offset:40288
    v_mfma_f32_16x16x32_bf16 v[116:119], v[28:31], v[72:75], v[116:119]
    ds_read_b64 v[28:29], v5 offset:1408
    ds_read_b64 v[30:31], v5 offset:1440
    s_waitcnt lgkmcnt(8)
    v_mfma_f32_16x16x32_bf16 v[68:71], v[24:27], v[64:67], 0
    ds_read_b128 v[72:75], v3 offset:40800
    v_mfma_f32_16x16x32_bf16 v[84:87], v[24:27], v[60:63], 0
    ds_read_b64 v[24:25], v5 offset:1376
    ds_read_b64 v[26:27], v5 offset:1408
    s_waitcnt lgkmcnt(10)
    v_mfma_f32_16x16x32_bf16 v[112:115], v[20:23], v[48:51], v[112:115]
    buffer_store_dwordx4 v[136:139], v1, s[52:55], s49 offen sc1
    v_mfma_f32_16x16x32_bf16 v[108:111], v[20:23], v[44:47], v[108:111]
    v_cvt_pk_bf16_f32 v68, v68, v69
    v_cvt_pk_bf16_f32 v69, v70, v71
    v_mfma_f32_16x16x32_bf16 v[104:107], v[20:23], v[40:43], v[104:107]
    v_cvt_pk_bf16_f32 v70, v84, v85
    v_cvt_pk_bf16_f32 v71, v86, v87
    s_waitcnt lgkmcnt(8)
    v_mfma_f32_16x16x32_bf16 v[104:107], v[16:19], v[76:79], v[104:107]
    ds_read_b64 v[20:21], v5 offset:1344
    ds_read_b64 v[22:23], v5 offset:1376
    v_mfma_f32_16x16x32_bf16 v[112:115], v[36:39], v[68:71], v[112:115]
    v_mfma_f32_16x16x32_bf16 v[116:119], v[32:35], v[68:71], v[116:119]
    ds_read_b128 v[32:35], v3 offset:37152
    s_waitcnt lgkmcnt(10)
    v_mfma_f32_16x16x32_bf16 v[84:87], v[56:59], v[64:67], 0
    ds_read_b64 v[64:65], v2 offset:3200
    ds_read_b64 v[66:67], v2 offset:3208
    v_mfma_f32_16x16x32_bf16 v[68:71], v[56:59], v[60:63], 0
    ds_read_b64 v[56:57], v2 offset:3712
    ds_read_b64 v[58:59], v2 offset:3720
    s_waitcnt lgkmcnt(13)
    v_mfma_f32_16x16x32_bf16 v[116:119], v[52:55], v[48:51], v[116:119]
    ds_read_b128 v[60:63], v3 offset:37088
    v_mfma_f32_16x16x32_bf16 v[112:115], v[52:55], v[44:47], v[112:115]
    v_cvt_pk_bf16_f32 v84, v84, v85
    v_cvt_pk_bf16_f32 v85, v86, v87
    v_mfma_f32_16x16x32_bf16 v[108:111], v[52:55], v[40:43], v[108:111]
    v_cvt_pk_bf16_f32 v86, v68, v69
    v_cvt_pk_bf16_f32 v87, v70, v71
    v_mfma_f32_16x16x32_bf16 v[112:115], v[16:19], v[80:83], v[112:115]
    ds_read_b64 v[48:49], v2 offset:3136
    ds_read_b64 v[50:51], v2 offset:3144
    v_mfma_f32_16x16x32_bf16 v[116:119], v[36:39], v[84:87], v[116:119]
    ds_read_b64 v[52:53], v2 offset:3648
    ds_read_b64 v[54:55], v2 offset:3656
    s_waitcnt lgkmcnt(15)
    v_mfma_f32_16x16x32_bf16 v[116:119], v[140:143], v[44:47], v[116:119]
    ds_read_b128 v[68:71], v3 offset:37024
    v_mfma_f32_16x16x32_bf16 v[112:115], v[140:143], v[40:43], v[112:115]
    ds_read_b64 v[16:17], v2 offset:3072
    ds_read_b64 v[18:19], v2 offset:3080
    v_mfma_f32_16x16x32_bf16 v[108:111], v[28:31], v[76:79], v[108:111]
    ds_read_b64 v[36:37], v2 offset:3584
    ds_read_b64 v[38:39], v2 offset:3592
    v_mfma_f32_16x16x32_bf16 v[116:119], v[28:31], v[80:83], v[116:119]
    ds_read_b128 v[84:87], v3 offset:37664
    s_waitcnt lgkmcnt(15)
    v_mfma_f32_16x16x32_bf16 v[116:119], v[72:75], v[40:43], v[116:119]
    ds_read_b128 v[44:47], v3 offset:37600
    v_mfma_f32_16x16x32_bf16 v[112:115], v[24:27], v[76:79], v[112:115]
    ds_read_b128 v[140:143], v3 offset:37536
    v_mfma_f32_16x16x32_bf16 v[116:119], v[20:23], v[76:79], v[116:119]
    ds_read_b128 v[28:31], v3 offset:38176
    s_waitcnt lgkmcnt(15)
    v_mfma_f32_16x16x32_bf16 v[92:95], v[32:35], v[64:67], v[92:95]
    ds_read_b128 v[80:83], v3 offset:38112
    s_waitcnt lgkmcnt(15)
    v_mfma_f32_16x16x32_bf16 v[88:91], v[32:35], v[56:59], v[88:91]
    ds_read_b128 v[72:75], v3 offset:38048
    s_waitcnt lgkmcnt(13)
    v_mfma_f32_16x16x32_bf16 v[92:95], v[60:63], v[48:51], v[92:95]
    ds_read_b128 v[40:43], v3 offset:38688
    s_waitcnt lgkmcnt(12)
    v_mfma_f32_16x16x32_bf16 v[88:91], v[60:63], v[52:55], v[88:91]
    ds_read_b128 v[24:27], v3 offset:38624
    s_waitcnt lgkmcnt(10)
    v_mfma_f32_16x16x32_bf16 v[92:95], v[68:71], v[16:19], v[92:95]
    ds_read_b128 v[20:23], v3 offset:38560
    s_waitcnt lgkmcnt(9)
    v_mfma_f32_16x16x32_bf16 v[88:91], v[68:71], v[36:39], v[88:91]
    ds_read_b128 v[76:79], v3 offset:39200
    s_waitcnt lgkmcnt(9)
    v_mfma_f32_16x16x32_bf16 v[96:99], v[84:87], v[64:67], v[96:99]
    ds_read_b128 v[32:35], v3 offset:39136
    s_mov_b32 m0, s7
    s_barrier
    v_mfma_f32_16x16x32_bf16 v[92:95], v[84:87], v[56:59], v[92:95]
    ds_read_b128 v[60:63], v3 offset:39072
    s_waitcnt lgkmcnt(10)
    v_mfma_f32_16x16x32_bf16 v[96:99], v[44:47], v[48:51], v[96:99]
    ds_read_b128 v[68:71], v3 offset:39712
    ds_write_addtid_b32 v88 offset:0
    v_mfma_f32_16x16x32_bf16 v[92:95], v[44:47], v[52:55], v[92:95]
    ds_read_b128 v[84:87], v3 offset:39648
    ds_write_addtid_b32 v89 offset:256
    s_waitcnt lgkmcnt(13)
    v_mfma_f32_16x16x32_bf16 v[96:99], v[140:143], v[16:19], v[96:99]
    ds_read_b128 v[44:47], v3 offset:39584
    ds_write_addtid_b32 v90 offset:640
    v_mfma_f32_16x16x32_bf16 v[92:95], v[140:143], v[36:39], v[92:95]
    ds_read_b128 v[140:143], v3 offset:40224
    ds_write_addtid_b32 v91 offset:896
    s_waitcnt lgkmcnt(15)
    v_mfma_f32_16x16x32_bf16 v[100:103], v[28:31], v[64:67], v[100:103]
    v_mfma_f32_16x16x32_bf16 v[96:99], v[28:31], v[56:59], v[96:99]
    ds_read_b128 v[28:31], v3 offset:40160
    v_mfma_f32_16x16x32_bf16 v[100:103], v[80:83], v[48:51], v[100:103]
    ds_write_addtid_b32 v92 offset:1152
    v_mfma_f32_16x16x32_bf16 v[96:99], v[80:83], v[52:55], v[96:99]
    ds_read_b128 v[80:83], v3 offset:40096
    ds_write_addtid_b32 v93 offset:1408
    s_waitcnt lgkmcnt(15)
    v_mfma_f32_16x16x32_bf16 v[100:103], v[72:75], v[16:19], v[100:103]
    ds_write_addtid_b32 v94 offset:1792
    v_mfma_f32_16x16x32_bf16 v[96:99], v[72:75], v[36:39], v[96:99]
    ds_read_b128 v[72:75], v3 offset:40736
    ds_write_addtid_b32 v95 offset:2048
    v_mfma_f32_16x16x32_bf16 v[104:107], v[40:43], v[64:67], v[104:107]
    v_mfma_f32_16x16x32_bf16 v[100:103], v[40:43], v[56:59], v[100:103]
    ds_read_b128 v[40:43], v3 offset:40672
    v_mfma_f32_16x16x32_bf16 v[104:107], v[24:27], v[48:51], v[104:107]
    ds_write_addtid_b32 v96 offset:2304
    v_mfma_f32_16x16x32_bf16 v[100:103], v[24:27], v[52:55], v[100:103]
    ds_read_b128 v[24:27], v3 offset:40608
    ds_write_addtid_b32 v97 offset:2560
    v_mfma_f32_16x16x32_bf16 v[104:107], v[20:23], v[16:19], v[104:107]
    ds_write_addtid_b32 v98 offset:2944
    v_mfma_f32_16x16x32_bf16 v[100:103], v[20:23], v[36:39], v[100:103]
    ds_write_addtid_b32 v99 offset:3200
    s_waitcnt lgkmcnt(15)
    v_mfma_f32_16x16x32_bf16 v[108:111], v[76:79], v[64:67], v[108:111]
    v_mfma_f32_16x16x32_bf16 v[104:107], v[76:79], v[56:59], v[104:107]
    v_mfma_f32_16x16x32_bf16 v[108:111], v[32:35], v[48:51], v[108:111]
    ds_write_addtid_b32 v100 offset:3456
    v_mfma_f32_16x16x32_bf16 v[104:107], v[32:35], v[52:55], v[104:107]
    ds_write_addtid_b32 v101 offset:3712
    v_mfma_f32_16x16x32_bf16 v[108:111], v[60:63], v[16:19], v[108:111]
    ds_write_addtid_b32 v102 offset:4096
    v_mfma_f32_16x16x32_bf16 v[104:107], v[60:63], v[36:39], v[104:107]
    ds_write_addtid_b32 v103 offset:4352
    v_mfma_f32_16x16x32_bf16 v[112:115], v[68:71], v[64:67], v[112:115]
    v_mfma_f32_16x16x32_bf16 v[108:111], v[68:71], v[56:59], v[108:111]
    v_mfma_f32_16x16x32_bf16 v[112:115], v[84:87], v[48:51], v[112:115]
    ds_write_addtid_b32 v104 offset:4608
    v_mfma_f32_16x16x32_bf16 v[108:111], v[84:87], v[52:55], v[108:111]
    ds_write_addtid_b32 v105 offset:4864
    v_mfma_f32_16x16x32_bf16 v[112:115], v[44:47], v[16:19], v[112:115]
    ds_write_addtid_b32 v106 offset:5248
    v_mfma_f32_16x16x32_bf16 v[108:111], v[44:47], v[36:39], v[108:111]
    ds_write_addtid_b32 v107 offset:5504
    s_waitcnt lgkmcnt(15)
    v_mfma_f32_16x16x32_bf16 v[112:115], v[140:143], v[56:59], v[112:115]
    v_mfma_f32_16x16x32_bf16 v[112:115], v[28:31], v[52:55], v[112:115]
    v_mfma_f32_16x16x32_bf16 v[112:115], v[80:83], v[36:39], v[112:115]
    ds_write_addtid_b32 v108 offset:5760
    v_mfma_f32_16x16x32_bf16 v[116:119], v[140:143], v[64:67], v[116:119]
    ds_write_addtid_b32 v109 offset:6016
    v_mfma_f32_16x16x32_bf16 v[116:119], v[28:31], v[48:51], v[116:119]
    ds_write_addtid_b32 v110 offset:6400
    v_mfma_f32_16x16x32_bf16 v[116:119], v[80:83], v[16:19], v[116:119]
    ds_write_addtid_b32 v111 offset:6656
    s_waitcnt vmcnt(0)
    v_mfma_f32_16x16x32_bf16 v[116:119], v[72:75], v[56:59], v[116:119]
    ds_write_addtid_b32 v112 offset:6912
    ds_write_addtid_b32 v113 offset:7168
    s_waitcnt lgkmcnt(15)
    v_mfma_f32_16x16x32_bf16 v[116:119], v[40:43], v[52:55], v[116:119]
    ds_write_addtid_b32 v114 offset:7552
    ds_write_addtid_b32 v115 offset:7808
    v_mfma_f32_16x16x32_bf16 v[116:119], v[24:27], v[36:39], v[116:119]
    s_nop 7
    ds_write_addtid_b32 v116 offset:8064
    ds_write_addtid_b32 v117 offset:8320
    ds_write_addtid_b32 v118 offset:8704
    ds_write_addtid_b32 v119 offset:8960
    s_nop 0
    s_waitcnt lgkmcnt(0)
    s_barrier
    ds_read_b128 v[56:59], v4 offset:0
    ds_read_b128 v[64:67], v4 offset:9216
    ds_read_b128 v[60:63], v4 offset:16
    ds_read_b128 v[68:71], v4 offset:9232
    ds_read_b128 v[72:75], v4 offset:4608
    ds_read_b128 v[80:83], v4 offset:13824
    ds_read_b128 v[76:79], v4 offset:4624
    ds_read_b128 v[84:87], v4 offset:13840
    s_waitcnt lgkmcnt(6)
    v_pk_add_f32 v[56:57], v[56:57], v[64:65]
    v_pk_add_f32 v[58:59], v[58:59], v[66:67]
    v_cvt_pk_bf16_f32 v88, v56, v57
    v_cvt_pk_bf16_f32 v89, v58, v59
    s_waitcnt lgkmcnt(4)
    v_pk_add_f32 v[60:61], v[60:61], v[68:69]
    v_pk_add_f32 v[62:63], v[62:63], v[70:71]
    v_cvt_pk_bf16_f32 v90, v60, v61
    v_cvt_pk_bf16_f32 v91, v62, v63
    buffer_store_dwordx4 v[88:91], v1, s[52:55], s10 offen sc1
    s_waitcnt lgkmcnt(2)
    v_pk_add_f32 v[72:73], v[72:73], v[80:81]
    v_pk_add_f32 v[74:75], v[74:75], v[82:83]
    v_cvt_pk_bf16_f32 v92, v72, v73
    v_cvt_pk_bf16_f32 v93, v74, v75
    s_waitcnt lgkmcnt(0)
    v_pk_add_f32 v[76:77], v[76:77], v[84:85]
    v_pk_add_f32 v[78:79], v[78:79], v[86:87]
    v_cvt_pk_bf16_f32 v94, v76, v77
    v_cvt_pk_bf16_f32 v95, v78, v79
    buffer_store_dwordx4 v[92:95], v1, s[52:55], s11 offen sc1
    s_nop 0
    s_lshr_b32 s49, s2, 3
    s_lshl_b32 s49, s49, 11
    v_lshl_add_u32 v2, v0, 3, s49
    v_min_u32 v2, interleave_layers__ssm_conv_s4d__mixer_token_mlp__prompt_kernel_codeend-interleave_layers__ssm_conv_s4d__mixer_token_mlp__prompt_kernel_pc2-8, v2
    global_load_dword v2, v2, s[50:51]
    v_lshrrev_b32 v3, 1, v0
    v_mul_u32_u24 v106, 8320, v3
    v_and_b32_e64 v3, 1, v0
    v_lshl_add_u32 v106, v3, 4, v106
    s_lshl_b32 s10, s34, 5
    s_add_u32 s10, s10, 14155776
    s_add_u32 s11, s10, 1064960
    v_and_b32 v108, 60, v0
    v_add_lshl_u32 v108, v108, s3, 2
    v_and_b32 v109, 0x70, v1
    v_lshrrev_b32_e64 v104, 5, v0
    v_and_b32 v105, 0x1f0, v1
    v_lshl_add_u32 v105, v104, 18, v105
    s_lshl_b32 s8, s34, 9
    s_add_u32 s8, s8, 16515072
    s_add_u32 s9, s8, 131072
    v_and_b32_e64 v104, 7, v0
    s_lshl_b32 s39, s34, 4
    v_lshl_add_u32 v104, v104, 1, s39
    v_mov_b32_e64 v141, 0
    global_load_short_d16_hi v141, v104, s[26:27]
    s_waitcnt vmcnt(2)
    s_barrier
    buffer_load_dwordx4 v[112:115], v106, s[52:55], s10 offen sc1
    buffer_load_dwordx4 v[116:119], v106, s[52:55], s11 offen sc1
    s_waitcnt vmcnt(1)
    v_max3_u32 v107, v112, v113, v114
    v_cmp_u_f32_e64 vcc, v107, v115
    s_cbranch_vccnz interleave_layers__ssm_conv_s4d__mixer_token_mlp__prompt_kernel_gretry185
interleave_layers__ssm_conv_s4d__mixer_token_mlp__prompt_kernel_gok186:
    v_dot2c_f32_bf16 v120, s18, v112
    v_dot2c_f32_bf16 v121, s19, v112
    v_dot2c_f32_bf16 v122, s18, v113
    v_dot2c_f32_bf16 v123, s19, v113
    v_dot2c_f32_bf16 v124, s18, v114
    v_dot2c_f32_bf16 v125, s19, v114
    v_dot2c_f32_bf16 v126, s18, v115
    v_dot2c_f32_bf16 v127, s19, v115
    v_pk_mul_f32 v[96:97], v[120:121], v[120:121]
    v_pk_mul_f32 v[98:99], v[122:123], v[122:123]
    v_pk_mul_f32 v[100:101], v[124:125], v[124:125]
    v_pk_mul_f32 v[102:103], v[126:127], v[126:127]
    s_waitcnt vmcnt(0)
    v_max3_u32 v107, v116, v117, v118
    v_cmp_u_f32_e64 vcc, v107, v119
    s_cbranch_vccnz interleave_layers__ssm_conv_s4d__mixer_token_mlp__prompt_kernel_gretry190
interleave_layers__ssm_conv_s4d__mixer_token_mlp__prompt_kernel_gok191:
    v_dot2c_f32_bf16 v128, s18, v116
    v_dot2c_f32_bf16 v129, s19, v116
    v_dot2c_f32_bf16 v130, s18, v117
    v_dot2c_f32_bf16 v131, s19, v117
    v_dot2c_f32_bf16 v132, s18, v118
    v_dot2c_f32_bf16 v133, s19, v118
    v_dot2c_f32_bf16 v134, s18, v119
    v_dot2c_f32_bf16 v135, s19, v119
    v_pk_add_f32 v[88:89], v[120:121], v[128:129]
    v_pk_add_f32 v[90:91], v[122:123], v[130:131]
    v_pk_add_f32 v[92:93], v[124:125], v[132:133]
    v_pk_add_f32 v[94:95], v[126:127], v[134:135]
    v_pk_fma_f32 v[96:97], v[128:129], v[128:129], v[96:97]
    v_pk_fma_f32 v[98:99], v[130:131], v[130:131], v[98:99]
    v_pk_fma_f32 v[100:101], v[132:133], v[132:133], v[100:101]
    v_pk_fma_f32 v[102:103], v[134:135], v[134:135], v[102:103]
    v_permlane32_swap_b32 v88, v96
    v_permlane32_swap_b32 v89, v97
    v_permlane32_swap_b32 v90, v98
    v_permlane32_swap_b32 v91, v99
    v_permlane32_swap_b32 v92, v100
    v_permlane32_swap_b32 v93, v101
    v_permlane32_swap_b32 v94, v102
    v_permlane32_swap_b32 v95, v103
    v_pk_add_f32 v[88:89], v[88:89], v[96:97]
    v_pk_add_f32 v[92:93], v[92:93], v[100:101]
    v_pk_add_f32 v[90:91], v[90:91], v[98:99]
    v_pk_add_f32 v[94:95], v[94:95], v[102:103]
    v_permlane16_swap_b32 v88, v92
    v_permlane16_swap_b32 v89, v93
    v_permlane16_swap_b32 v90, v94
    v_permlane16_swap_b32 v91, v95
    v_pk_add_f32 v[88:89], v[88:89], v[92:93]
    v_pk_add_f32 v[90:91], v[90:91], v[94:95]
    s_nop 0
    v_add_f32_dpp v96, v88, v88 row_ror:8 row_mask:0xf bank_mask:0x3
    v_add_f32_dpp v97, v89, v89 row_ror:8 row_mask:0xf bank_mask:0x3
    s_nop 0
    v_add_f32_dpp v96, v90, v90 row_ror:8 row_mask:0xf bank_mask:0xc
    v_add_f32_dpp v97, v91, v91 row_ror:8 row_mask:0xf bank_mask:0xc
    s_nop 0
    v_add_f32_dpp v88, v96, v96 row_shl:4 row_mask:0xf bank_mask:0x5
    s_nop 1
    v_add_f32_dpp v88, v97, v97 row_shr:4 row_mask:0xf bank_mask:0xa
    s_nop 1
    v_add_f32_dpp v88, v88, v88 quad_perm:[1,0,3,2] row_mask:0xf bank_mask:0xf
    s_nop 1
    v_add_f32_dpp v88, v88, v88 quad_perm:[2,3,0,1] row_mask:0xf bank_mask:0xf
    ds_write_b32 v108, v88 offset:46592
    v_mov_b32 v95, v95
    v_mov_b32 v95, v95
    v_mov_b32 v95, v95
    v_mov_b32 v95, v95
    s_waitcnt lgkmcnt(0)
    s_barrier
    ds_read_b128 v[88:91], v109 offset:46592
    ds_read_b128 v[96:99], v109 offset:46720
    v_mov_b32 v95, v95
    v_mov_b32 v95, v95
    v_mov_b32 v95, v95
    v_mov_b32 v95, v95
    v_mov_b32_e64 v95, v95
    v_mov_b32 v95, v95
    s_waitcnt lgkmcnt(0)
    v_pk_add_f32 v[88:89], v[88:89], v[90:91]
    v_pk_add_f32 v[96:97], v[96:97], v[98:99]
    v_add_f32 v137, v88, v89
    v_add_f32 v73, v96, v97
    v_mul_f32 v137, 0x3b000000, v137
    v_mul_f32 v73, 0x3b000000, v73
    v_fma_f32 v73, -v137, v137, v73
    v_max_f32_e64 v73, 0, v73
    v_add_f32 v138, 0x3727c5ac, v73
    v_fmamk_f32 v138, v138, 0x3727c5ac, v73
    v_rsq_f32 v139, v138
    s_nop 0
    v_mul_f32 v72, -v137, v139
    v_mov_b32_dpp v88, v139 row_newbcast:0 row_mask:0xf bank_mask:0xf
    v_mov_b32_dpp v89, v139 row_newbcast:1 row_mask:0xf bank_mask:0xf
    v_mov_b32_dpp v90, v139 row_newbcast:2 row_mask:0xf bank_mask:0xf
    v_mov_b32_dpp v91, v139 row_newbcast:3 row_mask:0xf bank_mask:0xf
    v_mov_b32_dpp v92, v139 row_newbcast:4 row_mask:0xf bank_mask:0xf
    v_mov_b32_dpp v93, v139 row_newbcast:5 row_mask:0xf bank_mask:0xf
    v_mov_b32_dpp v94, v139 row_newbcast:6 row_mask:0xf bank_mask:0xf
    v_mov_b32_dpp v95, v139 row_newbcast:7 row_mask:0xf bank_mask:0xf
    v_mov_b32_dpp v96, v72 row_newbcast:0 row_mask:0xf bank_mask:0xf
    v_mov_b32_dpp v97, v72 row_newbcast:1 row_mask:0xf bank_mask:0xf
    v_mov_b32_dpp v98, v72 row_newbcast:2 row_mask:0xf bank_mask:0xf
    v_mov_b32_dpp v99, v72 row_newbcast:3 row_mask:0xf bank_mask:0xf
    v_mov_b32_dpp v100, v72 row_newbcast:4 row_mask:0xf bank_mask:0xf
    v_mov_b32_dpp v101, v72 row_newbcast:5 row_mask:0xf bank_mask:0xf
    v_mov_b32_dpp v102, v72 row_newbcast:6 row_mask:0xf bank_mask:0xf
    v_mov_b32_dpp v103, v72 row_newbcast:7 row_mask:0xf bank_mask:0xf
    v_pk_fma_f32 v[72:73], v[120:121], v[88:89], v[96:97]
    v_pk_fma_f32 v[74:75], v[122:123], v[90:91], v[98:99]
    v_pk_fma_f32 v[76:77], v[124:125], v[92:93], v[100:101]
    v_pk_fma_f32 v[78:79], v[126:127], v[94:95], v[102:103]
    v_cvt_pk_bf16_f32 v112, v72, v73
    v_cvt_pk_bf16_f32 v113, v74, v75
    v_cvt_pk_bf16_f32 v114, v76, v77
    v_cvt_pk_bf16_f32 v115, v78, v79
    buffer_store_dwordx4 v[112:115], v105, s[52:55], s8 offen sc1
    v_pk_fma_f32 v[80:81], v[128:129], v[88:89], v[96:97]
    v_pk_fma_f32 v[82:83], v[130:131], v[90:91], v[98:99]
    v_pk_fma_f32 v[84:85], v[132:133], v[92:93], v[100:101]
    v_pk_fma_f32 v[86:87], v[134:135], v[94:95], v[102:103]
    v_cvt_pk_bf16_f32 v116, v80, v81
    v_cvt_pk_bf16_f32 v117, v82, v83
    v_cvt_pk_bf16_f32 v118, v84, v85
    v_cvt_pk_bf16_f32 v119, v86, v87
    buffer_store_dwordx4 v[116:119], v105, s[52:55], s9 offen sc1
    v_mul_f32 v136, v138, v139
    v_add_f32 v137, v137, v141
    v_lshrrev_b32 v140, 3, v0
    v_lshlrev_b32 v140, 22, v140
    v_add_lshl_u32 v140, v140, v0, 3
    s_lshl_b32 s39, s34, 6
    s_add_u32 s39, s39, 21233664
    buffer_store_dwordx2 v[136:137], v140, s[52:55], s39 offen sc1
    s_nop 0
    v_and_b32 v4, 63, v0
    v_lshrrev_b32 v24, 4, v4
    v_and_b32_e64 v25, 15, v4
    s_lshr_b32 s39, s3, 1
    s_lshl_b32 s39, s39, 6
    s_lshl_b32 s40, s36, 7
    s_add_u32 s39, s39, s40
    v_lshl_add_u32 v5, v24, 3, s39
    global_load_dwordx2 v[16:17], v5, s[22:23] offset:0
    global_load_dwordx2 v[18:19], v5, s[22:23] offset:32
    s_xor_b32 s76, s3, 0
    s_mul_i32 s76, s76, 6144
    s_xor_b32 s77, s3, 1
    s_mul_i32 s77, s77, 6144
    s_xor_b32 s78, s3, 2
    s_mul_i32 s78, s78, 6144
    s_xor_b32 s79, s3, 3
    s_mul_i32 s79, s79, 6144
    s_and_b32 s41, s3, 1
    s_lshl_b32 s40, s41, 8
    v_lshl_add_u32 v10, v4, 2, s76
    v_lshl_add_u32 v2, v25, 4, s40
    v_lshl_add_u32 v2, v24, 9, v2
    v_xor_b32 v3, 0x100, v2
    s_lshl_b32 s87, s3, 11
    s_add_u32 s87, s87, 24576
    v_and_b32 v12, 0x3c, v4
    v_lshl_add_u32 v12, v12, 2, s87
    v_bfe_u32 v32, v4, 1, 1
    v_lshl_add_u32 v12, v32, 8, v12
    v_and_b32_e64 v32, 1, v4
    v_lshl_add_u32 v12, v32, 3, v12
    s_lshl_b32 s39, s37, 1
    s_lshr_b32 s40, s3, 1
    s_add_u32 s39, s39, s40
    s_lshl_b32 s88, s39, 8
    s_add_u32 s88, s88, 21233664
    s_lshl_b32 s39, s39, 11
    s_lshl_b32 s40, s35, 18
    s_add_u32 s39, s39, s40
    s_add_u32 s84, s39, 16515072
    s_add_u32 s85, s84, 130048
    v_mul_u32_u24 v11, 80, v25
    v_lshl_add_u32 v11, v24, 3, v11
    s_mul_i32 s86, s3, 2560
    v_add_u32 v11, s86, v11
    s_mov_b32 s56, s28
    s_mov_b32 s57, s29
    s_mov_b32 s58, 0x200000
    s_mov_b32 s59, 0x20000
    v_and_b32 v5, 15, v4
    v_lshlrev_b32 v5, 2, v5
    v_lshrrev_b64 v[26:27], v5, s[64:65]
    v_lshrrev_b64 v[28:29], v5, s[66:67]
    v_cmp_gt_u32 vcc, 32, v4
    s_lshl_b32 s39, s35, 18
    s_lshl_b32 s40, s3, 15
    s_add_u32 s39, s39, s40
    s_add_u32 s39, s39, 16515072
    s_mul_i32 s41, s35, 229376
    s_add_u32 s41, s41, 18874368
    s_mul_i32 s40, s3, 28672
    s_add_u32 s40, s40, s41
    v_cndmask_b32 v26, v28, v26, vcc
    v_and_b32 v26, 15, v26
    v_mov_b32 v30, s39
    v_mov_b32 v27, s40
    v_cndmask_b32 v30, v27, v30, vcc
    v_mov_b32 v31, 131072
    v_mov_b32 v27, 114688
    v_cndmask_b32_e64 v31, v27, v31, vcc
    v_bfe_u32 v5, v4, 4, 1
    v_mad_u32_u24 v30, v31, v5, v30
    v_lshl_add_u32 v4, v26, 11, v30
    s_nop 0
    s_lshl_b32 s39, s36, 1
    s_lshr_b32 s40, s3, 1
    s_add_u32 s39, s39, s40
    s_lshl_b32 s39, s39, 11
    s_add_u32 s80, s39, s41
    s_add_u32 s81, s80, 114688
    s_mov_b32 s82, 0xbdd2d3e8
    s_mov_b32 s83, 0xbdd2d3e8
    v_mov_b32 v20, 0xc0135761
    v_mov_b32 v21, 0xc0135761
    v_readlane_b32 s7, v4, 0
    v_readlane_b32 s12, v4, 1
    v_readlane_b32 s13, v4, 2
    v_readlane_b32 s14, v4, 3
    v_readlane_b32 s15, v4, 4
    v_readlane_b32 s70, v4, 5
    s_waitcnt vmcnt(3)
    s_barrier
    buffer_load_dwordx4 v[68:71], v3, s[52:55], s7 offen sc1
    buffer_load_dwordx4 v[64:67], v2, s[52:55], s7 offen sc1
    buffer_load_dwordx4 v[60:63], v3, s[52:55], s12 offen sc1
    buffer_load_dwordx4 v[56:59], v2, s[52:55], s12 offen sc1
    buffer_load_dwordx4 v[52:55], v3, s[52:55], s13 offen sc1
    buffer_load_dwordx4 v[48:51], v2, s[52:55], s13 offen sc1
    buffer_load_dwordx4 v[44:47], v3, s[52:55], s14 offen sc1
    buffer_load_dwordx4 v[40:43], v2, s[52:55], s14 offen sc1
    buffer_load_dwordx4 v[36:39], v3, s[52:55], s15 offen sc1
    buffer_load_dwordx4 v[32:35], v2, s[52:55], s15 offen sc1
    s_waitcnt vmcnt(10)
    v_lshlrev_b32 v72, 16, v16
    v_and_b32 v73, 0xffff0000, v16
    v_lshlrev_b32_e64 v74, 16, v17
    v_and_b32 v75, 0xffff0000, v17
    v_lshlrev_b32_e64 v76, 16, v18
    v_and_b32 v77, 0xffff0000, v18
    v_lshlrev_b32_e64 v78, 16, v19
    v_and_b32 v79, 0xffff0000, v19
    v_lshlrev_b32_e64 v104, 16, v16
    v_and_b32 v105, 0xffff0000, v16
    v_lshlrev_b32_e64 v106, 16, v17
    v_and_b32 v107, 0xffff0000, v17
    v_lshlrev_b32_e64 v108, 16, v18
    v_and_b32 v109, 0xffff0000, v18
    v_lshlrev_b32_e64 v110, 16, v19
    v_and_b32 v111, 0xffff0000, v19
    s_cmp_ge_u32 s38, 7
    s_cbranch_scc1 interleave_layers__ssm_conv_s4d__mixer_token_mlp__prompt_kernel_g1idle206
    s_mov_b32 s43, 0
    s_waitcnt vmcnt(8)
    v_cmp_u_f32 vcc, v64, v68
    s_cbranch_vccnz interleave_layers__ssm_conv_s4d__mixer_token_mlp__prompt_kernel_rt214
interleave_layers__ssm_conv_s4d__mixer_token_mlp__prompt_kernel_ok215:
    v_mfma_f32_16x16x32_bf16 v[100:103], a[12:15], v[68:71], 0
    buffer_load_dwordx4 v[28:31], v3, s[52:55], s70 offen sc1
    v_mfma_f32_16x16x32_bf16 v[92:95], a[12:15], v[64:67], 0
    v_mfma_f32_16x16x32_bf16 v[96:99], a[8:11], v[68:71], 0
    buffer_load_dwordx4 v[24:27], v2, s[52:55], s70 offen sc1
    v_mfma_f32_16x16x32_bf16 v[88:91], a[8:11], v[64:67], 0
    v_mfma_f32_16x16x32_bf16 v[84:87], a[4:7], v[68:71], 0
    v_readlane_b32 s7, v4, 6
    v_mfma_f32_16x16x32_bf16 v[76:79], a[4:7], v[64:67], v[76:79]
    s_waitcnt vmcnt(8)
    v_cmp_u_f32 vcc, v56, v60
    v_mfma_f32_16x16x32_bf16 v[80:83], a[0:3], v[68:71], 0
    v_mfma_f32_16x16x32_bf16 v[72:75], a[0:3], v[64:67], v[72:75]
    s_nop 0
    s_cbranch_vccnz interleave_layers__ssm_conv_s4d__mixer_token_mlp__prompt_kernel_rt216
interleave_layers__ssm_conv_s4d__mixer_token_mlp__prompt_kernel_ok217:
    v_mfma_f32_16x16x32_bf16 v[100:103], a[28:31], v[60:63], v[100:103]
    buffer_load_dwordx4 v[68:71], v3, s[52:55], s7 offen sc1
    v_mfma_f32_16x16x32_bf16 v[92:95], a[28:31], v[56:59], v[92:95]
    v_mfma_f32_16x16x32_bf16 v[96:99], a[24:27], v[60:63], v[96:99]
    buffer_load_dwordx4 v[64:67], v2, s[52:55], s7 offen sc1
    v_mfma_f32_16x16x32_bf16 v[88:91], a[24:27], v[56:59], v[88:91]
    v_mfma_f32_16x16x32_bf16 v[84:87], a[20:23], v[60:63], v[84:87]
    v_readlane_b32 s12, v4, 7
    v_mfma_f32_16x16x32_bf16 v[76:79], a[20:23], v[56:59], v[76:79]
    s_waitcnt vmcnt(8)
    v_cmp_u_f32 vcc, v48, v52
    v_mfma_f32_16x16x32_bf16 v[80:83], a[16:19], v[60:63], v[80:83]
    v_mfma_f32_16x16x32_bf16 v[72:75], a[16:19], v[56:59], v[72:75]
    s_nop 0
    s_cbranch_vccnz interleave_layers__ssm_conv_s4d__mixer_token_mlp__prompt_kernel_rt218
interleave_layers__ssm_conv_s4d__mixer_token_mlp__prompt_kernel_ok219:
    v_mfma_f32_16x16x32_bf16 v[100:103], a[44:47], v[52:55], v[100:103]
    buffer_load_dwordx4 v[60:63], v3, s[52:55], s12 offen sc1
    v_mfma_f32_16x16x32_bf16 v[92:95], a[44:47], v[48:51], v[92:95]
    v_mfma_f32_16x16x32_bf16 v[96:99], a[40:43], v[52:55], v[96:99]
    buffer_load_dwordx4 v[56:59], v2, s[52:55], s12 offen sc1
    v_mfma_f32_16x16x32_bf16 v[88:91], a[40:43], v[48:51], v[88:91]
    v_mfma_f32_16x16x32_bf16 v[84:87], a[36:39], v[52:55], v[84:87]
    v_readlane_b32 s13, v4, 8
    v_mfma_f32_16x16x32_bf16 v[76:79], a[36:39], v[48:51], v[76:79]
    s_waitcnt vmcnt(8)
    v_cmp_u_f32 vcc, v40, v44
    v_mfma_f32_16x16x32_bf16 v[80:83], a[32:35], v[52:55], v[80:83]
    v_mfma_f32_16x16x32_bf16 v[72:75], a[32:35], v[48:51], v[72:75]
    s_nop 0
    s_cbranch_vccnz interleave_layers__ssm_conv_s4d__mixer_token_mlp__prompt_kernel_rt220
interleave_layers__ssm_conv_s4d__mixer_token_mlp__prompt_kernel_ok221:
    v_mfma_f32_16x16x32_bf16 v[100:103], a[60:63], v[44:47], v[100:103]
    buffer_load_dwordx4 v[52:55], v3, s[52:55], s13 offen sc1
    v_mfma_f32_16x16x32_bf16 v[92:95], a[60:63], v[40:43], v[92:95]
    v_mfma_f32_16x16x32_bf16 v[96:99], a[56:59], v[44:47], v[96:99]
    buffer_load_dwordx4 v[48:51], v2, s[52:55], s13 offen sc1
    v_mfma_f32_16x16x32_bf16 v[88:91], a[56:59], v[40:43], v[88:91]
    v_mfma_f32_16x16x32_bf16 v[84:87], a[52:55], v[44:47], v[84:87]
    v_readlane_b32 s14, v4, 9
    v_mfma_f32_16x16x32_bf16 v[76:79], a[52:55], v[40:43], v[76:79]
    s_waitcnt vmcnt(8)
    v_cmp_u_f32 vcc, v32, v36
    v_mfma_f32_16x16x32_bf16 v[80:83], a[48:51], v[44:47], v[80:83]
    v_mfma_f32_16x16x32_bf16 v[72:75], a[48:51], v[40:43], v[72:75]
    s_nop 0
    s_cbranch_vccnz interleave_layers__ssm_conv_s4d__mixer_token_mlp__prompt_kernel_rt222
interleave_layers__ssm_conv_s4d__mixer_token_mlp__prompt_kernel_ok223:
    v_mfma_f32_16x16x32_bf16 v[100:103], a[76:79], v[36:39], v[100:103]
    buffer_load_dwordx4 v[44:47], v3, s[52:55], s14 offen sc1
    v_mfma_f32_16x16x32_bf16 v[92:95], a[76:79], v[32:35], v[92:95]
    v_mfma_f32_16x16x32_bf16 v[96:99], a[72:75], v[36:39], v[96:99]
    buffer_load_dwordx4 v[40:43], v2, s[52:55], s14 offen sc1
    v_mfma_f32_16x16x32_bf16 v[88:91], a[72:75], v[32:35], v[88:91]
    v_mfma_f32_16x16x32_bf16 v[84:87], a[68:71], v[36:39], v[84:87]
    v_readlane_b32 s15, v4, 10
    v_mfma_f32_16x16x32_bf16 v[76:79], a[68:71], v[32:35], v[76:79]
    s_waitcnt vmcnt(8)
    v_cmp_u_f32 vcc, v24, v28
    v_mfma_f32_16x16x32_bf16 v[80:83], a[64:67], v[36:39], v[80:83]
    v_mfma_f32_16x16x32_bf16 v[72:75], a[64:67], v[32:35], v[72:75]
    s_nop 0
    s_cbranch_vccnz interleave_layers__ssm_conv_s4d__mixer_token_mlp__prompt_kernel_rt224
interleave_layers__ssm_conv_s4d__mixer_token_mlp__prompt_kernel_ok225:
    v_mfma_f32_16x16x32_bf16 v[100:103], a[92:95], v[28:31], v[100:103]
    buffer_load_dwordx4 v[36:39], v3, s[52:55], s15 offen sc1
    v_mfma_f32_16x16x32_bf16 v[92:95], a[92:95], v[24:27], v[92:95]
    v_mfma_f32_16x16x32_bf16 v[96:99], a[88:91], v[28:31], v[96:99]
    buffer_load_dwordx4 v[32:35], v2, s[52:55], s15 offen sc1
    v_mfma_f32_16x16x32_bf16 v[88:91], a[88:91], v[24:27], v[88:91]
    v_mfma_f32_16x16x32_bf16 v[84:87], a[84:87], v[28:31], v[84:87]
    v_readlane_b32 s70, v4, 11
    v_mfma_f32_16x16x32_bf16 v[76:79], a[84:87], v[24:27], v[76:79]
    s_waitcnt vmcnt(8)
    v_cmp_u_f32 vcc, v64, v68
    v_mfma_f32_16x16x32_bf16 v[80:83], a[80:83], v[28:31], v[80:83]
    v_mfma_f32_16x16x32_bf16 v[72:75], a[80:83], v[24:27], v[72:75]
    s_nop 0
    s_cbranch_vccnz interleave_layers__ssm_conv_s4d__mixer_token_mlp__prompt_kernel_rt226
interleave_layers__ssm_conv_s4d__mixer_token_mlp__prompt_kernel_ok227:
    v_mfma_f32_16x16x32_bf16 v[100:103], a[108:111], v[68:71], v[100:103]
    buffer_load_dwordx4 v[28:31], v3, s[52:55], s70 offen sc1
    v_mfma_f32_16x16x32_bf16 v[92:95], a[108:111], v[64:67], v[92:95]
    v_mfma_f32_16x16x32_bf16 v[96:99], a[104:107], v[68:71], v[96:99]
    buffer_load_dwordx4 v[24:27], v2, s[52:55], s70 offen sc1
    v_mfma_f32_16x16x32_bf16 v[88:91], a[104:107], v[64:67], v[88:91]
    v_mfma_f32_16x16x32_bf16 v[84:87], a[100:103], v[68:71], v[84:87]
    v_readlane_b32 s7, v4, 12
    v_mfma_f32_16x16x32_bf16 v[76:79], a[100:103], v[64:67], v[76:79]
    s_waitcnt vmcnt(8)
    v_cmp_u_f32 vcc, v56, v60
    v_mfma_f32_16x16x32_bf16 v[80:83], a[96:99], v[68:71], v[80:83]
    v_mfma_f32_16x16x32_bf16 v[72:75], a[96:99], v[64:67], v[72:75]
    s_nop 0
    s_cbranch_vccnz interleave_layers__ssm_conv_s4d__mixer_token_mlp__prompt_kernel_rt228
interleave_layers__ssm_conv_s4d__mixer_token_mlp__prompt_kernel_ok229:
    v_mfma_f32_16x16x32_bf16 v[100:103], a[124:127], v[60:63], v[100:103]
    buffer_load_dwordx4 v[68:71], v3, s[52:55], s7 offen sc1
    v_mfma_f32_16x16x32_bf16 v[92:95], a[124:127], v[56:59], v[92:95]
    v_mfma_f32_16x16x32_bf16 v[96:99], a[120:123], v[60:63], v[96:99]
    buffer_load_dwordx4 v[64:67], v2, s[52:55], s7 offen sc1
    v_mfma_f32_16x16x32_bf16 v[88:91], a[120:123], v[56:59], v[88:91]
    v_mfma_f32_16x16x32_bf16 v[84:87], a[116:119], v[60:63], v[84:87]
    v_readlane_b32 s12, v4, 13
    v_mfma_f32_16x16x32_bf16 v[76:79], a[116:119], v[56:59], v[76:79]
    s_waitcnt vmcnt(8)
    v_cmp_u_f32 vcc, v48, v52
    v_mfma_f32_16x16x32_bf16 v[80:83], a[112:115], v[60:63], v[80:83]
    v_mfma_f32_16x16x32_bf16 v[72:75], a[112:115], v[56:59], v[72:75]
    s_nop 0
    s_cbranch_vccnz interleave_layers__ssm_conv_s4d__mixer_token_mlp__prompt_kernel_rt230
interleave_layers__ssm_conv_s4d__mixer_token_mlp__prompt_kernel_ok231:
    v_mfma_f32_16x16x32_bf16 v[100:103], a[140:143], v[52:55], v[100:103]
    buffer_load_dwordx4 v[60:63], v3, s[52:55], s12 offen sc1
    v_mfma_f32_16x16x32_bf16 v[92:95], a[140:143], v[48:51], v[92:95]
    v_mfma_f32_16x16x32_bf16 v[96:99], a[136:139], v[52:55], v[96:99]
    buffer_load_dwordx4 v[56:59], v2, s[52:55], s12 offen sc1
    v_mfma_f32_16x16x32_bf16 v[88:91], a[136:139], v[48:51], v[88:91]
    v_mfma_f32_16x16x32_bf16 v[84:87], a[132:135], v[52:55], v[84:87]
    v_readlane_b32 s13, v4, 14
    v_mfma_f32_16x16x32_bf16 v[76:79], a[132:135], v[48:51], v[76:79]
    s_waitcnt vmcnt(8)
    v_cmp_u_f32 vcc, v40, v44
    v_mfma_f32_16x16x32_bf16 v[80:83], a[128:131], v[52:55], v[80:83]
    v_mfma_f32_16x16x32_bf16 v[72:75], a[128:131], v[48:51], v[72:75]
    s_nop 0
    s_cbranch_vccnz interleave_layers__ssm_conv_s4d__mixer_token_mlp__prompt_kernel_rt232
interleave_layers__ssm_conv_s4d__mixer_token_mlp__prompt_kernel_ok233:
    v_mfma_f32_16x16x32_bf16 v[100:103], a[156:159], v[44:47], v[100:103]
    buffer_load_dwordx4 v[52:55], v3, s[52:55], s13 offen sc1
    v_mfma_f32_16x16x32_bf16 v[92:95], a[156:159], v[40:43], v[92:95]
    v_mfma_f32_16x16x32_bf16 v[96:99], a[152:155], v[44:47], v[96:99]
    buffer_load_dwordx4 v[48:51], v2, s[52:55], s13 offen sc1
    v_mfma_f32_16x16x32_bf16 v[88:91], a[152:155], v[40:43], v[88:91]
    v_mfma_f32_16x16x32_bf16 v[84:87], a[148:151], v[44:47], v[84:87]
    v_readlane_b32 s14, v4, 15
    v_mfma_f32_16x16x32_bf16 v[76:79], a[148:151], v[40:43], v[76:79]
    s_waitcnt vmcnt(8)
    v_cmp_u_f32 vcc, v32, v36
    v_mfma_f32_16x16x32_bf16 v[80:83], a[144:147], v[44:47], v[80:83]
    v_mfma_f32_16x16x32_bf16 v[72:75], a[144:147], v[40:43], v[72:75]
    s_nop 0
    s_cbranch_vccnz interleave_layers__ssm_conv_s4d__mixer_token_mlp__prompt_kernel_rt234
interleave_layers__ssm_conv_s4d__mixer_token_mlp__prompt_kernel_ok235:
    v_mfma_f32_16x16x32_bf16 v[100:103], a[172:175], v[36:39], v[100:103]
    buffer_load_dwordx4 v[44:47], v3, s[52:55], s14 offen sc1
    v_mfma_f32_16x16x32_bf16 v[92:95], a[172:175], v[32:35], v[92:95]
    v_mfma_f32_16x16x32_bf16 v[96:99], a[168:171], v[36:39], v[96:99]
    buffer_load_dwordx4 v[40:43], v2, s[52:55], s14 offen sc1
    v_mfma_f32_16x16x32_bf16 v[88:91], a[168:171], v[32:35], v[88:91]
    v_mfma_f32_16x16x32_bf16 v[84:87], a[164:167], v[36:39], v[84:87]
    v_readlane_b32 s15, v4, 16
    v_mfma_f32_16x16x32_bf16 v[76:79], a[164:167], v[32:35], v[76:79]
    s_waitcnt vmcnt(8)
    v_cmp_u_f32 vcc, v24, v28
    v_mfma_f32_16x16x32_bf16 v[80:83], a[160:163], v[36:39], v[80:83]
    v_mfma_f32_16x16x32_bf16 v[72:75], a[160:163], v[32:35], v[72:75]
    s_nop 0
    s_cbranch_vccnz interleave_layers__ssm_conv_s4d__mixer_token_mlp__prompt_kernel_rt236
interleave_layers__ssm_conv_s4d__mixer_token_mlp__prompt_kernel_ok237:
    v_mfma_f32_16x16x32_bf16 v[100:103], a[188:191], v[28:31], v[100:103]
    buffer_load_dwordx4 v[36:39], v3, s[52:55], s15 offen sc1
    v_mfma_f32_16x16x32_bf16 v[92:95], a[188:191], v[24:27], v[92:95]
    v_mfma_f32_16x16x32_bf16 v[96:99], a[184:187], v[28:31], v[96:99]
    buffer_load_dwordx4 v[32:35], v2, s[52:55], s15 offen sc1
    v_mfma_f32_16x16x32_bf16 v[88:91], a[184:187], v[24:27], v[88:91]
    v_mfma_f32_16x16x32_bf16 v[84:87], a[180:183], v[28:31], v[84:87]
    v_readlane_b32 s70, v4, 17
    v_mfma_f32_16x16x32_bf16 v[76:79], a[180:183], v[24:27], v[76:79]
    s_waitcnt vmcnt(8)
    v_cmp_u_f32 vcc, v64, v68
    v_mfma_f32_16x16x32_bf16 v[80:83], a[176:179], v[28:31], v[80:83]
    v_mfma_f32_16x16x32_bf16 v[72:75], a[176:179], v[24:27], v[72:75]
    s_nop 0
    s_cbranch_vccnz interleave_layers__ssm_conv_s4d__mixer_token_mlp__prompt_kernel_rt238
interleave_layers__ssm_conv_s4d__mixer_token_mlp__prompt_kernel_ok239:
    v_mfma_f32_16x16x32_bf16 v[100:103], a[204:207], v[68:71], v[100:103]
    buffer_load_dwordx4 v[28:31], v3, s[52:55], s70 offen sc1
    v_mfma_f32_16x16x32_bf16 v[92:95], a[204:207], v[64:67], v[92:95]
    v_mfma_f32_16x16x32_bf16 v[96:99], a[200:203], v[68:71], v[96:99]
    buffer_load_dwordx4 v[24:27], v2, s[52:55], s70 offen sc1
    v_mfma_f32_16x16x32_bf16 v[88:91], a[200:203], v[64:67], v[88:91]
    v_mfma_f32_16x16x32_bf16 v[84:87], a[196:199], v[68:71], v[84:87]
    v_readlane_b32 s7, v4, 18
    v_mfma_f32_16x16x32_bf16 v[76:79], a[196:199], v[64:67], v[76:79]
    s_waitcnt vmcnt(8)
    v_cmp_u_f32 vcc, v56, v60
    v_mfma_f32_16x16x32_bf16 v[80:83], a[192:195], v[68:71], v[80:83]
    v_mfma_f32_16x16x32_bf16 v[72:75], a[192:195], v[64:67], v[72:75]
    s_nop 0
    s_cbranch_vccnz interleave_layers__ssm_conv_s4d__mixer_token_mlp__prompt_kernel_rt240
interleave_layers__ssm_conv_s4d__mixer_token_mlp__prompt_kernel_ok241:
    v_mfma_f32_16x16x32_bf16 v[100:103], a[220:223], v[60:63], v[100:103]
    buffer_load_dwordx4 v[68:71], v3, s[52:55], s7 offen sc1
    v_mfma_f32_16x16x32_bf16 v[92:95], a[220:223], v[56:59], v[92:95]
    v_mfma_f32_16x16x32_bf16 v[96:99], a[216:219], v[60:63], v[96:99]
    buffer_load_dwordx4 v[64:67], v2, s[52:55], s7 offen sc1
    v_mfma_f32_16x16x32_bf16 v[88:91], a[216:219], v[56:59], v[88:91]
    v_mfma_f32_16x16x32_bf16 v[84:87], a[212:215], v[60:63], v[84:87]
    v_readlane_b32 s12, v4, 19
    v_mfma_f32_16x16x32_bf16 v[76:79], a[212:215], v[56:59], v[76:79]
    s_waitcnt vmcnt(8)
    v_cmp_u_f32 vcc, v48, v52
    v_mfma_f32_16x16x32_bf16 v[80:83], a[208:211], v[60:63], v[80:83]
    v_mfma_f32_16x16x32_bf16 v[72:75], a[208:211], v[56:59], v[72:75]
    s_nop 0
    s_cbranch_vccnz interleave_layers__ssm_conv_s4d__mixer_token_mlp__prompt_kernel_rt242
interleave_layers__ssm_conv_s4d__mixer_token_mlp__prompt_kernel_ok243:
    v_mfma_f32_16x16x32_bf16 v[100:103], a[236:239], v[52:55], v[100:103]
    buffer_load_dwordx4 v[60:63], v3, s[52:55], s12 offen sc1
    v_mfma_f32_16x16x32_bf16 v[92:95], a[236:239], v[48:51], v[92:95]
    v_mfma_f32_16x16x32_bf16 v[96:99], a[232:235], v[52:55], v[96:99]
    buffer_load_dwordx4 v[56:59], v2, s[52:55], s12 offen sc1
    v_mfma_f32_16x16x32_bf16 v[88:91], a[232:235], v[48:51], v[88:91]
    v_mfma_f32_16x16x32_bf16 v[84:87], a[228:231], v[52:55], v[84:87]
    v_readlane_b32 s13, v4, 20
    v_mfma_f32_16x16x32_bf16 v[76:79], a[228:231], v[48:51], v[76:79]
    s_waitcnt vmcnt(8)
    v_cmp_u_f32 vcc, v40, v44
    v_mfma_f32_16x16x32_bf16 v[80:83], a[224:227], v[52:55], v[80:83]
    v_mfma_f32_16x16x32_bf16 v[72:75], a[224:227], v[48:51], v[72:75]
    s_nop 0
    s_cbranch_vccnz interleave_layers__ssm_conv_s4d__mixer_token_mlp__prompt_kernel_rt244
interleave_layers__ssm_conv_s4d__mixer_token_mlp__prompt_kernel_ok245:
    v_mfma_f32_16x16x32_bf16 v[100:103], a[252:255], v[44:47], v[100:103]
    buffer_load_dwordx4 v[52:55], v3, s[52:55], s13 offen sc1
    v_mfma_f32_16x16x32_bf16 v[92:95], a[252:255], v[40:43], v[92:95]
    v_mfma_f32_16x16x32_bf16 v[96:99], a[248:251], v[44:47], v[96:99]
    buffer_load_dwordx4 v[48:51], v2, s[52:55], s13 offen sc1
    v_mfma_f32_16x16x32_bf16 v[88:91], a[248:251], v[40:43], v[88:91]
    v_mfma_f32_16x16x32_bf16 v[84:87], a[244:247], v[44:47], v[84:87]
    v_readlane_b32 s14, v4, 21
    v_mfma_f32_16x16x32_bf16 v[76:79], a[244:247], v[40:43], v[76:79]
    s_waitcnt vmcnt(8)
    v_cmp_u_f32 vcc, v32, v36
    v_mfma_f32_16x16x32_bf16 v[80:83], a[240:243], v[44:47], v[80:83]
    v_mfma_f32_16x16x32_bf16 v[72:75], a[240:243], v[40:43], v[72:75]
    s_nop 0
    s_cbranch_vccnz interleave_layers__ssm_conv_s4d__mixer_token_mlp__prompt_kernel_rt246
interleave_layers__ssm_conv_s4d__mixer_token_mlp__prompt_kernel_ok247:
    v_mfma_f32_16x16x32_bf16 v[132:135], a[12:15], v[36:39], 0
    buffer_load_dwordx4 v[44:47], v3, s[52:55], s14 offen sc1
    v_mfma_f32_16x16x32_bf16 v[124:127], a[12:15], v[32:35], 0
    v_mfma_f32_16x16x32_bf16 v[128:131], a[8:11], v[36:39], 0
    buffer_load_dwordx4 v[40:43], v2, s[52:55], s14 offen sc1
    v_mfma_f32_16x16x32_bf16 v[120:123], a[8:11], v[32:35], 0
    s_barrier
    s_add_u32 m0, s79, 4096
    s_nop 0
    ds_write_addtid_b32 v96 offset:0
    v_mfma_f32_16x16x32_bf16 v[116:119], a[4:7], v[36:39], 0
    v_readlane_b32 s15, v4, 22
    ds_write_addtid_b32 v97 offset:256
    v_mfma_f32_16x16x32_bf16 v[108:111], a[4:7], v[32:35], v[108:111]
    s_waitcnt vmcnt(8)
    v_cmp_u_f32 vcc, v24, v28
    v_mfma_f32_16x16x32_bf16 v[112:115], a[0:3], v[36:39], 0
    ds_write_addtid_b32 v98 offset:512
    v_mfma_f32_16x16x32_bf16 v[104:107], a[0:3], v[32:35], v[104:107]
    s_nop 0
    s_cbranch_vccnz interleave_layers__ssm_conv_s4d__mixer_token_mlp__prompt_kernel_rt248
interleave_layers__ssm_conv_s4d__mixer_token_mlp__prompt_kernel_ok249:
    ds_write_addtid_b32 v99 offset:768
    v_mfma_f32_16x16x32_bf16 v[132:135], a[28:31], v[28:31], v[132:135]
    buffer_load_dwordx4 v[36:39], v3, s[52:55], s15 offen sc1
    ds_write_addtid_b32 v100 offset:1024
    v_mfma_f32_16x16x32_bf16 v[124:127], a[28:31], v[24:27], v[124:127]
    ds_write_addtid_b32 v101 offset:1280
    ds_write_addtid_b32 v102 offset:1536
    v_mfma_f32_16x16x32_bf16 v[128:131], a[24:27], v[28:31], v[128:131]
    buffer_load_dwordx4 v[32:35], v2, s[52:55], s15 offen sc1
    v_mfma_f32_16x16x32_bf16 v[120:123], a[24:27], v[24:27], v[120:123]
    ds_write_addtid_b32 v103 offset:1792
    s_add_u32 m0, s78, 2048
    v_mfma_f32_16x16x32_bf16 v[116:119], a[20:23], v[28:31], v[116:119]
    v_readlane_b32 s70, v4, 23
    ds_write_addtid_b32 v88 offset:0
    v_mfma_f32_16x16x32_bf16 v[108:111], a[20:23], v[24:27], v[108:111]
    s_waitcnt vmcnt(8)
    v_cmp_u_f32 vcc, v64, v68
    ds_write_addtid_b32 v89 offset:256
    v_mfma_f32_16x16x32_bf16 v[112:115], a[16:19], v[28:31], v[112:115]
    ds_write_addtid_b32 v90 offset:512
    v_mfma_f32_16x16x32_bf16 v[104:107], a[16:19], v[24:27], v[104:107]
    s_nop 0
    s_cbranch_vccnz interleave_layers__ssm_conv_s4d__mixer_token_mlp__prompt_kernel_rt250
interleave_layers__ssm_conv_s4d__mixer_token_mlp__prompt_kernel_ok251:
    ds_write_addtid_b32 v91 offset:768
    v_mfma_f32_16x16x32_bf16 v[132:135], a[44:47], v[68:71], v[132:135]
    buffer_load_dwordx4 v[28:31], v3, s[52:55], s70 offen sc1
    ds_write_addtid_b32 v92 offset:1024
    v_mfma_f32_16x16x32_bf16 v[124:127], a[44:47], v[64:67], v[124:127]
    ds_write_addtid_b32 v93 offset:1280
    v_mfma_f32_16x16x32_bf16 v[128:131], a[40:43], v[68:71], v[128:131]
    buffer_load_dwordx4 v[24:27], v2, s[52:55], s70 offen sc1
    ds_write_addtid_b32 v94 offset:1536
    v_mfma_f32_16x16x32_bf16 v[120:123], a[40:43], v[64:67], v[120:123]
    ds_write_addtid_b32 v95 offset:1792
    v_mfma_f32_16x16x32_bf16 v[116:119], a[36:39], v[68:71], v[116:119]
    v_readlane_b32 s7, v4, 24
    s_add_u32 m0, s77, 0
    s_nop 0
    ds_write_addtid_b32 v80 offset:0
    v_mfma_f32_16x16x32_bf16 v[108:111], a[36:39], v[64:67], v[108:111]
    s_waitcnt vmcnt(8)
    v_cmp_u_f32 vcc, v56, v60
    v_mfma_f32_16x16x32_bf16 v[112:115], a[32:35], v[68:71], v[112:115]
    ds_write_addtid_b32 v81 offset:256
    v_mfma_f32_16x16x32_bf16 v[104:107], a[32:35], v[64:67], v[104:107]
    s_nop 0
    s_cbranch_vccnz interleave_layers__ssm_conv_s4d__mixer_token_mlp__prompt_kernel_rt252
interleave_layers__ssm_conv_s4d__mixer_token_mlp__prompt_kernel_ok253:
    ds_write_addtid_b32 v82 offset:512
    v_mfma_f32_16x16x32_bf16 v[132:135], a[60:63], v[60:63], v[132:135]
    buffer_load_dwordx4 v[68:71], v3, s[52:55], s7 offen sc1
    ds_write_addtid_b32 v83 offset:768
    v_mfma_f32_16x16x32_bf16 v[124:127], a[60:63], v[56:59], v[124:127]
    ds_write_addtid_b32 v84 offset:1024
    ds_write_addtid_b32 v85 offset:1280
    v_mfma_f32_16x16x32_bf16 v[128:131], a[56:59], v[60:63], v[128:131]
    buffer_load_dwordx4 v[64:67], v2, s[52:55], s7 offen sc1
    v_mfma_f32_16x16x32_bf16 v[120:123], a[56:59], v[56:59], v[120:123]
    ds_write_addtid_b32 v86 offset:1536
    ds_write_addtid_b32 v87 offset:1792
    v_mfma_f32_16x16x32_bf16 v[116:119], a[52:55], v[60:63], v[116:119]
    v_readlane_b32 s12, v4, 25
    v_mfma_f32_16x16x32_bf16 v[108:111], a[52:55], v[56:59], v[108:111]
    s_waitcnt vmcnt(8)
    v_cmp_u_f32 vcc, v48, v52
    v_mfma_f32_16x16x32_bf16 v[112:115], a[48:51], v[60:63], v[112:115]
    v_mfma_f32_16x16x32_bf16 v[104:107], a[48:51], v[56:59], v[104:107]
    s_cbranch_vccnz interleave_layers__ssm_conv_s4d__mixer_token_mlp__prompt_kernel_rt254
interleave_layers__ssm_conv_s4d__mixer_token_mlp__prompt_kernel_ok255:
    v_mfma_f32_16x16x32_bf16 v[132:135], a[76:79], v[52:55], v[132:135]
    buffer_load_dwordx4 v[60:63], v3, s[52:55], s12 offen sc1
    s_nop 0
    s_waitcnt lgkmcnt(0)
    s_barrier
    v_mfma_f32_16x16x32_bf16 v[124:127], a[76:79], v[48:51], v[124:127]
    ds_read2st64_b32 v[80:81], v10 offset0:0 offset1:1
    ds_read2st64_b32 v[88:89], v10 offset0:8 offset1:9
    ds_read2st64_b32 v[96:97], v10 offset0:16 offset1:17
    v_mfma_f32_16x16x32_bf16 v[128:131], a[72:75], v[52:55], v[128:131]
    buffer_load_dwordx4 v[56:59], v2, s[52:55], s12 offen sc1
    ds_read2st64_b32 v[82:83], v10 offset0:2 offset1:3
    v_mfma_f32_16x16x32_bf16 v[120:123], a[72:75], v[48:51], v[120:123]
    ds_read2st64_b32 v[90:91], v10 offset0:10 offset1:11
    ds_read2st64_b32 v[98:99], v10 offset0:18 offset1:19
    ds_read2st64_b32 v[84:85], v10 offset0:4 offset1:5
    v_mfma_f32_16x16x32_bf16 v[116:119], a[68:71], v[52:55], v[116:119]
    v_readlane_b32 s13, v4, 26
    ds_read2st64_b32 v[92:93], v10 offset0:12 offset1:13
    ds_read2st64_b32 v[100:101], v10 offset0:20 offset1:21
    v_mfma_f32_16x16x32_bf16 v[108:111], a[68:71], v[48:51], v[108:111]
    s_waitcnt vmcnt(8)
    v_cmp_u_f32 vcc, v40, v44
    ds_read2st64_b32 v[86:87], v10 offset0:6 offset1:7
    v_mfma_f32_16x16x32_bf16 v[112:115], a[64:67], v[52:55], v[112:115]
    ds_read2st64_b32 v[94:95], v10 offset0:14 offset1:15
    ds_read2st64_b32 v[102:103], v10 offset0:22 offset1:23
    v_mfma_f32_16x16x32_bf16 v[104:107], a[64:67], v[48:51], v[104:107]
    s_cbranch_vccnz interleave_layers__ssm_conv_s4d__mixer_token_mlp__prompt_kernel_rt256
interleave_layers__ssm_conv_s4d__mixer_token_mlp__prompt_kernel_ok257:
    v_mfma_f32_16x16x32_bf16 v[132:135], a[92:95], v[44:47], v[132:135]
    buffer_load_dwordx4 v[52:55], v3, s[52:55], s13 offen sc1
    s_waitcnt lgkmcnt(9)
    v_add_f32_e64 v72, v80, v72
    v_mfma_f32_16x16x32_bf16 v[124:127], a[92:95], v[40:43], v[124:127]
    v_add_f32 v73, v81, v73
    v_add_f32 v88, v96, v88
    v_add_f32_e64 v89, v97, v89
    v_mfma_f32_16x16x32_bf16 v[128:131], a[88:91], v[44:47], v[128:131]
    buffer_load_dwordx4 v[48:51], v2, s[52:55], s13 offen sc1
    s_waitcnt lgkmcnt(6)
    v_add_f32 v74, v82, v74
    v_mfma_f32_16x16x32_bf16 v[120:123], a[88:91], v[40:43], v[120:123]
    v_add_f32 v75, v83, v75
    v_add_f32 v90, v98, v90
    v_mfma_f32_16x16x32_bf16 v[116:119], a[84:87], v[44:47], v[116:119]
    v_readlane_b32 s14, v4, 27
    v_add_f32 v91, v99, v91
    s_waitcnt lgkmcnt(3)
    v_add_f32_e64 v76, v84, v76
    v_mfma_f32_16x16x32_bf16 v[108:111], a[84:87], v[40:43], v[108:111]
    s_waitcnt vmcnt(8)
    v_cmp_u_f32 vcc, v32, v36
    v_mfma_f32_16x16x32_bf16 v[112:115], a[80:83], v[44:47], v[112:115]
    v_add_f32 v77, v85, v77
    v_add_f32 v92, v100, v92
    v_mfma_f32_16x16x32_bf16 v[104:107], a[80:83], v[40:43], v[104:107]
    s_cbranch_vccnz interleave_layers__ssm_conv_s4d__mixer_token_mlp__prompt_kernel_rt258
interleave_layers__ssm_conv_s4d__mixer_token_mlp__prompt_kernel_ok259:
    v_add_f32 v93, v101, v93
    s_waitcnt lgkmcnt(0)
    v_add_f32 v78, v86, v78
    v_mfma_f32_16x16x32_bf16 v[132:135], a[108:111], v[36:39], v[132:135]
    buffer_load_dwordx4 v[44:47], v3, s[52:55], s14 offen sc1
    v_add_f32_e64 v79, v87, v79
    v_mfma_f32_16x16x32_bf16 v[124:127], a[108:111], v[32:35], v[124:127]
    v_add_f32 v94, v102, v94
    v_add_f32 v95, v103, v95
    v_add_f32_e64 v72, v88, v72
    v_mfma_f32_16x16x32_bf16 v[128:131], a[104:107], v[36:39], v[128:131]
    buffer_load_dwordx4 v[40:43], v2, s[52:55], s14 offen sc1
    v_add_f32_e64 v73, v89, v73
    v_mfma_f32_16x16x32_bf16 v[120:123], a[104:107], v[32:35], v[120:123]
    v_add_f32 v74, v90, v74
    v_add_f32 v75, v91, v75
    v_add_f32_e64 v76, v92, v76
    v_mfma_f32_16x16x32_bf16 v[116:119], a[100:103], v[36:39], v[116:119]
    v_readlane_b32 s15, v4, 28
    v_add_f32 v77, v93, v77
    v_add_f32 v78, v94, v78
    v_mfma_f32_16x16x32_bf16 v[108:111], a[100:103], v[32:35], v[108:111]
    s_waitcnt vmcnt(8)
    v_cmp_u_f32 vcc, v24, v28
    v_add_f32_e64 v79, v95, v79
    v_mfma_f32_16x16x32_bf16 v[112:115], a[96:99], v[36:39], v[112:115]
    v_mul_f32 v80, v72, v72
    v_mul_f32 v81, v73, v73
    v_mfma_f32_16x16x32_bf16 v[104:107], a[96:99], v[32:35], v[104:107]
    s_cbranch_vccnz interleave_layers__ssm_conv_s4d__mixer_token_mlp__prompt_kernel_rt260
interleave_layers__ssm_conv_s4d__mixer_token_mlp__prompt_kernel_ok261:
    v_mul_f32 v82, v74, v74
    v_mul_f32_e64 v83, v75, v75
    v_mfma_f32_16x16x32_bf16 v[132:135], a[124:127], v[28:31], v[132:135]
    buffer_load_dwordx4 v[36:39], v3, s[52:55], s15 offen sc1
    v_mul_f32 v84, v76, v76
    v_mul_f32 v85, v77, v77
    v_mfma_f32_16x16x32_bf16 v[124:127], a[124:127], v[24:27], v[124:127]
    v_mul_f32 v86, v78, v78
    v_mul_f32 v87, v79, v79
    v_fma_f32 v80, v80, s82, v20
    v_mfma_f32_16x16x32_bf16 v[128:131], a[120:123], v[28:31], v[128:131]
    buffer_load_dwordx4 v[32:35], v2, s[52:55], s15 offen sc1
    v_fma_f32 v81, v81, s83, v21
    v_mfma_f32_16x16x32_bf16 v[120:123], a[120:123], v[24:27], v[120:123]
    v_fma_f32 v82, v82, s82, v20
    v_fma_f32 v83, v83, s83, v21
    v_fma_f32 v84, v84, s82, v20
    v_mfma_f32_16x16x32_bf16 v[116:119], a[116:119], v[28:31], v[116:119]
    v_readlane_b32 s70, v4, 29
    v_fma_f32 v85, v85, s83, v21
    v_fma_f32 v86, v86, s82, v20
    v_mfma_f32_16x16x32_bf16 v[108:111], a[116:119], v[24:27], v[108:111]
    s_waitcnt vmcnt(8)
    v_cmp_u_f32 vcc, v64, v68
    v_fma_f32 v87, v87, s83, v21
    v_mfma_f32_16x16x32_bf16 v[112:115], a[112:115], v[28:31], v[112:115]
    v_mul_f32 v80, v72, v80
    v_mul_f32 v81, v73, v81
    v_mfma_f32_16x16x32_bf16 v[104:107], a[112:115], v[24:27], v[104:107]
    s_cbranch_vccnz interleave_layers__ssm_conv_s4d__mixer_token_mlp__prompt_kernel_rt262
interleave_layers__ssm_conv_s4d__mixer_token_mlp__prompt_kernel_ok263:
    v_mul_f32 v82, v74, v82
    v_mul_f32_e64 v83, v75, v83
    v_mfma_f32_16x16x32_bf16 v[132:135], a[140:143], v[68:71], v[132:135]
    buffer_load_dwordx4 v[28:31], v3, s[52:55], s70 offen sc1
    v_mul_f32 v84, v76, v84
    v_mul_f32 v85, v77, v85
    v_mfma_f32_16x16x32_bf16 v[124:127], a[140:143], v[64:67], v[124:127]
    v_mul_f32 v86, v78, v86
    v_mul_f32 v87, v79, v87
    v_exp_f32_e64 v80, v80
    v_mfma_f32_16x16x32_bf16 v[128:131], a[136:139], v[68:71], v[128:131]
    buffer_load_dwordx4 v[24:27], v2, s[52:55], s70 offen sc1
    v_mfma_f32_16x16x32_bf16 v[120:123], a[136:139], v[64:67], v[120:123]
    v_exp_f32 v81, v81
    v_exp_f32 v82, v82
    v_mfma_f32_16x16x32_bf16 v[116:119], a[132:135], v[68:71], v[116:119]
    v_readlane_b32 s7, v4, 30
    v_exp_f32_e64 v83, v83
    v_mfma_f32_16x16x32_bf16 v[108:111], a[132:135], v[64:67], v[108:111]
    s_waitcnt vmcnt(8)
    v_cmp_u_f32 vcc, v56, v60
    v_mfma_f32_16x16x32_bf16 v[112:115], a[128:131], v[68:71], v[112:115]
    v_exp_f32_e64 v84, v84
    v_mfma_f32_16x16x32_bf16 v[104:107], a[128:131], v[64:67], v[104:107]
    s_cbranch_vccnz interleave_layers__ssm_conv_s4d__mixer_token_mlp__prompt_kernel_rt264
interleave_layers__ssm_conv_s4d__mixer_token_mlp__prompt_kernel_ok265:
    v_exp_f32 v85, v85
    v_mfma_f32_16x16x32_bf16 v[132:135], a[156:159], v[60:63], v[132:135]
    buffer_load_dwordx4 v[68:71], v3, s[52:55], s7 offen sc1
    v_exp_f32_e64 v86, v86
    v_mfma_f32_16x16x32_bf16 v[124:127], a[156:159], v[56:59], v[124:127]
    v_exp_f32 v87, v87
    v_add_f32 v80, 1.0, v80
    v_mfma_f32_16x16x32_bf16 v[128:131], a[152:155], v[60:63], v[128:131]
    buffer_load_dwordx4 v[64:67], v2, s[52:55], s7 offen sc1
    v_add_f32_e64 v81, 1.0, v81
    v_mfma_f32_16x16x32_bf16 v[120:123], a[152:155], v[56:59], v[120:123]
    v_add_f32 v82, 1.0, v82
    v_add_f32 v83, 1.0, v83
    v_add_f32_e64 v84, 1.0, v84
    v_mfma_f32_16x16x32_bf16 v[116:119], a[148:151], v[60:63], v[116:119]
    v_readlane_b32 s12, v4, 31
    v_add_f32 v85, 1.0, v85
    v_add_f32 v86, 1.0, v86
    v_mfma_f32_16x16x32_bf16 v[108:111], a[148:151], v[56:59], v[108:111]
    s_waitcnt vmcnt(8)
    v_cmp_u_f32 vcc, v48, v52
    v_add_f32_e64 v87, 1.0, v87
    v_mfma_f32_16x16x32_bf16 v[112:115], a[144:147], v[60:63], v[112:115]
    v_rcp_f32_e64 v80, v80
    v_mfma_f32_16x16x32_bf16 v[104:107], a[144:147], v[56:59], v[104:107]
    s_cbranch_vccnz interleave_layers__ssm_conv_s4d__mixer_token_mlp__prompt_kernel_rt266
interleave_layers__ssm_conv_s4d__mixer_token_mlp__prompt_kernel_ok267:
    v_rcp_f32 v81, v81
    v_mfma_f32_16x16x32_bf16 v[132:135], a[172:175], v[52:55], v[132:135]
    buffer_load_dwordx4 v[60:63], v3, s[52:55], s12 offen sc1
    v_rcp_f32_e64 v82, v82
    v_mfma_f32_16x16x32_bf16 v[124:127], a[172:175], v[48:51], v[124:127]
    s_mov_b32 m0, s87
    v_and_b32 v5, 63, v0
    v_lshlrev_b32_e64 v5, 2, v5
    buffer_load_dwordx4 v2, s[52:55], s84 offen offset:0 sc1 lds
    buffer_load_dwordx4 v2, s[52:55], s85 offen offset:1024 sc1 lds
    s_lshl_b32 s42, s3, 8
    s_add_u32 m0, s42, 44032
    s_nop 0
    buffer_load_dword v5, s[52:55], s88 offen sc1 lds
    v_mfma_f32_16x16x32_bf16 v[128:131], a[168:171], v[52:55], v[128:131]
    buffer_load_dwordx4 v[56:59], v2, s[52:55], s12 offen sc1
    v_mfma_f32_16x16x32_bf16 v[120:123], a[168:171], v[48:51], v[120:123]
    v_mfma_f32_16x16x32_bf16 v[116:119], a[164:167], v[52:55], v[116:119]
    v_rcp_f32_e64 v83, v83
    v_mfma_f32_16x16x32_bf16 v[108:111], a[164:167], v[48:51], v[108:111]
    s_waitcnt vmcnt(11)
    v_cmp_u_f32 vcc, v40, v44
    v_rcp_f32_e64 v84, v84
    v_mfma_f32_16x16x32_bf16 v[112:115], a[160:163], v[52:55], v[112:115]
    v_rcp_f32_e64 v85, v85
    v_mfma_f32_16x16x32_bf16 v[104:107], a[160:163], v[48:51], v[104:107]
    s_cbranch_vccnz interleave_layers__ssm_conv_s4d__mixer_token_mlp__prompt_kernel_rt268
interleave_layers__ssm_conv_s4d__mixer_token_mlp__prompt_kernel_ok269:
    v_rcp_f32 v86, v86
    v_mfma_f32_16x16x32_bf16 v[132:135], a[188:191], v[44:47], v[132:135]
    v_rcp_f32_e64 v87, v87
    v_mfma_f32_16x16x32_bf16 v[124:127], a[188:191], v[40:43], v[124:127]
    v_mul_f32 v72, v80, v72
    v_mul_f32 v73, v81, v73
    v_mul_f32_e64 v74, v82, v74
    v_mfma_f32_16x16x32_bf16 v[128:131], a[184:187], v[44:47], v[128:131]
    v_mul_f32 v75, v83, v75
    v_mul_f32 v76, v84, v76
    v_mfma_f32_16x16x32_bf16 v[120:123], a[184:187], v[40:43], v[120:123]
    v_mul_f32 v77, v85, v77
    v_mul_f32 v78, v86, v78
    v_mul_f32_e64 v79, v87, v79
    v_mfma_f32_16x16x32_bf16 v[116:119], a[180:183], v[44:47], v[116:119]
    v_cvt_pk_bf16_f32 v88, v72, v73
    v_cvt_pk_bf16_f32 v89, v74, v75
    v_cvt_pk_bf16_f32 v90, v76, v77
    v_mfma_f32_16x16x32_bf16 v[108:111], a[180:183], v[40:43], v[108:111]
    s_waitcnt vmcnt(9)
    v_cmp_u_f32 vcc, v32, v36
    v_cvt_pk_bf16_f32 v91, v78, v79
    v_mfma_f32_16x16x32_bf16 v[112:115], a[176:179], v[44:47], v[112:115]
    v_mfma_f32_16x16x32_bf16 v[104:107], a[176:179], v[40:43], v[104:107]
    s_nop 0
    s_cbranch_vccnz interleave_layers__ssm_conv_s4d__mixer_token_mlp__prompt_kernel_rt270
interleave_layers__ssm_conv_s4d__mixer_token_mlp__prompt_kernel_ok271:
    v_mfma_f32_16x16x32_bf16 v[132:135], a[204:207], v[36:39], v[132:135]
    buffer_store_dwordx4 v[88:91], v2, s[52:55], s80 offen sc1
    v_mfma_f32_16x16x32_bf16 v[124:127], a[204:207], v[32:35], v[124:127]
    v_mfma_f32_16x16x32_bf16 v[128:131], a[200:203], v[36:39], v[128:131]
    v_mfma_f32_16x16x32_bf16 v[120:123], a[200:203], v[32:35], v[120:123]
    v_mfma_f32_16x16x32_bf16 v[116:119], a[196:199], v[36:39], v[116:119]
    v_mfma_f32_16x16x32_bf16 v[108:111], a[196:199], v[32:35], v[108:111]
    s_waitcnt vmcnt(8)
    v_cmp_u_f32 vcc, v24, v28
    v_mfma_f32_16x16x32_bf16 v[112:115], a[192:195], v[36:39], v[112:115]
    v_mfma_f32_16x16x32_bf16 v[104:107], a[192:195], v[32:35], v[104:107]
    s_cbranch_vccnz interleave_layers__ssm_conv_s4d__mixer_token_mlp__prompt_kernel_rt272
interleave_layers__ssm_conv_s4d__mixer_token_mlp__prompt_kernel_ok273:
    v_mfma_f32_16x16x32_bf16 v[132:135], a[220:223], v[28:31], v[132:135]
    s_waitcnt vmcnt(2)
    v_and_b32 v96, 0xc0, v0
    v_and_b32_e64 v97, 15, v0
    v_mfma_f32_16x16x32_bf16 v[124:127], a[220:223], v[24:27], v[124:127]
    v_lshlrev_b32_e64 v96, 2, v96
    v_lshl_add_u32 v96, v97, 3, v96
    ds_read_b64_tr_b16 v[80:81], v12 offset:0
    v_mfma_f32_16x16x32_bf16 v[128:131], a[216:219], v[28:31], v[128:131]
    ds_read_b64_tr_b16 v[82:83], v12 offset:512
    ds_read_b64_tr_b16 v[84:85], v12 offset:1024
    ds_read_b64_tr_b16 v[86:87], v12 offset:1536
    v_mfma_f32_16x16x32_bf16 v[120:123], a[216:219], v[24:27], v[120:123]
    ds_read_b64 v[92:93], v96 offset:44032
    ds_read_b64 v[94:95], v96 offset:44160
    v_mfma_f32_16x16x32_bf16 v[116:119], a[212:215], v[28:31], v[116:119]
    v_mfma_f32_16x16x32_bf16 v[108:111], a[212:215], v[24:27], v[108:111]
    v_cmp_u_f32_e64 vcc, v64, v68
    v_mfma_f32_16x16x32_bf16 v[112:115], a[208:211], v[28:31], v[112:115]
    v_mfma_f32_16x16x32_bf16 v[104:107], a[208:211], v[24:27], v[104:107]
    s_cbranch_vccnz interleave_layers__ssm_conv_s4d__mixer_token_mlp__prompt_kernel_rt274
interleave_layers__ssm_conv_s4d__mixer_token_mlp__prompt_kernel_ok275:
    v_mfma_f32_16x16x32_bf16 v[132:135], a[236:239], v[68:71], v[132:135]
    v_mfma_f32_16x16x32_bf16 v[124:127], a[236:239], v[64:67], v[124:127]
    s_waitcnt lgkmcnt(0)
    v_pk_max_u16 v5, v80, v81
    v_pk_max_u16 v5, v5, v82
    v_pk_max_u16 v5, v5, v83
    v_pk_max_u16 v5, v5, v84
    v_pk_max_u16 v5, v5, v85
    v_pk_max_u16 v5, v5, v86
    v_pk_max_u16 v5, v5, v87
    v_lshlrev_b32_e64 v97, 16, v5
    v_max3_u32 v97, v97, v92, v94
    v_cmp_u_f32 vcc, v5, v97
    s_cbranch_vccnz interleave_layers__ssm_conv_s4d__mixer_token_mlp__prompt_kernel_x3rt276
interleave_layers__ssm_conv_s4d__mixer_token_mlp__prompt_kernel_x3ok277:
    v_mfma_f32_16x16x32_bf16 v[128:131], a[232:235], v[68:71], v[128:131]
    v_mfma_f32_16x16x32_bf16 v[120:123], a[232:235], v[64:67], v[120:123]
    v_mfma_f32_16x16x32_bf16 v[116:119], a[228:231], v[68:71], v[116:119]
    v_mfma_f32_16x16x32_bf16 v[108:111], a[228:231], v[64:67], v[108:111]
    s_waitcnt vmcnt(1)
    v_cmp_u_f32 vcc, v56, v60
    v_mfma_f32_16x16x32_bf16 v[112:115], a[224:227], v[68:71], v[112:115]
    v_lshlrev_b32_e64 v72, 16, v80
    v_and_b32 v73, 0xffff0000, v80
    v_lshlrev_b32_e64 v74, 16, v81
    v_mfma_f32_16x16x32_bf16 v[104:107], a[224:227], v[64:67], v[104:107]
    s_cbranch_vccnz interleave_layers__ssm_conv_s4d__mixer_token_mlp__prompt_kernel_rt278
interleave_layers__ssm_conv_s4d__mixer_token_mlp__prompt_kernel_ok279:
    v_and_b32 v75, 0xffff0000, v81
    v_lshlrev_b32 v76, 16, v82
    v_mfma_f32_16x16x32_bf16 v[132:135], a[252:255], v[60:63], v[132:135]
    s_nop 0
    s_barrier
    v_readlane_b32 s7, v4, 32
    v_readlane_b32 s12, v4, 39
    v_mfma_f32_16x16x32_bf16 v[124:127], a[252:255], v[56:59], v[124:127]
    v_readlane_b32 s13, v4, 33
    v_readlane_b32 s14, v4, 40
    v_mfma_f32_16x16x32_bf16 v[128:131], a[248:251], v[60:63], v[128:131]
    v_readlane_b32 s15, v4, 34
    v_readlane_b32 s70, v4, 41
    v_mfma_f32_16x16x32_bf16 v[120:123], a[248:251], v[56:59], v[120:123]
    v_and_b32 v77, 0xffff0000, v82
    v_lshlrev_b32_e64 v78, 16, v83
    v_mfma_f32_16x16x32_bf16 v[116:119], a[244:247], v[60:63], v[116:119]
    v_and_b32 v79, 0xffff0000, v83
    v_fma_f32 v72, v72, v92, v93
    s_add_u32 m0, s79, 4096
    v_mfma_f32_16x16x32_bf16 v[112:115], a[240:243], v[60:63], v[112:115]
    v_fma_f32 v73, v73, v92, v93
    v_fma_f32 v74, v74, v92, v93
    ds_write_addtid_b32 v128 offset:0
    ds_write_addtid_b32 v129 offset:256
    v_mfma_f32_16x16x32_bf16 v[108:111], a[244:247], v[56:59], v[108:111]
    v_fma_f32 v75, v75, v92, v93
    v_fma_f32 v76, v76, v94, v95
    ds_write_addtid_b32 v130 offset:512
    ds_write_addtid_b32 v131 offset:768
    v_mfma_f32_16x16x32_bf16 v[104:107], a[240:243], v[56:59], v[104:107]
    v_fma_f32 v77, v77, v94, v95
    v_fma_f32 v78, v78, v94, v95
    v_fma_f32 v79, v79, v94, v95
    ds_write_addtid_b32 v132 offset:1024
    ds_write_addtid_b32 v133 offset:1280
    ds_write_addtid_b32 v134 offset:1536
    ds_write_addtid_b32 v135 offset:1792
    s_add_u32 m0, s78, 2048
    s_nop 0
    s_nop 0
    ds_write_addtid_b32 v120 offset:0
    ds_write_addtid_b32 v121 offset:256
    ds_write_addtid_b32 v122 offset:512
    ds_write_addtid_b32 v123 offset:768
    ds_write_addtid_b32 v124 offset:1024
    ds_write_addtid_b32 v125 offset:1280
    ds_write_addtid_b32 v126 offset:1536
    ds_write_addtid_b32 v127 offset:1792
    s_add_u32 m0, s77, 0
    s_nop 0
    ds_write_addtid_b32 v112 offset:0
    ds_write_addtid_b32 v113 offset:256
    ds_write_addtid_b32 v114 offset:512
    buffer_load_dwordx4 v[68:71], v3, s[52:55], s7 offen sc1
    ds_write_addtid_b32 v115 offset:768
    ds_write_addtid_b32 v116 offset:1024
    ds_write_addtid_b32 v117 offset:1280
    ds_write_addtid_b32 v118 offset:1536
    buffer_load_dwordx4 v[64:67], v2, s[52:55], s7 offen sc1
    ds_write_addtid_b32 v119 offset:1792
    buffer_load_dwordx4 v[52:55], v3, s[52:55], s12 offen sc1
    s_waitcnt lgkmcnt(0)
    s_barrier
    ds_read2st64_b32 v[112:113], v10 offset0:0 offset1:1
    ds_read2st64_b32 v[120:121], v10 offset0:8 offset1:9
    ds_read2st64_b32 v[128:129], v10 offset0:16 offset1:17
    ds_read2st64_b32 v[114:115], v10 offset0:2 offset1:3
    ds_read2st64_b32 v[122:123], v10 offset0:10 offset1:11
    ds_read2st64_b32 v[130:131], v10 offset0:18 offset1:19
    ds_read2st64_b32 v[116:117], v10 offset0:4 offset1:5
    ds_read2st64_b32 v[124:125], v10 offset0:12 offset1:13
    ds_read2st64_b32 v[132:133], v10 offset0:20 offset1:21
    ds_read2st64_b32 v[118:119], v10 offset0:6 offset1:7
    ds_read2st64_b32 v[126:127], v10 offset0:14 offset1:15
    ds_read2st64_b32 v[134:135], v10 offset0:22 offset1:23
    buffer_load_dwordx4 v[48:51], v2, s[52:55], s12 offen sc1
    buffer_load_dwordx4 v[44:47], v3, s[52:55], s13 offen sc1
    v_mov_b32_e64 v5, v5
    v_mov_b32 v5, v5
    s_waitcnt lgkmcnt(9)
    v_pk_add_f32 v[104:105], v[104:105], v[112:113]
    v_pk_add_f32 v[120:121], v[120:121], v[128:129]
    s_waitcnt lgkmcnt(6)
    v_pk_add_f32 v[106:107], v[106:107], v[114:115]
    v_pk_add_f32 v[122:123], v[122:123], v[130:131]
    s_waitcnt lgkmcnt(3)
    v_pk_add_f32 v[108:109], v[108:109], v[116:117]
    v_pk_add_f32 v[124:125], v[124:125], v[132:133]
    buffer_load_dwordx4 v[40:43], v2, s[52:55], s13 offen sc1
    s_nop 0
    s_waitcnt lgkmcnt(0)
    v_pk_add_f32 v[110:111], v[110:111], v[118:119]
    v_pk_add_f32 v[126:127], v[126:127], v[134:135]
    v_pk_add_f32 v[104:105], v[104:105], v[120:121]
    v_pk_add_f32 v[106:107], v[106:107], v[122:123]
    v_pk_add_f32 v[108:109], v[108:109], v[124:125]
    v_pk_add_f32 v[110:111], v[110:111], v[126:127]
    buffer_load_dwordx4 v[36:39], v3, s[52:55], s14 offen sc1
    v_pk_mul_f32 v[112:113], v[104:105], v[104:105]
    v_pk_mul_f32 v[114:115], v[106:107], v[106:107]
    v_pk_mul_f32 v[116:117], v[108:109], v[108:109]
    v_pk_mul_f32 v[118:119], v[110:111], v[110:111]
    v_pk_fma_f32 v[112:113], v[112:113], s[82:83], v[20:21]
    v_pk_fma_f32 v[114:115], v[114:115], s[82:83], v[20:21]
    buffer_load_dwordx4 v[32:35], v2, s[52:55], s14 offen sc1
    v_pk_fma_f32 v[116:117], v[116:117], s[82:83], v[20:21]
    v_pk_fma_f32 v[118:119], v[118:119], s[82:83], v[20:21]
    v_pk_mul_f32 v[112:113], v[112:113], v[104:105]
    v_pk_mul_f32 v[114:115], v[114:115], v[106:107]
    v_pk_mul_f32 v[116:117], v[116:117], v[108:109]
    v_pk_mul_f32 v[118:119], v[118:119], v[110:111]
    buffer_load_dwordx4 v[28:31], v3, s[52:55], s15 offen sc1
    v_exp_f32 v112, v112
    v_exp_f32 v113, v113
    v_exp_f32 v114, v114
    v_exp_f32 v115, v115
    v_exp_f32 v116, v116
    v_exp_f32 v117, v117
    buffer_load_dwordx4 v[24:27], v2, s[52:55], s15 offen sc1
    v_exp_f32 v118, v118
    v_exp_f32 v119, v119
    v_pk_add_f32 v[112:113], v[112:113], 1.0 op_sel_hi:[1,0]
    v_pk_add_f32 v[114:115], v[114:115], 1.0 op_sel_hi:[1,0]
    v_pk_add_f32 v[116:117], v[116:117], 1.0 op_sel_hi:[1,0]
    v_pk_add_f32 v[118:119], v[118:119], 1.0 op_sel_hi:[1,0]
    v_rcp_f32 v112, v112
    v_rcp_f32 v113, v113
    v_rcp_f32 v114, v114
    v_rcp_f32 v115, v115
    v_rcp_f32 v116, v116
    v_rcp_f32 v117, v117
    v_rcp_f32 v118, v118
    v_rcp_f32 v119, v119
    v_pk_mul_f32 v[104:105], v[104:105], v[112:113]
    v_pk_mul_f32 v[106:107], v[106:107], v[114:115]
    v_pk_mul_f32 v[108:109], v[108:109], v[116:117]
    v_pk_mul_f32 v[110:111], v[110:111], v[118:119]
    v_cvt_pk_bf16_f32 v120, v104, v105
    v_cvt_pk_bf16_f32 v121, v106, v107
    v_cvt_pk_bf16_f32 v122, v108, v109
    v_cvt_pk_bf16_f32 v123, v110, v111
    buffer_store_dwordx4 v[120:123], v2, s[52:55], s81 offen sc1
interleave_layers__ssm_conv_s4d__mixer_token_mlp__prompt_kernel_g1skip207:
    s_lshl_b32 s39, s37, 1
    s_lshr_b32 s40, s3, 1
    s_add_u32 s39, s39, s40
    s_lshl_b32 s39, s39, 15
    s_lshl_b32 s40, s35, 1
    s_and_b32 s41, s3, 1
    s_add_u32 s40, s40, s41
    s_lshl_b32 s40, s40, 6
    s_add_u32 s80, s39, s40
    s_add_u32 s81, s80, 16384
    s_mov_b32 s43, 0
    s_waitcnt vmcnt(9)
    v_cmp_u_f32_e64 vcc, v64, v68
    s_cbranch_vccnz interleave_layers__ssm_conv_s4d__mixer_token_mlp__prompt_kernel_rt289
interleave_layers__ssm_conv_s4d__mixer_token_mlp__prompt_kernel_ok290:
    v_mfma_f32_16x16x32_bf16 v[100:103], v[68:71], v[156:159], 0
    ds_read_b64_tr_b16 v[60:61], v9 offset:512
    buffer_load_dwordx4 v[140:143], v3, s[52:55], s70 offen sc1
    v_mfma_f32_16x16x32_bf16 v[92:95], v[64:67], v[156:159], 0
    ds_read_b64_tr_b16 v[62:63], v9 offset:2560
    v_mfma_f32_16x16x32_bf16 v[96:99], v[68:71], v[152:155], 0
    ds_read_b64_tr_b16 v[56:57], v8 offset:512
    buffer_load_dwordx4 v[136:139], v2, s[52:55], s70 offen sc1
    v_mfma_f32_16x16x32_bf16 v[88:91], v[64:67], v[152:155], 0
    ds_read_b64_tr_b16 v[58:59], v8 offset:2560
    v_mfma_f32_16x16x32_bf16 v[84:87], v[68:71], v[148:151], 0
    ds_read_b64_tr_b16 v[20:21], v9 offset:0
    v_readlane_b32 s7, v4, 35
    v_mfma_f32_16x16x32_bf16 v[76:79], v[64:67], v[148:151], v[76:79]
    ds_read_b64_tr_b16 v[22:23], v9 offset:2048
    s_waitcnt vmcnt(9)
    v_cmp_u_f32 vcc, v48, v52
    v_mfma_f32_16x16x32_bf16 v[80:83], v[68:71], v[144:147], 0
    ds_read_b64_tr_b16 v[16:17], v8 offset:0
    v_mfma_f32_16x16x32_bf16 v[72:75], v[64:67], v[144:147], v[72:75]
    ds_read_b64_tr_b16 v[18:19], v8 offset:2048
    s_cbranch_vccnz interleave_layers__ssm_conv_s4d__mixer_token_mlp__prompt_kernel_rt291
interleave_layers__ssm_conv_s4d__mixer_token_mlp__prompt_kernel_ok292:
    s_waitcnt lgkmcnt(4)
    v_mfma_f32_16x16x32_bf16 v[100:103], v[52:55], v[60:63], v[100:103]
    buffer_load_dwordx4 v[68:71], v3, s[52:55], s7 offen sc1
    v_mfma_f32_16x16x32_bf16 v[92:95], v[48:51], v[60:63], v[92:95]
    v_mfma_f32_16x16x32_bf16 v[96:99], v[52:55], v[56:59], v[96:99]
    buffer_load_dwordx4 v[64:67], v2, s[52:55], s7 offen sc1
    v_mfma_f32_16x16x32_bf16 v[88:91], v[48:51], v[56:59], v[88:91]
    s_waitcnt lgkmcnt(0)
    v_mfma_f32_16x16x32_bf16 v[84:87], v[52:55], v[20:23], v[84:87]
    v_readlane_b32 s12, v4, 42
    v_mfma_f32_16x16x32_bf16 v[76:79], v[48:51], v[20:23], v[76:79]
    s_waitcnt vmcnt(9)
    v_cmp_u_f32_e64 vcc, v40, v44
    v_mfma_f32_16x16x32_bf16 v[80:83], v[52:55], v[16:19], v[80:83]
    v_mfma_f32_16x16x32_bf16 v[72:75], v[48:51], v[16:19], v[72:75]
    s_nop 0
    s_cbranch_vccnz interleave_layers__ssm_conv_s4d__mixer_token_mlp__prompt_kernel_rt293
interleave_layers__ssm_conv_s4d__mixer_token_mlp__prompt_kernel_ok294:
    v_mfma_f32_16x16x32_bf16 v[100:103], v[44:47], v[172:175], v[100:103]
    ds_read_b64_tr_b16 v[60:61], v9 offset:16896
    buffer_load_dwordx4 v[52:55], v3, s[52:55], s12 offen sc1
    v_and_b32 v128, 0xc0, v0
    v_mfma_f32_16x16x32_bf16 v[92:95], v[40:43], v[172:175], v[92:95]
    ds_read_b64_tr_b16 v[62:63], v9 offset:18944
    v_and_b32 v129, 15, v0
    v_lshlrev_b32 v128, 2, v128
    v_mfma_f32_16x16x32_bf16 v[96:99], v[44:47], v[168:171], v[96:99]
    ds_read_b64_tr_b16 v[56:57], v8 offset:16896
    buffer_load_dwordx4 v[48:51], v2, s[52:55], s12 offen sc1
    v_lshl_add_u32 v128, v129, 3, v128
    v_mfma_f32_16x16x32_bf16 v[88:91], v[40:43], v[168:171], v[88:91]
    ds_read_b64_tr_b16 v[58:59], v8 offset:18944
    ds_read_b64_tr_b16 v[116:117], v12 offset:1024
    ds_read_b64_tr_b16 v[118:119], v12 offset:1536
    v_mfma_f32_16x16x32_bf16 v[84:87], v[44:47], v[164:167], v[84:87]
    ds_read_b64_tr_b16 v[20:21], v9 offset:16384
    v_readlane_b32 s13, v4, 36
    ds_read_b64 v[124:125], v128 offset:44032
    v_mfma_f32_16x16x32_bf16 v[76:79], v[40:43], v[164:167], v[76:79]
    ds_read_b64_tr_b16 v[22:23], v9 offset:18432
    s_waitcnt vmcnt(9)
    v_cmp_u_f32 vcc, v32, v36
    v_mfma_f32_16x16x32_bf16 v[80:83], v[44:47], v[160:163], v[80:83]
    ds_read_b64_tr_b16 v[16:17], v8 offset:16384
    ds_read_b64 v[126:127], v128 offset:44160
    v_mfma_f32_16x16x32_bf16 v[72:75], v[40:43], v[160:163], v[72:75]
    ds_read_b64_tr_b16 v[18:19], v8 offset:18432
    s_cbranch_vccnz interleave_layers__ssm_conv_s4d__mixer_token_mlp__prompt_kernel_rt295
interleave_layers__ssm_conv_s4d__mixer_token_mlp__prompt_kernel_ok296:
    s_waitcnt lgkmcnt(8)
    v_mfma_f32_16x16x32_bf16 v[100:103], v[36:39], v[60:63], v[100:103]
    buffer_load_dwordx4 v[44:47], v3, s[52:55], s13 offen sc1
    v_mfma_f32_16x16x32_bf16 v[92:95], v[32:35], v[60:63], v[92:95]
    v_mfma_f32_16x16x32_bf16 v[96:99], v[36:39], v[56:59], v[96:99]
    buffer_load_dwordx4 v[40:43], v2, s[52:55], s13 offen sc1
    s_waitcnt lgkmcnt(1)
    v_lshlrev_b32 v104, 16, v116
    v_mfma_f32_16x16x32_bf16 v[88:91], v[32:35], v[56:59], v[88:91]
    v_and_b32 v105, 0xffff0000, v116
    v_lshlrev_b32_e64 v106, 16, v117
    v_and_b32 v107, 0xffff0000, v117
    s_waitcnt lgkmcnt(0)
    v_mfma_f32_16x16x32_bf16 v[84:87], v[36:39], v[20:23], v[84:87]
    v_readlane_b32 s14, v4, 43
    v_lshlrev_b32 v108, 16, v118
    v_mfma_f32_16x16x32_bf16 v[76:79], v[32:35], v[20:23], v[76:79]
    s_waitcnt vmcnt(9)
    v_cmp_u_f32 vcc, v24, v28
    v_and_b32 v109, 0xffff0000, v118
    v_mfma_f32_16x16x32_bf16 v[80:83], v[36:39], v[16:19], v[80:83]
    v_lshlrev_b32_e64 v110, 16, v119
    v_and_b32 v111, 0xffff0000, v119
    v_fma_f32 v104, v104, v124, v125
    v_mfma_f32_16x16x32_bf16 v[72:75], v[32:35], v[16:19], v[72:75]
    s_nop 0
    s_cbranch_vccnz interleave_layers__ssm_conv_s4d__mixer_token_mlp__prompt_kernel_rt297
interleave_layers__ssm_conv_s4d__mixer_token_mlp__prompt_kernel_ok298:
    v_fma_f32 v105, v105, v124, v125
    v_fma_f32 v106, v106, v124, v125
    v_mfma_f32_16x16x32_bf16 v[100:103], v[28:31], v[188:191], v[100:103]
    ds_read_b64_tr_b16 v[60:61], v9 offset:33280
    buffer_load_dwordx4 v[36:39], v3, s[52:55], s14 offen sc1
    v_fma_f32 v107, v107, v124, v125
    v_mfma_f32_16x16x32_bf16 v[92:95], v[24:27], v[188:191], v[92:95]
    ds_read_b64_tr_b16 v[62:63], v9 offset:35328
    v_fma_f32 v108, v108, v126, v127
    v_fma_f32 v109, v109, v126, v127
    v_mfma_f32_16x16x32_bf16 v[96:99], v[28:31], v[184:187], v[96:99]
    ds_read_b64_tr_b16 v[56:57], v8 offset:33280
    buffer_load_dwordx4 v[32:35], v2, s[52:55], s14 offen sc1
    v_fma_f32 v110, v110, v126, v127
    v_mfma_f32_16x16x32_bf16 v[88:91], v[24:27], v[184:187], v[88:91]
    ds_read_b64_tr_b16 v[58:59], v8 offset:35328
    v_fma_f32 v111, v111, v126, v127
    v_mfma_f32_16x16x32_bf16 v[84:87], v[28:31], v[180:183], v[84:87]
    ds_read_b64_tr_b16 v[20:21], v9 offset:32768
    v_readlane_b32 s15, v4, 37
    v_mfma_f32_16x16x32_bf16 v[76:79], v[24:27], v[180:183], v[76:79]
    ds_read_b64_tr_b16 v[22:23], v9 offset:34816
    s_waitcnt vmcnt(8)
    v_cmp_u_f32 vcc, v136, v140
    v_mfma_f32_16x16x32_bf16 v[80:83], v[28:31], v[176:179], v[80:83]
    ds_read_b64_tr_b16 v[16:17], v8 offset:32768
    v_mfma_f32_16x16x32_bf16 v[72:75], v[24:27], v[176:179], v[72:75]
    ds_read_b64_tr_b16 v[18:19], v8 offset:34816
    s_cbranch_vccnz interleave_layers__ssm_conv_s4d__mixer_token_mlp__prompt_kernel_rt299
interleave_layers__ssm_conv_s4d__mixer_token_mlp__prompt_kernel_ok300:
    s_waitcnt lgkmcnt(4)
    v_mfma_f32_16x16x32_bf16 v[100:103], v[140:143], v[60:63], v[100:103]
    buffer_load_dwordx4 v[28:31], v3, s[52:55], s15 offen sc1
    v_mfma_f32_16x16x32_bf16 v[92:95], v[136:139], v[60:63], v[92:95]
    v_mfma_f32_16x16x32_bf16 v[96:99], v[140:143], v[56:59], v[96:99]
    buffer_load_dwordx4 v[24:27], v2, s[52:55], s15 offen sc1
    v_mfma_f32_16x16x32_bf16 v[88:91], v[136:139], v[56:59], v[88:91]
    s_waitcnt lgkmcnt(0)
    v_mfma_f32_16x16x32_bf16 v[84:87], v[140:143], v[20:23], v[84:87]
    v_readlane_b32 s70, v4, 44
    v_mfma_f32_16x16x32_bf16 v[76:79], v[136:139], v[20:23], v[76:79]
    s_waitcnt vmcnt(8)
    v_cmp_u_f32_e64 vcc, v64, v68
    v_mfma_f32_16x16x32_bf16 v[80:83], v[140:143], v[16:19], v[80:83]
    v_mfma_f32_16x16x32_bf16 v[72:75], v[136:139], v[16:19], v[72:75]
    s_nop 0
    s_cbranch_vccnz interleave_layers__ssm_conv_s4d__mixer_token_mlp__prompt_kernel_rt301
interleave_layers__ssm_conv_s4d__mixer_token_mlp__prompt_kernel_ok302:
    v_mfma_f32_16x16x32_bf16 v[100:103], v[68:71], v[204:207], v[100:103]
    ds_read_b64_tr_b16 v[60:61], v7 offset:33280
    buffer_load_dwordx4 v[140:143], v3, s[52:55], s70 offen sc1
    v_mfma_f32_16x16x32_bf16 v[92:95], v[64:67], v[204:207], v[92:95]
    ds_read_b64_tr_b16 v[62:63], v7 offset:35328
    v_mfma_f32_16x16x32_bf16 v[96:99], v[68:71], v[200:203], v[96:99]
    ds_read_b64_tr_b16 v[56:57], v6 offset:33280
    buffer_load_dwordx4 v[136:139], v2, s[52:55], s70 offen sc1
    v_mfma_f32_16x16x32_bf16 v[88:91], v[64:67], v[200:203], v[88:91]
    ds_read_b64_tr_b16 v[58:59], v6 offset:35328
    v_mfma_f32_16x16x32_bf16 v[84:87], v[68:71], v[196:199], v[84:87]
    ds_read_b64_tr_b16 v[20:21], v7 offset:32768
    v_readlane_b32 s7, v4, 38
    v_mfma_f32_16x16x32_bf16 v[76:79], v[64:67], v[196:199], v[76:79]
    ds_read_b64_tr_b16 v[22:23], v7 offset:34816
    s_waitcnt vmcnt(8)
    v_cmp_u_f32 vcc, v48, v52
    v_mfma_f32_16x16x32_bf16 v[80:83], v[68:71], v[192:195], v[80:83]
    ds_read_b64_tr_b16 v[16:17], v6 offset:32768
    v_mfma_f32_16x16x32_bf16 v[72:75], v[64:67], v[192:195], v[72:75]
    ds_read_b64_tr_b16 v[18:19], v6 offset:34816
    s_cbranch_vccnz interleave_layers__ssm_conv_s4d__mixer_token_mlp__prompt_kernel_rt303
interleave_layers__ssm_conv_s4d__mixer_token_mlp__prompt_kernel_ok304:
    s_waitcnt lgkmcnt(4)
    v_mfma_f32_16x16x32_bf16 v[100:103], v[52:55], v[60:63], v[100:103]
    buffer_load_dwordx4 v[68:71], v3, s[52:55], s7 offen sc1
    v_mfma_f32_16x16x32_bf16 v[92:95], v[48:51], v[60:63], v[92:95]
    v_mfma_f32_16x16x32_bf16 v[96:99], v[52:55], v[56:59], v[96:99]
    buffer_load_dwordx4 v[64:67], v2, s[52:55], s7 offen sc1
    v_mfma_f32_16x16x32_bf16 v[88:91], v[48:51], v[56:59], v[88:91]
    s_waitcnt lgkmcnt(0)
    v_mfma_f32_16x16x32_bf16 v[84:87], v[52:55], v[20:23], v[84:87]
    v_readlane_b32 s12, v4, 45
    v_mfma_f32_16x16x32_bf16 v[76:79], v[48:51], v[20:23], v[76:79]
    s_waitcnt vmcnt(8)
    v_cmp_u_f32_e64 vcc, v40, v44
    v_mfma_f32_16x16x32_bf16 v[80:83], v[52:55], v[16:19], v[80:83]
    v_mfma_f32_16x16x32_bf16 v[72:75], v[48:51], v[16:19], v[72:75]
    s_nop 0
    s_cbranch_vccnz interleave_layers__ssm_conv_s4d__mixer_token_mlp__prompt_kernel_rt305
interleave_layers__ssm_conv_s4d__mixer_token_mlp__prompt_kernel_ok306:
    v_mfma_f32_16x16x32_bf16 v[100:103], v[44:47], v[220:223], v[100:103]
    ds_read_b64_tr_b16 v[60:61], v7 offset:512
    buffer_load_dwordx4 v[52:55], v3, s[52:55], s12 offen sc1
    v_mfma_f32_16x16x32_bf16 v[92:95], v[40:43], v[220:223], v[92:95]
    ds_read_b64_tr_b16 v[62:63], v7 offset:2560
    v_mfma_f32_16x16x32_bf16 v[96:99], v[44:47], v[216:219], v[96:99]
    ds_read_b64_tr_b16 v[56:57], v6 offset:512
    buffer_load_dwordx4 v[48:51], v2, s[52:55], s12 offen sc1
    v_mfma_f32_16x16x32_bf16 v[88:91], v[40:43], v[216:219], v[88:91]
    ds_read_b64_tr_b16 v[58:59], v6 offset:2560
    v_mfma_f32_16x16x32_bf16 v[84:87], v[44:47], v[212:215], v[84:87]
    ds_read_b64_tr_b16 v[20:21], v7 offset:0
    v_readlane_b32 s13, v4, 48
    v_mfma_f32_16x16x32_bf16 v[76:79], v[40:43], v[212:215], v[76:79]
    ds_read_b64_tr_b16 v[22:23], v7 offset:2048
    s_waitcnt vmcnt(8)
    v_cmp_u_f32 vcc, v32, v36
    v_mfma_f32_16x16x32_bf16 v[80:83], v[44:47], v[208:211], v[80:83]
    ds_read_b64_tr_b16 v[16:17], v6 offset:0
    v_mfma_f32_16x16x32_bf16 v[72:75], v[40:43], v[208:211], v[72:75]
    ds_read_b64_tr_b16 v[18:19], v6 offset:2048
    s_cbranch_vccnz interleave_layers__ssm_conv_s4d__mixer_token_mlp__prompt_kernel_rt307
interleave_layers__ssm_conv_s4d__mixer_token_mlp__prompt_kernel_ok308:
    s_waitcnt lgkmcnt(4)
    v_mfma_f32_16x16x32_bf16 v[100:103], v[36:39], v[60:63], v[100:103]
    buffer_load_dwordx4 v[44:47], v3, s[52:55], s13 offen sc1
    v_mfma_f32_16x16x32_bf16 v[92:95], v[32:35], v[60:63], v[92:95]
    v_mfma_f32_16x16x32_bf16 v[96:99], v[36:39], v[56:59], v[96:99]
    buffer_load_dwordx4 v[40:43], v2, s[52:55], s13 offen sc1
    v_mfma_f32_16x16x32_bf16 v[88:91], v[32:35], v[56:59], v[88:91]
    s_waitcnt lgkmcnt(0)
    v_mfma_f32_16x16x32_bf16 v[84:87], v[36:39], v[20:23], v[84:87]
    v_readlane_b32 s14, v4, 55
    v_mfma_f32_16x16x32_bf16 v[76:79], v[32:35], v[20:23], v[76:79]
    s_waitcnt vmcnt(8)
    v_cmp_u_f32_e64 vcc, v24, v28
    v_mfma_f32_16x16x32_bf16 v[80:83], v[36:39], v[16:19], v[80:83]
    v_mfma_f32_16x16x32_bf16 v[72:75], v[32:35], v[16:19], v[72:75]
    s_nop 0
    s_cbranch_vccnz interleave_layers__ssm_conv_s4d__mixer_token_mlp__prompt_kernel_rt309
interleave_layers__ssm_conv_s4d__mixer_token_mlp__prompt_kernel_ok310:
    v_mfma_f32_16x16x32_bf16 v[100:103], v[28:31], v[236:239], v[100:103]
    ds_read_b64_tr_b16 v[60:61], v7 offset:16896
    buffer_load_dwordx4 v[36:39], v3, s[52:55], s14 offen sc1
    v_mfma_f32_16x16x32_bf16 v[92:95], v[24:27], v[236:239], v[92:95]
    ds_read_b64_tr_b16 v[62:63], v7 offset:18944
    v_mfma_f32_16x16x32_bf16 v[96:99], v[28:31], v[232:235], v[96:99]
    ds_read_b64_tr_b16 v[56:57], v6 offset:16896
    buffer_load_dwordx4 v[32:35], v2, s[52:55], s14 offen sc1
    v_mfma_f32_16x16x32_bf16 v[88:91], v[24:27], v[232:235], v[88:91]
    ds_read_b64_tr_b16 v[58:59], v6 offset:18944
    v_mfma_f32_16x16x32_bf16 v[84:87], v[28:31], v[228:231], v[84:87]
    ds_read_b64_tr_b16 v[20:21], v7 offset:16384
    v_readlane_b32 s15, v4, 49
    v_mfma_f32_16x16x32_bf16 v[76:79], v[24:27], v[228:231], v[76:79]
    ds_read_b64_tr_b16 v[22:23], v7 offset:18432
    s_waitcnt vmcnt(8)
    v_cmp_u_f32 vcc, v136, v140
    v_mfma_f32_16x16x32_bf16 v[80:83], v[28:31], v[224:227], v[80:83]
    ds_read_b64_tr_b16 v[16:17], v6 offset:16384
    v_mfma_f32_16x16x32_bf16 v[72:75], v[24:27], v[224:227], v[72:75]
    ds_read_b64_tr_b16 v[18:19], v6 offset:18432
    s_cbranch_vccnz interleave_layers__ssm_conv_s4d__mixer_token_mlp__prompt_kernel_rt311
interleave_layers__ssm_conv_s4d__mixer_token_mlp__prompt_kernel_ok312:
    s_waitcnt lgkmcnt(4)
    v_mfma_f32_16x16x32_bf16 v[100:103], v[140:143], v[60:63], v[100:103]
    buffer_load_dwordx4 v[28:31], v3, s[52:55], s15 offen sc1
    v_mfma_f32_16x16x32_bf16 v[92:95], v[136:139], v[60:63], v[92:95]
    v_mfma_f32_16x16x32_bf16 v[96:99], v[140:143], v[56:59], v[96:99]
    buffer_load_dwordx4 v[24:27], v2, s[52:55], s15 offen sc1
    v_mfma_f32_16x16x32_bf16 v[88:91], v[136:139], v[56:59], v[88:91]
    s_waitcnt lgkmcnt(0)
    v_mfma_f32_16x16x32_bf16 v[84:87], v[140:143], v[20:23], v[84:87]
    v_readlane_b32 s70, v4, 56
    v_mfma_f32_16x16x32_bf16 v[76:79], v[136:139], v[20:23], v[76:79]
    s_waitcnt vmcnt(8)
    v_cmp_u_f32_e64 vcc, v64, v68
    v_mfma_f32_16x16x32_bf16 v[80:83], v[140:143], v[16:19], v[80:83]
    v_mfma_f32_16x16x32_bf16 v[72:75], v[136:139], v[16:19], v[72:75]
    s_nop 0
    s_cbranch_vccnz interleave_layers__ssm_conv_s4d__mixer_token_mlp__prompt_kernel_rt313
interleave_layers__ssm_conv_s4d__mixer_token_mlp__prompt_kernel_ok314:
    v_mfma_f32_16x16x32_bf16 v[100:103], v[68:71], v[252:255], v[100:103]
    ds_read_b64_tr_b16 v[60:61], v7 offset:49664
    buffer_load_dwordx4 v[140:143], v3, s[52:55], s70 offen sc1
    v_mfma_f32_16x16x32_bf16 v[92:95], v[64:67], v[252:255], v[92:95]
    ds_read_b64_tr_b16 v[62:63], v7 offset:51712
    v_mfma_f32_16x16x32_bf16 v[96:99], v[68:71], v[248:251], v[96:99]
    ds_read_b64_tr_b16 v[56:57], v6 offset:49664
    buffer_load_dwordx4 v[136:139], v2, s[52:55], s70 offen sc1
    v_mfma_f32_16x16x32_bf16 v[88:91], v[64:67], v[248:251], v[88:91]
    ds_read_b64_tr_b16 v[58:59], v6 offset:51712
    v_mfma_f32_16x16x32_bf16 v[84:87], v[68:71], v[244:247], v[84:87]
    ds_read_b64_tr_b16 v[20:21], v7 offset:49152
    v_readlane_b32 s7, v4, 50
    v_mfma_f32_16x16x32_bf16 v[76:79], v[64:67], v[244:247], v[76:79]
    ds_read_b64_tr_b16 v[22:23], v7 offset:51200
    s_waitcnt vmcnt(8)
    v_cmp_u_f32 vcc, v48, v52
    v_mfma_f32_16x16x32_bf16 v[80:83], v[68:71], v[240:243], v[80:83]
    ds_read_b64_tr_b16 v[16:17], v6 offset:49152
    v_mfma_f32_16x16x32_bf16 v[72:75], v[64:67], v[240:243], v[72:75]
    ds_read_b64_tr_b16 v[18:19], v6 offset:51200
    s_cbranch_vccnz interleave_layers__ssm_conv_s4d__mixer_token_mlp__prompt_kernel_rt315
interleave_layers__ssm_conv_s4d__mixer_token_mlp__prompt_kernel_ok316:
    s_waitcnt lgkmcnt(4)
    v_mfma_f32_16x16x32_bf16 v[100:103], v[52:55], v[60:63], v[100:103]
    buffer_load_dwordx4 v[68:71], v3, s[52:55], s7 offen sc1
    v_mfma_f32_16x16x32_bf16 v[92:95], v[48:51], v[60:63], v[92:95]
    v_mfma_f32_16x16x32_bf16 v[96:99], v[52:55], v[56:59], v[96:99]
    buffer_load_dwordx4 v[64:67], v2, s[52:55], s7 offen sc1
    v_mfma_f32_16x16x32_bf16 v[88:91], v[48:51], v[56:59], v[88:91]
    s_waitcnt lgkmcnt(0)
    v_mfma_f32_16x16x32_bf16 v[84:87], v[52:55], v[20:23], v[84:87]
    v_readlane_b32 s12, v4, 57
    v_mfma_f32_16x16x32_bf16 v[76:79], v[48:51], v[20:23], v[76:79]
    s_waitcnt vmcnt(8)
    v_cmp_u_f32_e64 vcc, v40, v44
    v_mfma_f32_16x16x32_bf16 v[80:83], v[52:55], v[16:19], v[80:83]
    v_mfma_f32_16x16x32_bf16 v[72:75], v[48:51], v[16:19], v[72:75]
    s_nop 0
    s_cbranch_vccnz interleave_layers__ssm_conv_s4d__mixer_token_mlp__prompt_kernel_rt317
interleave_layers__ssm_conv_s4d__mixer_token_mlp__prompt_kernel_ok318:
    v_mfma_f32_16x16x32_bf16 v[132:135], v[44:47], v[156:159], 0
    ds_read_b64_tr_b16 v[60:61], v9 offset:512
    buffer_load_dwordx4 v[52:55], v3, s[52:55], s12 offen sc1
    v_mfma_f32_16x16x32_bf16 v[124:127], v[40:43], v[156:159], 0
    ds_read_b64_tr_b16 v[62:63], v9 offset:2560
    v_mfma_f32_16x16x32_bf16 v[128:131], v[44:47], v[152:155], 0
    ds_read_b64_tr_b16 v[56:57], v8 offset:512
    buffer_load_dwordx4 v[48:51], v2, s[52:55], s12 offen sc1
    v_mfma_f32_16x16x32_bf16 v[120:123], v[40:43], v[152:155], 0
    ds_read_b64_tr_b16 v[58:59], v8 offset:2560
    s_nop 0
    s_barrier
    s_add_u32 m0, s79, 4096
    v_mfma_f32_16x16x32_bf16 v[116:119], v[44:47], v[148:151], 0
    ds_read_b64_tr_b16 v[20:21], v9 offset:0
    v_readlane_b32 s13, v4, 51
    ds_write_addtid_b32 v96 offset:0
    v_mfma_f32_16x16x32_bf16 v[108:111], v[40:43], v[148:151], v[108:111]
    ds_read_b64_tr_b16 v[22:23], v9 offset:2048
    s_waitcnt vmcnt(8)
    v_cmp_u_f32 vcc, v32, v36
    v_mfma_f32_16x16x32_bf16 v[112:115], v[44:47], v[144:147], 0
    ds_read_b64_tr_b16 v[16:17], v8 offset:0
    ds_write_addtid_b32 v97 offset:256
    v_mfma_f32_16x16x32_bf16 v[104:107], v[40:43], v[144:147], v[104:107]
    ds_read_b64_tr_b16 v[18:19], v8 offset:2048
    s_cbranch_vccnz interleave_layers__ssm_conv_s4d__mixer_token_mlp__prompt_kernel_rt319
interleave_layers__ssm_conv_s4d__mixer_token_mlp__prompt_kernel_ok320:
    s_waitcnt lgkmcnt(6)
    v_mfma_f32_16x16x32_bf16 v[132:135], v[36:39], v[60:63], v[132:135]
    buffer_load_dwordx4 v[44:47], v3, s[52:55], s13 offen sc1
    ds_write_addtid_b32 v98 offset:512
    v_mfma_f32_16x16x32_bf16 v[124:127], v[32:35], v[60:63], v[124:127]
    ds_write_addtid_b32 v99 offset:768
    v_mfma_f32_16x16x32_bf16 v[128:131], v[36:39], v[56:59], v[128:131]
    buffer_load_dwordx4 v[40:43], v2, s[52:55], s13 offen sc1
    ds_write_addtid_b32 v100 offset:1024
    v_mfma_f32_16x16x32_bf16 v[120:123], v[32:35], v[56:59], v[120:123]
    ds_write_addtid_b32 v101 offset:1280
    ds_write_addtid_b32 v102 offset:1536
    s_waitcnt lgkmcnt(5)
    v_mfma_f32_16x16x32_bf16 v[116:119], v[36:39], v[20:23], v[116:119]
    v_readlane_b32 s14, v4, 58
    v_mfma_f32_16x16x32_bf16 v[108:111], v[32:35], v[20:23], v[108:111]
    s_waitcnt vmcnt(8)
    v_cmp_u_f32_e64 vcc, v24, v28
    ds_write_addtid_b32 v103 offset:1792
    v_mfma_f32_16x16x32_bf16 v[112:115], v[36:39], v[16:19], v[112:115]
    s_add_u32 m0, s78, 2048
    s_nop 0
    ds_write_addtid_b32 v88 offset:0
    v_mfma_f32_16x16x32_bf16 v[104:107], v[32:35], v[16:19], v[104:107]
    s_cbranch_vccnz interleave_layers__ssm_conv_s4d__mixer_token_mlp__prompt_kernel_rt321
interleave_layers__ssm_conv_s4d__mixer_token_mlp__prompt_kernel_ok322:
    ds_write_addtid_b32 v89 offset:256
    v_mfma_f32_16x16x32_bf16 v[132:135], v[28:31], v[172:175], v[132:135]
    ds_read_b64_tr_b16 v[60:61], v9 offset:16896
    buffer_load_dwordx4 v[36:39], v3, s[52:55], s14 offen sc1
    v_mfma_f32_16x16x32_bf16 v[124:127], v[24:27], v[172:175], v[124:127]
    ds_read_b64_tr_b16 v[62:63], v9 offset:18944
    ds_write_addtid_b32 v90 offset:512
    v_mfma_f32_16x16x32_bf16 v[128:131], v[28:31], v[168:171], v[128:131]
    ds_read_b64_tr_b16 v[56:57], v8 offset:16896
    buffer_load_dwordx4 v[32:35], v2, s[52:55], s14 offen sc1
    ds_write_addtid_b32 v91 offset:768
    v_mfma_f32_16x16x32_bf16 v[120:123], v[24:27], v[168:171], v[120:123]
    ds_read_b64_tr_b16 v[58:59], v8 offset:18944
    ds_write_addtid_b32 v92 offset:1024
    v_mfma_f32_16x16x32_bf16 v[116:119], v[28:31], v[164:167], v[116:119]
    ds_read_b64_tr_b16 v[20:21], v9 offset:16384
    v_readlane_b32 s15, v4, 52
    v_mfma_f32_16x16x32_bf16 v[108:111], v[24:27], v[164:167], v[108:111]
    ds_read_b64_tr_b16 v[22:23], v9 offset:18432
    s_waitcnt vmcnt(8)
    v_cmp_u_f32 vcc, v136, v140
    v_mfma_f32_16x16x32_bf16 v[112:115], v[28:31], v[160:163], v[112:115]
    ds_read_b64_tr_b16 v[16:17], v8 offset:16384
    ds_write_addtid_b32 v93 offset:1280
    v_mfma_f32_16x16x32_bf16 v[104:107], v[24:27], v[160:163], v[104:107]
    ds_read_b64_tr_b16 v[18:19], v8 offset:18432
    s_cbranch_vccnz interleave_layers__ssm_conv_s4d__mixer_token_mlp__prompt_kernel_rt323
interleave_layers__ssm_conv_s4d__mixer_token_mlp__prompt_kernel_ok324:
    ds_write_addtid_b32 v94 offset:1536
    s_waitcnt lgkmcnt(7)
    v_mfma_f32_16x16x32_bf16 v[132:135], v[140:143], v[60:63], v[132:135]
    buffer_load_dwordx4 v[28:31], v3, s[52:55], s15 offen sc1
    v_mfma_f32_16x16x32_bf16 v[124:127], v[136:139], v[60:63], v[124:127]
    ds_write_addtid_b32 v95 offset:1792
    s_nop 0
    s_add_u32 m0, s77, 0
    v_mfma_f32_16x16x32_bf16 v[128:131], v[140:143], v[56:59], v[128:131]
    buffer_load_dwordx4 v[24:27], v2, s[52:55], s15 offen sc1
    ds_write_addtid_b32 v80 offset:0
    v_mfma_f32_16x16x32_bf16 v[120:123], v[136:139], v[56:59], v[120:123]
    ds_write_addtid_b32 v81 offset:256
    ds_write_addtid_b32 v82 offset:512
    s_waitcnt lgkmcnt(5)
    v_mfma_f32_16x16x32_bf16 v[116:119], v[140:143], v[20:23], v[116:119]
    v_readlane_b32 s70, v4, 59
    v_mfma_f32_16x16x32_bf16 v[108:111], v[136:139], v[20:23], v[108:111]
    s_waitcnt vmcnt(8)
    v_cmp_u_f32_e64 vcc, v64, v68
    ds_write_addtid_b32 v83 offset:768
    v_mfma_f32_16x16x32_bf16 v[112:115], v[140:143], v[16:19], v[112:115]
    ds_write_addtid_b32 v84 offset:1024
    v_mfma_f32_16x16x32_bf16 v[104:107], v[136:139], v[16:19], v[104:107]
    s_nop 0
    s_cbranch_vccnz interleave_layers__ssm_conv_s4d__mixer_token_mlp__prompt_kernel_rt325
interleave_layers__ssm_conv_s4d__mixer_token_mlp__prompt_kernel_ok326:
    ds_write_addtid_b32 v85 offset:1280
    v_mfma_f32_16x16x32_bf16 v[132:135], v[68:71], v[188:191], v[132:135]
    ds_read_b64_tr_b16 v[60:61], v9 offset:33280
    buffer_load_dwordx4 v[140:143], v3, s[52:55], s70 offen sc1
    ds_write_addtid_b32 v86 offset:1536
    v_mfma_f32_16x16x32_bf16 v[124:127], v[64:67], v[188:191], v[124:127]
    ds_read_b64_tr_b16 v[62:63], v9 offset:35328
    ds_write_addtid_b32 v87 offset:1792
    v_mfma_f32_16x16x32_bf16 v[128:131], v[68:71], v[184:187], v[128:131]
    ds_read_b64_tr_b16 v[56:57], v8 offset:33280
    buffer_load_dwordx4 v[136:139], v2, s[52:55], s70 offen sc1
    v_mfma_f32_16x16x32_bf16 v[120:123], v[64:67], v[184:187], v[120:123]
    ds_read_b64_tr_b16 v[58:59], v8 offset:35328
    v_mfma_f32_16x16x32_bf16 v[116:119], v[68:71], v[180:183], v[116:119]
    ds_read_b64_tr_b16 v[20:21], v9 offset:32768
    v_readlane_b32 s7, v4, 53
    v_mfma_f32_16x16x32_bf16 v[108:111], v[64:67], v[180:183], v[108:111]
    ds_read_b64_tr_b16 v[22:23], v9 offset:34816
    s_waitcnt vmcnt(8)
    v_cmp_u_f32 vcc, v48, v52
    v_mfma_f32_16x16x32_bf16 v[112:115], v[68:71], v[176:179], v[112:115]
    ds_read_b64_tr_b16 v[16:17], v8 offset:32768
    v_mfma_f32_16x16x32_bf16 v[104:107], v[64:67], v[176:179], v[104:107]
    ds_read_b64_tr_b16 v[18:19], v8 offset:34816
    s_cbranch_vccnz interleave_layers__ssm_conv_s4d__mixer_token_mlp__prompt_kernel_rt327
interleave_layers__ssm_conv_s4d__mixer_token_mlp__prompt_kernel_ok328:
    s_waitcnt lgkmcnt(4)
    v_mfma_f32_16x16x32_bf16 v[132:135], v[52:55], v[60:63], v[132:135]
    buffer_load_dwordx4 v[68:71], v3, s[52:55], s7 offen sc1
    s_waitcnt lgkmcnt(0)
    s_barrier
    v_mfma_f32_16x16x32_bf16 v[124:127], v[48:51], v[60:63], v[124:127]
    ds_read2st64_b32 v[80:81], v10 offset0:0 offset1:1
    ds_read2st64_b32 v[88:89], v10 offset0:8 offset1:9
    v_mfma_f32_16x16x32_bf16 v[128:131], v[52:55], v[56:59], v[128:131]
    buffer_load_dwordx4 v[64:67], v2, s[52:55], s7 offen sc1
    ds_read2st64_b32 v[96:97], v10 offset0:16 offset1:17
    ds_read2st64_b32 v[82:83], v10 offset0:2 offset1:3
    v_mfma_f32_16x16x32_bf16 v[120:123], v[48:51], v[56:59], v[120:123]
    ds_read2st64_b32 v[90:91], v10 offset0:10 offset1:11
    ds_read2st64_b32 v[98:99], v10 offset0:18 offset1:19
    ds_read2st64_b32 v[84:85], v10 offset0:4 offset1:5
    v_mfma_f32_16x16x32_bf16 v[116:119], v[52:55], v[20:23], v[116:119]
    v_readlane_b32 s12, v4, 60
    ds_read2st64_b32 v[92:93], v10 offset0:12 offset1:13
    ds_read2st64_b32 v[100:101], v10 offset0:20 offset1:21
    v_mfma_f32_16x16x32_bf16 v[108:111], v[48:51], v[20:23], v[108:111]
    s_waitcnt vmcnt(8)
    v_cmp_u_f32 vcc, v40, v44
    ds_read2st64_b32 v[86:87], v10 offset0:6 offset1:7
    v_mfma_f32_16x16x32_bf16 v[112:115], v[52:55], v[16:19], v[112:115]
    ds_read2st64_b32 v[94:95], v10 offset0:14 offset1:15
    ds_read2st64_b32 v[102:103], v10 offset0:22 offset1:23
    v_mfma_f32_16x16x32_bf16 v[104:107], v[48:51], v[16:19], v[104:107]
    s_cbranch_vccnz interleave_layers__ssm_conv_s4d__mixer_token_mlp__prompt_kernel_rt329
interleave_layers__ssm_conv_s4d__mixer_token_mlp__prompt_kernel_ok330:
    s_waitcnt lgkmcnt(9)
    v_add_f32_e64 v72, v80, v72
    v_mfma_f32_16x16x32_bf16 v[132:135], v[44:47], v[204:207], v[132:135]
    ds_read_b64_tr_b16 v[60:61], v7 offset:33280
    buffer_load_dwordx4 v[52:55], v3, s[52:55], s12 offen sc1
    v_mfma_f32_16x16x32_bf16 v[124:127], v[40:43], v[204:207], v[124:127]
    ds_read_b64_tr_b16 v[62:63], v7 offset:35328
    v_add_f32 v73, v81, v73
    v_add_f32 v88, v96, v88
    v_mfma_f32_16x16x32_bf16 v[128:131], v[44:47], v[200:203], v[128:131]
    ds_read_b64_tr_b16 v[56:57], v6 offset:33280
    buffer_load_dwordx4 v[48:51], v2, s[52:55], s12 offen sc1
    v_add_f32_e64 v89, v97, v89
    v_mfma_f32_16x16x32_bf16 v[120:123], v[40:43], v[200:203], v[120:123]
    ds_read_b64_tr_b16 v[58:59], v6 offset:35328
    s_waitcnt lgkmcnt(10)
    v_add_f32 v74, v82, v74
    v_mfma_f32_16x16x32_bf16 v[116:119], v[44:47], v[196:199], v[116:119]
    ds_read_b64_tr_b16 v[20:21], v7 offset:32768
    v_readlane_b32 s13, v4, 54
    v_add_f32_e64 v75, v83, v75
    v_mfma_f32_16x16x32_bf16 v[108:111], v[40:43], v[196:199], v[108:111]
    ds_read_b64_tr_b16 v[22:23], v7 offset:34816
    s_waitcnt vmcnt(8)
    v_cmp_u_f32 vcc, v32, v36
    v_mfma_f32_16x16x32_bf16 v[112:115], v[44:47], v[192:195], v[112:115]
    ds_read_b64_tr_b16 v[16:17], v6 offset:32768
    v_add_f32 v90, v98, v90
    v_add_f32 v91, v99, v91
    v_mfma_f32_16x16x32_bf16 v[104:107], v[40:43], v[192:195], v[104:107]
    ds_read_b64_tr_b16 v[18:19], v6 offset:34816
    s_cbranch_vccnz interleave_layers__ssm_conv_s4d__mixer_token_mlp__prompt_kernel_rt331
interleave_layers__ssm_conv_s4d__mixer_token_mlp__prompt_kernel_ok332:
    s_waitcnt lgkmcnt(11)
    v_add_f32 v76, v84, v76
    s_waitcnt lgkmcnt(4)
    v_mfma_f32_16x16x32_bf16 v[132:135], v[36:39], v[60:63], v[132:135]
    buffer_load_dwordx4 v[44:47], v3, s[52:55], s13 offen sc1
    v_mfma_f32_16x16x32_bf16 v[124:127], v[32:35], v[60:63], v[124:127]
    v_add_f32 v77, v85, v77
    v_add_f32 v92, v100, v92
    v_add_f32_e64 v93, v101, v93
    v_mfma_f32_16x16x32_bf16 v[128:131], v[36:39], v[56:59], v[128:131]
    buffer_load_dwordx4 v[40:43], v2, s[52:55], s13 offen sc1
    v_add_f32 v78, v86, v78
    v_add_f32 v79, v87, v79
    v_mfma_f32_16x16x32_bf16 v[120:123], v[32:35], v[56:59], v[120:123]
    v_add_f32 v94, v102, v94
    v_add_f32 v95, v103, v95
    v_add_f32 v72, v88, v72
    s_waitcnt lgkmcnt(0)
    v_mfma_f32_16x16x32_bf16 v[116:119], v[36:39], v[20:23], v[116:119]
    v_readlane_b32 s14, v4, 61
    v_add_f32_e64 v73, v89, v73
    v_mfma_f32_16x16x32_bf16 v[108:111], v[32:35], v[20:23], v[108:111]
    s_waitcnt vmcnt(8)
    v_cmp_u_f32 vcc, v24, v28
    v_add_f32_e64 v74, v90, v74
    v_mfma_f32_16x16x32_bf16 v[112:115], v[36:39], v[16:19], v[112:115]
    v_add_f32 v75, v91, v75
    v_add_f32 v76, v92, v76
    v_add_f32_e64 v77, v93, v77
    v_mfma_f32_16x16x32_bf16 v[104:107], v[32:35], v[16:19], v[104:107]
    s_cbranch_vccnz interleave_layers__ssm_conv_s4d__mixer_token_mlp__prompt_kernel_rt333
interleave_layers__ssm_conv_s4d__mixer_token_mlp__prompt_kernel_ok334:
    v_add_f32 v78, v94, v78
    v_add_f32_e64 v79, v95, v79
    v_mfma_f32_16x16x32_bf16 v[132:135], v[28:31], v[220:223], v[132:135]
    ds_read_b64_tr_b16 v[60:61], v7 offset:512
    buffer_load_dwordx4 v[36:39], v3, s[52:55], s14 offen sc1
    v_cvt_pk_bf16_f32 v88, v72, v73
    v_mfma_f32_16x16x32_bf16 v[124:127], v[24:27], v[220:223], v[124:127]
    ds_read_b64_tr_b16 v[62:63], v7 offset:2560
    v_cvt_pk_bf16_f32 v89, v74, v75
    v_cvt_pk_bf16_f32 v90, v76, v77
    v_mfma_f32_16x16x32_bf16 v[128:131], v[28:31], v[216:219], v[128:131]
    ds_read_b64_tr_b16 v[56:57], v6 offset:512
    buffer_load_dwordx4 v[32:35], v2, s[52:55], s14 offen sc1
    v_cvt_pk_bf16_f32 v91, v78, v79
    v_mfma_f32_16x16x32_bf16 v[120:123], v[24:27], v[216:219], v[120:123]
    ds_read_b64_tr_b16 v[58:59], v6 offset:2560
    ds_write_b64 v11, v[88:89] offset:32768
    ds_write_b64 v11, v[90:91] offset:34048
    v_mfma_f32_16x16x32_bf16 v[116:119], v[28:31], v[212:215], v[116:119]
    ds_read_b64_tr_b16 v[20:21], v7 offset:0
    v_mfma_f32_16x16x32_bf16 v[108:111], v[24:27], v[212:215], v[108:111]
    ds_read_b64_tr_b16 v[22:23], v7 offset:2048
    s_waitcnt vmcnt(8)
    v_cmp_u_f32 vcc, v136, v140
    v_mfma_f32_16x16x32_bf16 v[112:115], v[28:31], v[208:211], v[112:115]
    ds_read_b64_tr_b16 v[16:17], v6 offset:0
    v_mfma_f32_16x16x32_bf16 v[104:107], v[24:27], v[208:211], v[104:107]
    ds_read_b64_tr_b16 v[18:19], v6 offset:2048
    s_cbranch_vccnz interleave_layers__ssm_conv_s4d__mixer_token_mlp__prompt_kernel_rt335
interleave_layers__ssm_conv_s4d__mixer_token_mlp__prompt_kernel_ok336:
    s_waitcnt lgkmcnt(6)
    v_mfma_f32_16x16x32_bf16 v[132:135], v[140:143], v[60:63], v[132:135]
    v_mfma_f32_16x16x32_bf16 v[124:127], v[136:139], v[60:63], v[124:127]
    v_mfma_f32_16x16x32_bf16 v[128:131], v[140:143], v[56:59], v[128:131]
    v_mfma_f32_16x16x32_bf16 v[120:123], v[136:139], v[56:59], v[120:123]
    s_waitcnt lgkmcnt(0)
    v_mfma_f32_16x16x32_bf16 v[116:119], v[140:143], v[20:23], v[116:119]
    v_mfma_f32_16x16x32_bf16 v[108:111], v[136:139], v[20:23], v[108:111]
    s_waitcnt vmcnt(6)
    v_cmp_u_f32_e64 vcc, v64, v68
    v_mfma_f32_16x16x32_bf16 v[112:115], v[140:143], v[16:19], v[112:115]
    v_mfma_f32_16x16x32_bf16 v[104:107], v[136:139], v[16:19], v[104:107]
    s_nop 0
    s_cbranch_vccnz interleave_layers__ssm_conv_s4d__mixer_token_mlp__prompt_kernel_rt337
interleave_layers__ssm_conv_s4d__mixer_token_mlp__prompt_kernel_ok338:
    v_mfma_f32_16x16x32_bf16 v[132:135], v[68:71], v[236:239], v[132:135]
    ds_read_b64_tr_b16 v[60:61], v7 offset:16896
    v_mfma_f32_16x16x32_bf16 v[124:127], v[64:67], v[236:239], v[124:127]
    ds_read_b64_tr_b16 v[62:63], v7 offset:18944
    v_mfma_f32_16x16x32_bf16 v[128:131], v[68:71], v[232:235], v[128:131]
    ds_read_b64_tr_b16 v[56:57], v6 offset:16896
    v_mfma_f32_16x16x32_bf16 v[120:123], v[64:67], v[232:235], v[120:123]
    ds_read_b64_tr_b16 v[58:59], v6 offset:18944
    v_mfma_f32_16x16x32_bf16 v[116:119], v[68:71], v[228:231], v[116:119]
    ds_read_b64_tr_b16 v[20:21], v7 offset:16384
    v_mfma_f32_16x16x32_bf16 v[108:111], v[64:67], v[228:231], v[108:111]
    ds_read_b64_tr_b16 v[22:23], v7 offset:18432
    s_waitcnt vmcnt(4)
    v_cmp_u_f32 vcc, v48, v52
    v_mfma_f32_16x16x32_bf16 v[112:115], v[68:71], v[224:227], v[112:115]
    ds_read_b64_tr_b16 v[16:17], v6 offset:16384
    v_mfma_f32_16x16x32_bf16 v[104:107], v[64:67], v[224:227], v[104:107]
    ds_read_b64_tr_b16 v[18:19], v6 offset:18432
    s_cbranch_vccnz interleave_layers__ssm_conv_s4d__mixer_token_mlp__prompt_kernel_rt339
interleave_layers__ssm_conv_s4d__mixer_token_mlp__prompt_kernel_ok340:
    s_waitcnt lgkmcnt(4)
    v_mfma_f32_16x16x32_bf16 v[132:135], v[52:55], v[60:63], v[132:135]
    v_mfma_f32_16x16x32_bf16 v[124:127], v[48:51], v[60:63], v[124:127]
    v_mfma_f32_16x16x32_bf16 v[128:131], v[52:55], v[56:59], v[128:131]
    v_mfma_f32_16x16x32_bf16 v[120:123], v[48:51], v[56:59], v[120:123]
    s_waitcnt lgkmcnt(0)
    v_mfma_f32_16x16x32_bf16 v[116:119], v[52:55], v[20:23], v[116:119]
    v_mfma_f32_16x16x32_bf16 v[108:111], v[48:51], v[20:23], v[108:111]
    s_waitcnt vmcnt(2)
    v_cmp_u_f32_e64 vcc, v40, v44
    v_mfma_f32_16x16x32_bf16 v[112:115], v[52:55], v[16:19], v[112:115]
    v_mfma_f32_16x16x32_bf16 v[104:107], v[48:51], v[16:19], v[104:107]
    s_nop 0
    s_cbranch_vccnz interleave_layers__ssm_conv_s4d__mixer_token_mlp__prompt_kernel_rt341
interleave_layers__ssm_conv_s4d__mixer_token_mlp__prompt_kernel_ok342:
    v_mfma_f32_16x16x32_bf16 v[132:135], v[44:47], v[252:255], v[132:135]
    ds_read_b64_tr_b16 v[60:61], v7 offset:49664
    v_mfma_f32_16x16x32_bf16 v[124:127], v[40:43], v[252:255], v[124:127]
    ds_read_b64_tr_b16 v[62:63], v7 offset:51712
    v_mfma_f32_16x16x32_bf16 v[128:131], v[44:47], v[248:251], v[128:131]
    ds_read_b64_tr_b16 v[56:57], v6 offset:49664
    v_mfma_f32_16x16x32_bf16 v[120:123], v[40:43], v[248:251], v[120:123]
    ds_read_b64_tr_b16 v[58:59], v6 offset:51712
    v_mfma_f32_16x16x32_bf16 v[116:119], v[44:47], v[244:247], v[116:119]
    ds_read_b64_tr_b16 v[20:21], v7 offset:49152
    v_mfma_f32_16x16x32_bf16 v[108:111], v[40:43], v[244:247], v[108:111]
    ds_read_b64_tr_b16 v[22:23], v7 offset:51200
    s_waitcnt vmcnt(0)
    v_cmp_u_f32 vcc, v32, v36
    v_mfma_f32_16x16x32_bf16 v[112:115], v[44:47], v[240:243], v[112:115]
    ds_read_b64_tr_b16 v[16:17], v6 offset:49152
    v_mfma_f32_16x16x32_bf16 v[104:107], v[40:43], v[240:243], v[104:107]
    ds_read_b64_tr_b16 v[18:19], v6 offset:51200
    s_cbranch_vccnz interleave_layers__ssm_conv_s4d__mixer_token_mlp__prompt_kernel_rt343
interleave_layers__ssm_conv_s4d__mixer_token_mlp__prompt_kernel_ok344:
    s_waitcnt lgkmcnt(4)
    v_mfma_f32_16x16x32_bf16 v[132:135], v[36:39], v[60:63], v[132:135]
    s_barrier
    v_mfma_f32_16x16x32_bf16 v[124:127], v[32:35], v[60:63], v[124:127]
    v_mfma_f32_16x16x32_bf16 v[128:131], v[36:39], v[56:59], v[128:131]
    v_mfma_f32_16x16x32_bf16 v[120:123], v[32:35], v[56:59], v[120:123]
    s_waitcnt lgkmcnt(0)
    v_mfma_f32_16x16x32_bf16 v[116:119], v[36:39], v[20:23], v[116:119]
    s_add_u32 m0, s79, 4096
    v_mfma_f32_16x16x32_bf16 v[112:115], v[36:39], v[16:19], v[112:115]
    ds_write_addtid_b32 v128 offset:0
    ds_write_addtid_b32 v129 offset:256
    v_mfma_f32_16x16x32_bf16 v[108:111], v[32:35], v[20:23], v[108:111]
    ds_write_addtid_b32 v130 offset:512
    ds_write_addtid_b32 v131 offset:768
    v_mfma_f32_16x16x32_bf16 v[104:107], v[32:35], v[16:19], v[104:107]
    ds_write_addtid_b32 v132 offset:1024
    ds_write_addtid_b32 v133 offset:1280
    ds_write_addtid_b32 v134 offset:1536
    ds_write_addtid_b32 v135 offset:1792
    s_add_u32 m0, s78, 2048
    s_nop 0
    s_nop 0
    ds_write_addtid_b32 v120 offset:0
    ds_write_addtid_b32 v121 offset:256
    ds_write_addtid_b32 v122 offset:512
    ds_write_addtid_b32 v123 offset:768
    ds_write_addtid_b32 v124 offset:1024
    ds_write_addtid_b32 v125 offset:1280
    ds_write_addtid_b32 v126 offset:1536
    ds_write_addtid_b32 v127 offset:1792
    s_add_u32 m0, s77, 0
    s_nop 0
    ds_write_addtid_b32 v112 offset:0
    ds_write_addtid_b32 v113 offset:256
    ds_write_addtid_b32 v114 offset:512
    ds_write_addtid_b32 v115 offset:768
    ds_write_addtid_b32 v116 offset:1024
    ds_write_addtid_b32 v117 offset:1280
    ds_write_addtid_b32 v118 offset:1536
    ds_write_addtid_b32 v119 offset:1792
    s_waitcnt lgkmcnt(0)
    s_barrier
    ds_read2st64_b32 v[112:113], v10 offset0:0 offset1:1
    ds_read2st64_b32 v[120:121], v10 offset0:8 offset1:9
    ds_read2st64_b32 v[128:129], v10 offset0:16 offset1:17
    ds_read2st64_b32 v[114:115], v10 offset0:2 offset1:3
    ds_read2st64_b32 v[122:123], v10 offset0:10 offset1:11
    ds_read2st64_b32 v[130:131], v10 offset0:18 offset1:19
    ds_read2st64_b32 v[116:117], v10 offset0:4 offset1:5
    ds_read2st64_b32 v[124:125], v10 offset0:12 offset1:13
    ds_read2st64_b32 v[132:133], v10 offset0:20 offset1:21
    ds_read2st64_b32 v[118:119], v10 offset0:6 offset1:7
    ds_read2st64_b32 v[126:127], v10 offset0:14 offset1:15
    ds_read2st64_b32 v[134:135], v10 offset0:22 offset1:23
    v_bfe_u32 v5, v0, 2, 4
    v_and_b32_e64 v73, 0x30, v1
    v_mul_u32_u24 v72, 80, v5
    v_add3_u32 v72, v72, v73, s86
    v_lshl_add_u32 v73, v5, 10, v73
    s_waitcnt lgkmcnt(9)
    v_pk_add_f32 v[104:105], v[104:105], v[112:113]
    v_pk_add_f32 v[120:121], v[120:121], v[128:129]
    s_waitcnt lgkmcnt(6)
    v_pk_add_f32 v[106:107], v[106:107], v[114:115]
    v_pk_add_f32 v[122:123], v[122:123], v[130:131]
    s_waitcnt lgkmcnt(3)
    v_pk_add_f32 v[108:109], v[108:109], v[116:117]
    v_pk_add_f32 v[124:125], v[124:125], v[132:133]
    s_waitcnt lgkmcnt(0)
    v_pk_add_f32 v[110:111], v[110:111], v[118:119]
    v_pk_add_f32 v[126:127], v[126:127], v[134:135]
    v_pk_add_f32 v[104:105], v[104:105], v[120:121]
    v_pk_add_f32 v[106:107], v[106:107], v[122:123]
    v_pk_add_f32 v[108:109], v[108:109], v[124:125]
    v_pk_add_f32 v[110:111], v[110:111], v[126:127]
    v_cvt_pk_bf16_f32 v120, v104, v105
    v_cvt_pk_bf16_f32 v121, v106, v107
    v_cvt_pk_bf16_f32 v122, v108, v109
    v_cvt_pk_bf16_f32 v123, v110, v111
    ds_write_b64 v11, v[120:121] offset:32800
    ds_write_b64 v11, v[122:123] offset:34080
    s_waitcnt lgkmcnt(0)
    ds_read_b128 v[112:115], v72 offset:32768
    ds_read_b128 v[116:119], v72 offset:34048
    s_waitcnt lgkmcnt(1)
    buffer_store_dwordx4 v[112:115], v73, s[56:59], s80 offen sc1
    s_waitcnt lgkmcnt(0)
    buffer_store_dwordx4 v[116:119], v73, s[56:59], s81 offen sc1
    s_nop 0
interleave_layers__ssm_conv_s4d__mixer_token_mlp__prompt_kernel_end1:
    s_endpgm
interleave_layers__ssm_conv_s4d__mixer_token_mlp__prompt_kernel_frt3:
    s_mov_b32 s43, 0
interleave_layers__ssm_conv_s4d__mixer_token_mlp__prompt_kernel_flp5:
    s_mov_b64 exec, vcc
    buffer_load_dword v246, v247, s[52:55], s10 offen sc1
    s_waitcnt vmcnt(0)
    v_cmp_ne_u32 vcc, s68, v246
    s_add_u32 s43, s43, 1
    s_cmp_ge_u32 s43, 32768
    s_cbranch_scc1 interleave_layers__ssm_conv_s4d__mixer_token_mlp__prompt_kernel_ffin6
    s_cbranch_vccnz interleave_layers__ssm_conv_s4d__mixer_token_mlp__prompt_kernel_flp5
interleave_layers__ssm_conv_s4d__mixer_token_mlp__prompt_kernel_ffin6:
    s_mov_b64 exec, -1
    s_branch interleave_layers__ssm_conv_s4d__mixer_token_mlp__prompt_kernel_fok4
interleave_layers__ssm_conv_s4d__mixer_token_mlp__prompt_kernel_gretry11:
    s_mov_b32 s43, 0
interleave_layers__ssm_conv_s4d__mixer_token_mlp__prompt_kernel_glp13:
    s_mov_b64 exec, vcc
    buffer_load_dwordx4 v[112:115], v106, s[52:55], s10 offen sc1
    s_mov_b64 exec, -1
    s_waitcnt vmcnt(1)
    v_max3_u32 v107, v116, v117, v118
    v_cmpx_u_f32 vcc, v107, v119
    s_cbranch_execz interleave_layers__ssm_conv_s4d__mixer_token_mlp__prompt_kernel_gsk15
    buffer_load_dwordx4 v[116:119], v106, s[52:55], s11 offen sc1
interleave_layers__ssm_conv_s4d__mixer_token_mlp__prompt_kernel_gsk15:
    s_mov_b64 exec, -1
    s_waitcnt vmcnt(0)
    v_max3_u32 v107, v112, v113, v114
    v_cmp_u_f32 vcc, v107, v115
    s_add_u32 s43, s43, 1
    s_cmp_ge_u32 s43, 32768
    s_cbranch_scc1 interleave_layers__ssm_conv_s4d__mixer_token_mlp__prompt_kernel_gfin14
    s_cbranch_vccnz interleave_layers__ssm_conv_s4d__mixer_token_mlp__prompt_kernel_glp13
interleave_layers__ssm_conv_s4d__mixer_token_mlp__prompt_kernel_gfin14:
    s_mov_b64 exec, -1
    s_branch interleave_layers__ssm_conv_s4d__mixer_token_mlp__prompt_kernel_gok12
interleave_layers__ssm_conv_s4d__mixer_token_mlp__prompt_kernel_gretry16:
    s_mov_b32 s43, 0
interleave_layers__ssm_conv_s4d__mixer_token_mlp__prompt_kernel_glp18:
    s_mov_b64 exec, vcc
    buffer_load_dwordx4 v[116:119], v106, s[52:55], s11 offen sc1
    s_waitcnt vmcnt(0)
    v_max3_u32 v107, v116, v117, v118
    v_cmp_u_f32_e64 vcc, v107, v119
    s_add_u32 s43, s43, 1
    s_cmp_ge_u32 s43, 32768
    s_nop 0
    s_cbranch_scc1 interleave_layers__ssm_conv_s4d__mixer_token_mlp__prompt_kernel_gfin19
    s_cbranch_vccnz interleave_layers__ssm_conv_s4d__mixer_token_mlp__prompt_kernel_glp18
interleave_layers__ssm_conv_s4d__mixer_token_mlp__prompt_kernel_gfin19:
    s_mov_b64 exec, -1
    s_branch interleave_layers__ssm_conv_s4d__mixer_token_mlp__prompt_kernel_gok17
interleave_layers__ssm_conv_s4d__mixer_token_mlp__prompt_kernel_reload20:
    s_sleep 2
    buffer_load_dwordx4 v[68:71], v11, s[52:55], s7 offen sc1
    buffer_load_dwordx4 v[64:67], v10, s[52:55], s7 offen sc1
    buffer_load_dwordx4 v[60:63], v11, s[52:55], s12 offen sc1
    buffer_load_dwordx4 v[56:59], v10, s[52:55], s12 offen sc1
    buffer_load_dwordx4 v[52:55], v11, s[52:55], s13 offen sc1
    buffer_load_dwordx4 v[48:51], v10, s[52:55], s13 offen sc1
    buffer_load_dwordx4 v[44:47], v11, s[52:55], s14 offen sc1
    buffer_load_dwordx4 v[40:43], v10, s[52:55], s14 offen sc1
    buffer_load_dwordx4 v[36:39], v11, s[52:55], s15 offen sc1
    buffer_load_dwordx4 v[32:35], v10, s[52:55], s15 offen sc1
    s_add_u32 s43, s43, 1
    s_waitcnt vmcnt(8)
    v_cmp_u_f32_e64 vcc, v64, v68
    s_cmp_ge_u32 s43, 32768
    s_cbranch_scc1 interleave_layers__ssm_conv_s4d__mixer_token_mlp__prompt_kernel_rfin34
    s_cbranch_vccnz interleave_layers__ssm_conv_s4d__mixer_token_mlp__prompt_kernel_reload20
interleave_layers__ssm_conv_s4d__mixer_token_mlp__prompt_kernel_rfin34:
    s_setpc_b64 s[44:45]
interleave_layers__ssm_conv_s4d__mixer_token_mlp__prompt_kernel_reload21:
    s_sleep 2
    buffer_load_dwordx4 v[60:63], v11, s[52:55], s12 offen sc1
    buffer_load_dwordx4 v[56:59], v10, s[52:55], s12 offen sc1
    buffer_load_dwordx4 v[52:55], v11, s[52:55], s13 offen sc1
    buffer_load_dwordx4 v[48:51], v10, s[52:55], s13 offen sc1
    buffer_load_dwordx4 v[44:47], v11, s[52:55], s14 offen sc1
    buffer_load_dwordx4 v[40:43], v10, s[52:55], s14 offen sc1
    buffer_load_dwordx4 v[36:39], v11, s[52:55], s15 offen sc1
    buffer_load_dwordx4 v[32:35], v10, s[52:55], s15 offen sc1
    buffer_load_dwordx4 v[28:31], v11, s[52:55], s70 offen sc1
    buffer_load_dwordx4 v[24:27], v10, s[52:55], s70 offen sc1
    s_add_u32 s43, s43, 1
    s_waitcnt vmcnt(8)
    v_cmp_u_f32_e64 vcc, v56, v60
    s_cmp_ge_u32 s43, 32768
    s_cbranch_scc1 interleave_layers__ssm_conv_s4d__mixer_token_mlp__prompt_kernel_rfin35
    s_cbranch_vccnz interleave_layers__ssm_conv_s4d__mixer_token_mlp__prompt_kernel_reload21
interleave_layers__ssm_conv_s4d__mixer_token_mlp__prompt_kernel_rfin35:
    s_setpc_b64 s[44:45]
interleave_layers__ssm_conv_s4d__mixer_token_mlp__prompt_kernel_reload22:
    s_sleep 2
    buffer_load_dwordx4 v[52:55], v11, s[52:55], s13 offen sc1
    buffer_load_dwordx4 v[48:51], v10, s[52:55], s13 offen sc1
    buffer_load_dwordx4 v[44:47], v11, s[52:55], s14 offen sc1
    buffer_load_dwordx4 v[40:43], v10, s[52:55], s14 offen sc1
    buffer_load_dwordx4 v[36:39], v11, s[52:55], s15 offen sc1
    buffer_load_dwordx4 v[32:35], v10, s[52:55], s15 offen sc1
    buffer_load_dwordx4 v[28:31], v11, s[52:55], s70 offen sc1
    buffer_load_dwordx4 v[24:27], v10, s[52:55], s70 offen sc1
    buffer_load_dwordx4 v[68:71], v11, s[52:55], s7 offen sc1
    buffer_load_dwordx4 v[64:67], v10, s[52:55], s7 offen sc1
    s_add_u32 s43, s43, 1
    s_waitcnt vmcnt(8)
    v_cmp_u_f32_e64 vcc, v48, v52
    s_cmp_ge_u32 s43, 32768
    s_cbranch_scc1 interleave_layers__ssm_conv_s4d__mixer_token_mlp__prompt_kernel_rfin36
    s_cbranch_vccnz interleave_layers__ssm_conv_s4d__mixer_token_mlp__prompt_kernel_reload22
interleave_layers__ssm_conv_s4d__mixer_token_mlp__prompt_kernel_rfin36:
    s_setpc_b64 s[44:45]
interleave_layers__ssm_conv_s4d__mixer_token_mlp__prompt_kernel_reload23:
    s_sleep 2
    buffer_load_dwordx4 v[44:47], v11, s[52:55], s14 offen sc1
    buffer_load_dwordx4 v[40:43], v10, s[52:55], s14 offen sc1
    buffer_load_dwordx4 v[36:39], v11, s[52:55], s15 offen sc1
    buffer_load_dwordx4 v[32:35], v10, s[52:55], s15 offen sc1
    buffer_load_dwordx4 v[28:31], v11, s[52:55], s70 offen sc1
    buffer_load_dwordx4 v[24:27], v10, s[52:55], s70 offen sc1
    buffer_load_dwordx4 v[68:71], v11, s[52:55], s7 offen sc1
    buffer_load_dwordx4 v[64:67], v10, s[52:55], s7 offen sc1
    buffer_load_dwordx4 v[60:63], v11, s[52:55], s12 offen sc1
    buffer_load_dwordx4 v[56:59], v10, s[52:55], s12 offen sc1
    s_add_u32 s43, s43, 1
    s_waitcnt vmcnt(8)
    v_cmp_u_f32_e64 vcc, v40, v44
    s_cmp_ge_u32 s43, 32768
    s_cbranch_scc1 interleave_layers__ssm_conv_s4d__mixer_token_mlp__prompt_kernel_rfin37
    s_cbranch_vccnz interleave_layers__ssm_conv_s4d__mixer_token_mlp__prompt_kernel_reload23
interleave_layers__ssm_conv_s4d__mixer_token_mlp__prompt_kernel_rfin37:
    s_setpc_b64 s[44:45]
interleave_layers__ssm_conv_s4d__mixer_token_mlp__prompt_kernel_reload24:
    s_sleep 2
    buffer_load_dwordx4 v[36:39], v11, s[52:55], s15 offen sc1
    buffer_load_dwordx4 v[32:35], v10, s[52:55], s15 offen sc1
    buffer_load_dwordx4 v[28:31], v11, s[52:55], s70 offen sc1
    buffer_load_dwordx4 v[24:27], v10, s[52:55], s70 offen sc1
    buffer_load_dwordx4 v[68:71], v11, s[52:55], s7 offen sc1
    buffer_load_dwordx4 v[64:67], v10, s[52:55], s7 offen sc1
    buffer_load_dwordx4 v[60:63], v11, s[52:55], s12 offen sc1
    buffer_load_dwordx4 v[56:59], v10, s[52:55], s12 offen sc1
    buffer_load_dwordx4 v[52:55], v11, s[52:55], s13 offen sc1
    buffer_load_dwordx4 v[48:51], v10, s[52:55], s13 offen sc1
    s_add_u32 s43, s43, 1
    s_waitcnt vmcnt(8)
    v_cmp_u_f32_e64 vcc, v32, v36
    s_cmp_ge_u32 s43, 32768
    s_cbranch_scc1 interleave_layers__ssm_conv_s4d__mixer_token_mlp__prompt_kernel_rfin38
    s_cbranch_vccnz interleave_layers__ssm_conv_s4d__mixer_token_mlp__prompt_kernel_reload24
interleave_layers__ssm_conv_s4d__mixer_token_mlp__prompt_kernel_rfin38:
    s_setpc_b64 s[44:45]
interleave_layers__ssm_conv_s4d__mixer_token_mlp__prompt_kernel_reload25:
    s_sleep 2
    buffer_load_dwordx4 v[28:31], v11, s[52:55], s70 offen sc1
    buffer_load_dwordx4 v[24:27], v10, s[52:55], s70 offen sc1
    buffer_load_dwordx4 v[68:71], v11, s[52:55], s7 offen sc1
    buffer_load_dwordx4 v[64:67], v10, s[52:55], s7 offen sc1
    buffer_load_dwordx4 v[60:63], v11, s[52:55], s12 offen sc1
    buffer_load_dwordx4 v[56:59], v10, s[52:55], s12 offen sc1
    buffer_load_dwordx4 v[52:55], v11, s[52:55], s13 offen sc1
    buffer_load_dwordx4 v[48:51], v10, s[52:55], s13 offen sc1
    buffer_load_dwordx4 v[44:47], v11, s[52:55], s14 offen sc1
    buffer_load_dwordx4 v[40:43], v10, s[52:55], s14 offen sc1
    s_add_u32 s43, s43, 1
    s_waitcnt vmcnt(8)
    v_cmp_u_f32_e64 vcc, v24, v28
    s_cmp_ge_u32 s43, 32768
    s_cbranch_scc1 interleave_layers__ssm_conv_s4d__mixer_token_mlp__prompt_kernel_rfin39
    s_cbranch_vccnz interleave_layers__ssm_conv_s4d__mixer_token_mlp__prompt_kernel_reload25
interleave_layers__ssm_conv_s4d__mixer_token_mlp__prompt_kernel_rfin39:
    s_setpc_b64 s[44:45]
interleave_layers__ssm_conv_s4d__mixer_token_mlp__prompt_kernel_rt40:
    s_call_b64 s[44:45], interleave_layers__ssm_conv_s4d__mixer_token_mlp__prompt_kernel_reload20
    s_branch interleave_layers__ssm_conv_s4d__mixer_token_mlp__prompt_kernel_ok41
interleave_layers__ssm_conv_s4d__mixer_token_mlp__prompt_kernel_rt42:
    s_call_b64 s[44:45], interleave_layers__ssm_conv_s4d__mixer_token_mlp__prompt_kernel_reload21
    s_branch interleave_layers__ssm_conv_s4d__mixer_token_mlp__prompt_kernel_ok43
interleave_layers__ssm_conv_s4d__mixer_token_mlp__prompt_kernel_rt44:
    s_call_b64 s[44:45], interleave_layers__ssm_conv_s4d__mixer_token_mlp__prompt_kernel_reload22
    s_branch interleave_layers__ssm_conv_s4d__mixer_token_mlp__prompt_kernel_ok45
interleave_layers__ssm_conv_s4d__mixer_token_mlp__prompt_kernel_rt46:
    s_call_b64 s[44:45], interleave_layers__ssm_conv_s4d__mixer_token_mlp__prompt_kernel_reload23
    s_branch interleave_layers__ssm_conv_s4d__mixer_token_mlp__prompt_kernel_ok47
interleave_layers__ssm_conv_s4d__mixer_token_mlp__prompt_kernel_rt48:
    s_call_b64 s[44:45], interleave_layers__ssm_conv_s4d__mixer_token_mlp__prompt_kernel_reload24
    s_branch interleave_layers__ssm_conv_s4d__mixer_token_mlp__prompt_kernel_ok49
interleave_layers__ssm_conv_s4d__mixer_token_mlp__prompt_kernel_rt50:
    s_call_b64 s[44:45], interleave_layers__ssm_conv_s4d__mixer_token_mlp__prompt_kernel_reload25
    s_branch interleave_layers__ssm_conv_s4d__mixer_token_mlp__prompt_kernel_ok51
interleave_layers__ssm_conv_s4d__mixer_token_mlp__prompt_kernel_rt52:
    s_call_b64 s[44:45], interleave_layers__ssm_conv_s4d__mixer_token_mlp__prompt_kernel_reload20
    s_branch interleave_layers__ssm_conv_s4d__mixer_token_mlp__prompt_kernel_ok53
interleave_layers__ssm_conv_s4d__mixer_token_mlp__prompt_kernel_rt54:
    s_call_b64 s[44:45], interleave_layers__ssm_conv_s4d__mixer_token_mlp__prompt_kernel_reload21
    s_branch interleave_layers__ssm_conv_s4d__mixer_token_mlp__prompt_kernel_ok55
interleave_layers__ssm_conv_s4d__mixer_token_mlp__prompt_kernel_rt56:
    s_call_b64 s[44:45], interleave_layers__ssm_conv_s4d__mixer_token_mlp__prompt_kernel_reload22
    s_branch interleave_layers__ssm_conv_s4d__mixer_token_mlp__prompt_kernel_ok57
interleave_layers__ssm_conv_s4d__mixer_token_mlp__prompt_kernel_rt58:
    s_call_b64 s[44:45], interleave_layers__ssm_conv_s4d__mixer_token_mlp__prompt_kernel_reload23
    s_branch interleave_layers__ssm_conv_s4d__mixer_token_mlp__prompt_kernel_ok59
interleave_layers__ssm_conv_s4d__mixer_token_mlp__prompt_kernel_rt60:
    s_call_b64 s[44:45], interleave_layers__ssm_conv_s4d__mixer_token_mlp__prompt_kernel_reload24
    s_branch interleave_layers__ssm_conv_s4d__mixer_token_mlp__prompt_kernel_ok61
interleave_layers__ssm_conv_s4d__mixer_token_mlp__prompt_kernel_rt62:
    s_call_b64 s[44:45], interleave_layers__ssm_conv_s4d__mixer_token_mlp__prompt_kernel_reload25
    s_branch interleave_layers__ssm_conv_s4d__mixer_token_mlp__prompt_kernel_ok63
interleave_layers__ssm_conv_s4d__mixer_token_mlp__prompt_kernel_rt64:
    s_call_b64 s[44:45], interleave_layers__ssm_conv_s4d__mixer_token_mlp__prompt_kernel_reload20
    s_branch interleave_layers__ssm_conv_s4d__mixer_token_mlp__prompt_kernel_ok65
interleave_layers__ssm_conv_s4d__mixer_token_mlp__prompt_kernel_rt66:
    s_call_b64 s[44:45], interleave_layers__ssm_conv_s4d__mixer_token_mlp__prompt_kernel_reload21
    s_branch interleave_layers__ssm_conv_s4d__mixer_token_mlp__prompt_kernel_ok67
interleave_layers__ssm_conv_s4d__mixer_token_mlp__prompt_kernel_rt68:
    s_call_b64 s[44:45], interleave_layers__ssm_conv_s4d__mixer_token_mlp__prompt_kernel_reload22
    s_branch interleave_layers__ssm_conv_s4d__mixer_token_mlp__prompt_kernel_ok69
interleave_layers__ssm_conv_s4d__mixer_token_mlp__prompt_kernel_rt70:
    s_call_b64 s[44:45], interleave_layers__ssm_conv_s4d__mixer_token_mlp__prompt_kernel_reload23
    s_branch interleave_layers__ssm_conv_s4d__mixer_token_mlp__prompt_kernel_ok71
interleave_layers__ssm_conv_s4d__mixer_token_mlp__prompt_kernel_rt72:
    s_call_b64 s[44:45], interleave_layers__ssm_conv_s4d__mixer_token_mlp__prompt_kernel_reload24
    s_branch interleave_layers__ssm_conv_s4d__mixer_token_mlp__prompt_kernel_ok73
interleave_layers__ssm_conv_s4d__mixer_token_mlp__prompt_kernel_rt74:
    s_call_b64 s[44:45], interleave_layers__ssm_conv_s4d__mixer_token_mlp__prompt_kernel_reload25
    s_branch interleave_layers__ssm_conv_s4d__mixer_token_mlp__prompt_kernel_ok75
interleave_layers__ssm_conv_s4d__mixer_token_mlp__prompt_kernel_rt76:
    s_call_b64 s[44:45], interleave_layers__ssm_conv_s4d__mixer_token_mlp__prompt_kernel_reload20
    s_branch interleave_layers__ssm_conv_s4d__mixer_token_mlp__prompt_kernel_ok77
interleave_layers__ssm_conv_s4d__mixer_token_mlp__prompt_kernel_rt78:
    s_call_b64 s[44:45], interleave_layers__ssm_conv_s4d__mixer_token_mlp__prompt_kernel_reload21
    s_branch interleave_layers__ssm_conv_s4d__mixer_token_mlp__prompt_kernel_ok79
interleave_layers__ssm_conv_s4d__mixer_token_mlp__prompt_kernel_rt80:
    s_call_b64 s[44:45], interleave_layers__ssm_conv_s4d__mixer_token_mlp__prompt_kernel_reload22
    s_branch interleave_layers__ssm_conv_s4d__mixer_token_mlp__prompt_kernel_ok81
interleave_layers__ssm_conv_s4d__mixer_token_mlp__prompt_kernel_rt82:
    s_call_b64 s[44:45], interleave_layers__ssm_conv_s4d__mixer_token_mlp__prompt_kernel_reload23
    s_branch interleave_layers__ssm_conv_s4d__mixer_token_mlp__prompt_kernel_ok83
interleave_layers__ssm_conv_s4d__mixer_token_mlp__prompt_kernel_rt84:
    s_call_b64 s[44:45], interleave_layers__ssm_conv_s4d__mixer_token_mlp__prompt_kernel_reload24
    s_branch interleave_layers__ssm_conv_s4d__mixer_token_mlp__prompt_kernel_ok85
interleave_layers__ssm_conv_s4d__mixer_token_mlp__prompt_kernel_rt86:
    s_call_b64 s[44:45], interleave_layers__ssm_conv_s4d__mixer_token_mlp__prompt_kernel_reload25
    s_branch interleave_layers__ssm_conv_s4d__mixer_token_mlp__prompt_kernel_ok87
interleave_layers__ssm_conv_s4d__mixer_token_mlp__prompt_kernel_rt88:
    s_call_b64 s[44:45], interleave_layers__ssm_conv_s4d__mixer_token_mlp__prompt_kernel_reload20
    s_branch interleave_layers__ssm_conv_s4d__mixer_token_mlp__prompt_kernel_ok89
interleave_layers__ssm_conv_s4d__mixer_token_mlp__prompt_kernel_rt90:
    s_call_b64 s[44:45], interleave_layers__ssm_conv_s4d__mixer_token_mlp__prompt_kernel_reload21
    s_branch interleave_layers__ssm_conv_s4d__mixer_token_mlp__prompt_kernel_ok91
interleave_layers__ssm_conv_s4d__mixer_token_mlp__prompt_kernel_rt92:
    s_call_b64 s[44:45], interleave_layers__ssm_conv_s4d__mixer_token_mlp__prompt_kernel_reload22
    s_branch interleave_layers__ssm_conv_s4d__mixer_token_mlp__prompt_kernel_ok93
interleave_layers__ssm_conv_s4d__mixer_token_mlp__prompt_kernel_rt94:
    s_call_b64 s[44:45], interleave_layers__ssm_conv_s4d__mixer_token_mlp__prompt_kernel_reload23
    s_branch interleave_layers__ssm_conv_s4d__mixer_token_mlp__prompt_kernel_ok95
interleave_layers__ssm_conv_s4d__mixer_token_mlp__prompt_kernel_rt96:
    s_call_b64 s[44:45], interleave_layers__ssm_conv_s4d__mixer_token_mlp__prompt_kernel_reload24
    s_waitcnt vmcnt(0)
    s_branch interleave_layers__ssm_conv_s4d__mixer_token_mlp__prompt_kernel_ok97
interleave_layers__ssm_conv_s4d__mixer_token_mlp__prompt_kernel_rt98:
    s_call_b64 s[44:45], interleave_layers__ssm_conv_s4d__mixer_token_mlp__prompt_kernel_reload25
    s_waitcnt vmcnt(0)
    s_branch interleave_layers__ssm_conv_s4d__mixer_token_mlp__prompt_kernel_ok99
interleave_layers__ssm_conv_s4d__mixer_token_mlp__prompt_kernel_rt100:
    s_call_b64 s[44:45], interleave_layers__ssm_conv_s4d__mixer_token_mlp__prompt_kernel_reload20
    s_waitcnt vmcnt(0)
    s_branch interleave_layers__ssm_conv_s4d__mixer_token_mlp__prompt_kernel_ok101
interleave_layers__ssm_conv_s4d__mixer_token_mlp__prompt_kernel_rt102:
    s_call_b64 s[44:45], interleave_layers__ssm_conv_s4d__mixer_token_mlp__prompt_kernel_reload21
    s_waitcnt vmcnt(0)
    s_branch interleave_layers__ssm_conv_s4d__mixer_token_mlp__prompt_kernel_ok103
interleave_layers__ssm_conv_s4d__mixer_token_mlp__prompt_kernel_g1idle32:
    s_bfe_u32 s48, s66, 0x4001c
    s_lshl_b32 s48, s48, 17
    s_add_u32 s48, s48, s6
    s_add_u32 m0, s4, 65536
    s_nop 0
    buffer_load_dwordx4 v2, s[60:63], s48 offen offset:0 lds
    buffer_load_dwordx4 v3, s[60:63], s48 offen offset:1024 lds
    buffer_load_dwordx4 v4, s[60:63], s48 offen offset:2048 lds
    buffer_load_dwordx4 v5, s[60:63], s48 offen offset:3072 lds
    s_bfe_u32 s48, s67, 0x40000
    s_lshl_b32 s48, s48, 17
    s_add_u32 s48, s48, s6
    s_add_u32 m0, s4, 81920
    s_nop 0
    buffer_load_dwordx4 v2, s[60:63], s48 offen offset:0 lds
    buffer_load_dwordx4 v3, s[60:63], s48 offen offset:1024 lds
    buffer_load_dwordx4 v4, s[60:63], s48 offen offset:2048 lds
    buffer_load_dwordx4 v5, s[60:63], s48 offen offset:3072 lds
    s_waitcnt vmcnt(34)
    ds_read_b64_tr_b16 v[176:177], v8 offset:32768
    ds_read_b64_tr_b16 v[178:179], v8 offset:34816
    ds_read_b64_tr_b16 v[180:181], v9 offset:32768
    ds_read_b64_tr_b16 v[182:183], v9 offset:34816
    ds_read_b64_tr_b16 v[184:185], v8 offset:33280
    ds_read_b64_tr_b16 v[186:187], v8 offset:35328
    ds_read_b64_tr_b16 v[188:189], v9 offset:33280
    ds_read_b64_tr_b16 v[190:191], v9 offset:35328
    s_bfe_u32 s48, s67, 0x40004
    s_lshl_b32 s48, s48, 17
    s_add_u32 s48, s48, s6
    s_add_u32 m0, s4, 98304
    s_waitcnt lgkmcnt(0)
    buffer_load_dwordx4 v2, s[60:63], s48 offen offset:0 lds
    buffer_load_dwordx4 v3, s[60:63], s48 offen offset:1024 lds
    buffer_load_dwordx4 v4, s[60:63], s48 offen offset:2048 lds
    buffer_load_dwordx4 v5, s[60:63], s48 offen offset:3072 lds
    s_waitcnt vmcnt(34)
    ds_read_b64_tr_b16 v[192:193], v6 offset:32768
    ds_read_b64_tr_b16 v[194:195], v6 offset:34816
    ds_read_b64_tr_b16 v[196:197], v7 offset:32768
    ds_read_b64_tr_b16 v[198:199], v7 offset:34816
    ds_read_b64_tr_b16 v[200:201], v6 offset:33280
    ds_read_b64_tr_b16 v[202:203], v6 offset:35328
    ds_read_b64_tr_b16 v[204:205], v7 offset:33280
    ds_read_b64_tr_b16 v[206:207], v7 offset:35328
    s_bfe_u32 s48, s67, 0x40008
    s_lshl_b32 s48, s48, 17
    s_add_u32 s48, s48, s6
    s_add_u32 m0, s4, 32768
    s_waitcnt lgkmcnt(0)
    buffer_load_dwordx4 v2, s[60:63], s48 offen offset:0 lds
    buffer_load_dwordx4 v3, s[60:63], s48 offen offset:1024 lds
    buffer_load_dwordx4 v4, s[60:63], s48 offen offset:2048 lds
    buffer_load_dwordx4 v5, s[60:63], s48 offen offset:3072 lds
    s_waitcnt vmcnt(34)
    ds_read_b64_tr_b16 v[208:209], v6 offset:0
    ds_read_b64_tr_b16 v[210:211], v6 offset:2048
    ds_read_b64_tr_b16 v[212:213], v7 offset:0
    ds_read_b64_tr_b16 v[214:215], v7 offset:2048
    ds_read_b64_tr_b16 v[216:217], v6 offset:512
    ds_read_b64_tr_b16 v[218:219], v6 offset:2560
    ds_read_b64_tr_b16 v[220:221], v7 offset:512
    ds_read_b64_tr_b16 v[222:223], v7 offset:2560
    s_bfe_u32 s48, s67, 0x4000c
    s_lshl_b32 s48, s48, 17
    s_add_u32 s48, s48, s6
    s_add_u32 m0, s4, 0
    s_waitcnt lgkmcnt(0)
    buffer_load_dwordx4 v2, s[60:63], s48 offen offset:0 lds
    buffer_load_dwordx4 v3, s[60:63], s48 offen offset:1024 lds
    buffer_load_dwordx4 v4, s[60:63], s48 offen offset:2048 lds
    buffer_load_dwordx4 v5, s[60:63], s48 offen offset:3072 lds
    s_nop 0
    s_waitcnt vmcnt(34)
    ds_read_b64_tr_b16 v[224:225], v6 offset:16384
    ds_read_b64_tr_b16 v[226:227], v6 offset:18432
    ds_read_b64_tr_b16 v[228:229], v7 offset:16384
    ds_read_b64_tr_b16 v[230:231], v7 offset:18432
    ds_read_b64_tr_b16 v[232:233], v6 offset:16896
    ds_read_b64_tr_b16 v[234:235], v6 offset:18944
    ds_read_b64_tr_b16 v[236:237], v7 offset:16896
    ds_read_b64_tr_b16 v[238:239], v7 offset:18944
    s_bfe_u32 s48, s67, 0x40010
    s_lshl_b32 s48, s48, 17
    s_add_u32 s48, s48, s6
    s_add_u32 m0, s4, 16384
    s_waitcnt lgkmcnt(0)
    buffer_load_dwordx4 v2, s[60:63], s48 offen offset:0 lds
    buffer_load_dwordx4 v3, s[60:63], s48 offen offset:1024 lds
    buffer_load_dwordx4 v4, s[60:63], s48 offen offset:2048 lds
    buffer_load_dwordx4 v5, s[60:63], s48 offen offset:3072 lds
    s_waitcnt vmcnt(34)
    ds_read_b64_tr_b16 v[240:241], v6 offset:49152
    ds_read_b64_tr_b16 v[242:243], v6 offset:51200
    ds_read_b64_tr_b16 v[244:245], v7 offset:49152
    ds_read_b64_tr_b16 v[246:247], v7 offset:51200
    ds_read_b64_tr_b16 v[248:249], v6 offset:49664
    ds_read_b64_tr_b16 v[250:251], v6 offset:51712
    ds_read_b64_tr_b16 v[252:253], v7 offset:49664
    ds_read_b64_tr_b16 v[254:255], v7 offset:51712
    s_cmp_lg_u32 s2, 255
    s_cbranch_scc1 interleave_layers__ssm_conv_s4d__mixer_token_mlp__prompt_kernel_ep104
    v_mov_b32 v76, s68
    v_mov_b32 v77, 28049408
    buffer_store_dword v76, v77, s[52:55], 0 offen sc1
interleave_layers__ssm_conv_s4d__mixer_token_mlp__prompt_kernel_ep104:
    s_mov_b32 s39, 12
interleave_layers__ssm_conv_s4d__mixer_token_mlp__prompt_kernel_walk105:
    s_and_b32 s40, s39, 31
    v_readlane_b32 s41, v12, s40
    s_add_u32 s39, s39, 1
    s_cmp_lt_u32 s39, 44
    s_nop 2
    buffer_load_dwordx4 v[72:75], v10, s[52:55], s41 offen sc1
    buffer_load_dwordx4 v[76:79], v11, s[52:55], s41 offen sc1
    s_waitcnt vmcnt(8)
    s_cbranch_scc1 interleave_layers__ssm_conv_s4d__mixer_token_mlp__prompt_kernel_walk105
    s_waitcnt vmcnt(0) lgkmcnt(0)
    s_branch interleave_layers__ssm_conv_s4d__mixer_token_mlp__prompt_kernel_g1skip33
interleave_layers__ssm_conv_s4d__mixer_token_mlp__prompt_kernel_reload26:
    s_sleep 2
    buffer_load_dwordx4 v[68:71], v11, s[52:55], s7 offen sc1
    buffer_load_dwordx4 v[64:67], v10, s[52:55], s7 offen sc1
    buffer_load_dwordx4 v[52:55], v11, s[52:55], s12 offen sc1
    buffer_load_dwordx4 v[48:51], v10, s[52:55], s12 offen sc1
    buffer_load_dwordx4 v[44:47], v11, s[52:55], s13 offen sc1
    buffer_load_dwordx4 v[40:43], v10, s[52:55], s13 offen sc1
    buffer_load_dwordx4 v[36:39], v11, s[52:55], s14 offen sc1
    buffer_load_dwordx4 v[32:35], v10, s[52:55], s14 offen sc1
    buffer_load_dwordx4 v[28:31], v11, s[52:55], s15 offen sc1
    buffer_load_dwordx4 v[24:27], v10, s[52:55], s15 offen sc1
    s_add_u32 s43, s43, 1
    s_waitcnt vmcnt(8)
    v_cmp_u_f32_e64 vcc, v64, v68
    s_cmp_ge_u32 s43, 32768
    s_cbranch_scc1 interleave_layers__ssm_conv_s4d__mixer_token_mlp__prompt_kernel_rfin106
    s_cbranch_vccnz interleave_layers__ssm_conv_s4d__mixer_token_mlp__prompt_kernel_reload26
interleave_layers__ssm_conv_s4d__mixer_token_mlp__prompt_kernel_rfin106:
    s_setpc_b64 s[44:45]
interleave_layers__ssm_conv_s4d__mixer_token_mlp__prompt_kernel_reload27:
    s_sleep 2
    buffer_load_dwordx4 v[52:55], v11, s[52:55], s12 offen sc1
    buffer_load_dwordx4 v[48:51], v10, s[52:55], s12 offen sc1
    buffer_load_dwordx4 v[44:47], v11, s[52:55], s13 offen sc1
    buffer_load_dwordx4 v[40:43], v10, s[52:55], s13 offen sc1
    buffer_load_dwordx4 v[36:39], v11, s[52:55], s14 offen sc1
    buffer_load_dwordx4 v[32:35], v10, s[52:55], s14 offen sc1
    buffer_load_dwordx4 v[28:31], v11, s[52:55], s15 offen sc1
    buffer_load_dwordx4 v[24:27], v10, s[52:55], s15 offen sc1
    buffer_load_dwordx4 v[140:143], v11, s[52:55], s70 offen sc1
    buffer_load_dwordx4 v[136:139], v10, s[52:55], s70 offen sc1
    s_add_u32 s43, s43, 1
    s_waitcnt vmcnt(8)
    v_cmp_u_f32_e64 vcc, v48, v52
    s_cmp_ge_u32 s43, 32768
    s_cbranch_scc1 interleave_layers__ssm_conv_s4d__mixer_token_mlp__prompt_kernel_rfin107
    s_cbranch_vccnz interleave_layers__ssm_conv_s4d__mixer_token_mlp__prompt_kernel_reload27
interleave_layers__ssm_conv_s4d__mixer_token_mlp__prompt_kernel_rfin107:
    s_setpc_b64 s[44:45]
interleave_layers__ssm_conv_s4d__mixer_token_mlp__prompt_kernel_reload28:
    s_sleep 2
    buffer_load_dwordx4 v[44:47], v11, s[52:55], s13 offen sc1
    buffer_load_dwordx4 v[40:43], v10, s[52:55], s13 offen sc1
    buffer_load_dwordx4 v[36:39], v11, s[52:55], s14 offen sc1
    buffer_load_dwordx4 v[32:35], v10, s[52:55], s14 offen sc1
    buffer_load_dwordx4 v[28:31], v11, s[52:55], s15 offen sc1
    buffer_load_dwordx4 v[24:27], v10, s[52:55], s15 offen sc1
    buffer_load_dwordx4 v[140:143], v11, s[52:55], s70 offen sc1
    buffer_load_dwordx4 v[136:139], v10, s[52:55], s70 offen sc1
    buffer_load_dwordx4 v[68:71], v11, s[52:55], s7 offen sc1
    buffer_load_dwordx4 v[64:67], v10, s[52:55], s7 offen sc1
    s_add_u32 s43, s43, 1
    s_waitcnt vmcnt(8)
    v_cmp_u_f32_e64 vcc, v40, v44
    s_cmp_ge_u32 s43, 32768
    s_cbranch_scc1 interleave_layers__ssm_conv_s4d__mixer_token_mlp__prompt_kernel_rfin108
    s_cbranch_vccnz interleave_layers__ssm_conv_s4d__mixer_token_mlp__prompt_kernel_reload28
interleave_layers__ssm_conv_s4d__mixer_token_mlp__prompt_kernel_rfin108:
    s_setpc_b64 s[44:45]
interleave_layers__ssm_conv_s4d__mixer_token_mlp__prompt_kernel_reload29:
    s_sleep 2
    buffer_load_dwordx4 v[36:39], v11, s[52:55], s14 offen sc1
    buffer_load_dwordx4 v[32:35], v10, s[52:55], s14 offen sc1
    buffer_load_dwordx4 v[28:31], v11, s[52:55], s15 offen sc1
    buffer_load_dwordx4 v[24:27], v10, s[52:55], s15 offen sc1
    buffer_load_dwordx4 v[140:143], v11, s[52:55], s70 offen sc1
    buffer_load_dwordx4 v[136:139], v10, s[52:55], s70 offen sc1
    buffer_load_dwordx4 v[68:71], v11, s[52:55], s7 offen sc1
    buffer_load_dwordx4 v[64:67], v10, s[52:55], s7 offen sc1
    buffer_load_dwordx4 v[52:55], v11, s[52:55], s12 offen sc1
    buffer_load_dwordx4 v[48:51], v10, s[52:55], s12 offen sc1
    s_add_u32 s43, s43, 1
    s_waitcnt vmcnt(8)
    v_cmp_u_f32_e64 vcc, v32, v36
    s_cmp_ge_u32 s43, 32768
    s_cbranch_scc1 interleave_layers__ssm_conv_s4d__mixer_token_mlp__prompt_kernel_rfin109
    s_cbranch_vccnz interleave_layers__ssm_conv_s4d__mixer_token_mlp__prompt_kernel_reload29
interleave_layers__ssm_conv_s4d__mixer_token_mlp__prompt_kernel_rfin109:
    s_setpc_b64 s[44:45]
interleave_layers__ssm_conv_s4d__mixer_token_mlp__prompt_kernel_reload30:
    s_sleep 2
    buffer_load_dwordx4 v[28:31], v11, s[52:55], s15 offen sc1
    buffer_load_dwordx4 v[24:27], v10, s[52:55], s15 offen sc1
    buffer_load_dwordx4 v[140:143], v11, s[52:55], s70 offen sc1
    buffer_load_dwordx4 v[136:139], v10, s[52:55], s70 offen sc1
    buffer_load_dwordx4 v[68:71], v11, s[52:55], s7 offen sc1
    buffer_load_dwordx4 v[64:67], v10, s[52:55], s7 offen sc1
    buffer_load_dwordx4 v[52:55], v11, s[52:55], s12 offen sc1
    buffer_load_dwordx4 v[48:51], v10, s[52:55], s12 offen sc1
    buffer_load_dwordx4 v[44:47], v11, s[52:55], s13 offen sc1
    buffer_load_dwordx4 v[40:43], v10, s[52:55], s13 offen sc1
    s_add_u32 s43, s43, 1
    s_waitcnt vmcnt(8)
    v_cmp_u_f32_e64 vcc, v24, v28
    s_cmp_ge_u32 s43, 32768
    s_cbranch_scc1 interleave_layers__ssm_conv_s4d__mixer_token_mlp__prompt_kernel_rfin110
    s_cbranch_vccnz interleave_layers__ssm_conv_s4d__mixer_token_mlp__prompt_kernel_reload30
interleave_layers__ssm_conv_s4d__mixer_token_mlp__prompt_kernel_rfin110:
    s_setpc_b64 s[44:45]
interleave_layers__ssm_conv_s4d__mixer_token_mlp__prompt_kernel_reload31:
    s_sleep 2
    buffer_load_dwordx4 v[140:143], v11, s[52:55], s70 offen sc1
    buffer_load_dwordx4 v[136:139], v10, s[52:55], s70 offen sc1
    buffer_load_dwordx4 v[68:71], v11, s[52:55], s7 offen sc1
    buffer_load_dwordx4 v[64:67], v10, s[52:55], s7 offen sc1
    buffer_load_dwordx4 v[52:55], v11, s[52:55], s12 offen sc1
    buffer_load_dwordx4 v[48:51], v10, s[52:55], s12 offen sc1
    buffer_load_dwordx4 v[44:47], v11, s[52:55], s13 offen sc1
    buffer_load_dwordx4 v[40:43], v10, s[52:55], s13 offen sc1
    buffer_load_dwordx4 v[36:39], v11, s[52:55], s14 offen sc1
    buffer_load_dwordx4 v[32:35], v10, s[52:55], s14 offen sc1
    s_add_u32 s43, s43, 1
    s_waitcnt vmcnt(8)
    v_cmp_u_f32_e64 vcc, v136, v140
    s_cmp_ge_u32 s43, 32768
    s_cbranch_scc1 interleave_layers__ssm_conv_s4d__mixer_token_mlp__prompt_kernel_rfin111
    s_cbranch_vccnz interleave_layers__ssm_conv_s4d__mixer_token_mlp__prompt_kernel_reload31
interleave_layers__ssm_conv_s4d__mixer_token_mlp__prompt_kernel_rfin111:
    s_setpc_b64 s[44:45]
interleave_layers__ssm_conv_s4d__mixer_token_mlp__prompt_kernel_rt112:
    s_call_b64 s[44:45], interleave_layers__ssm_conv_s4d__mixer_token_mlp__prompt_kernel_reload26
    s_branch interleave_layers__ssm_conv_s4d__mixer_token_mlp__prompt_kernel_ok113
interleave_layers__ssm_conv_s4d__mixer_token_mlp__prompt_kernel_rt114:
    s_call_b64 s[44:45], interleave_layers__ssm_conv_s4d__mixer_token_mlp__prompt_kernel_reload27
    s_branch interleave_layers__ssm_conv_s4d__mixer_token_mlp__prompt_kernel_ok115
interleave_layers__ssm_conv_s4d__mixer_token_mlp__prompt_kernel_rt116:
    s_call_b64 s[44:45], interleave_layers__ssm_conv_s4d__mixer_token_mlp__prompt_kernel_reload28
    s_branch interleave_layers__ssm_conv_s4d__mixer_token_mlp__prompt_kernel_ok117
interleave_layers__ssm_conv_s4d__mixer_token_mlp__prompt_kernel_rt118:
    s_call_b64 s[44:45], interleave_layers__ssm_conv_s4d__mixer_token_mlp__prompt_kernel_reload29
    s_branch interleave_layers__ssm_conv_s4d__mixer_token_mlp__prompt_kernel_ok119
interleave_layers__ssm_conv_s4d__mixer_token_mlp__prompt_kernel_rt120:
    s_call_b64 s[44:45], interleave_layers__ssm_conv_s4d__mixer_token_mlp__prompt_kernel_reload30
    s_branch interleave_layers__ssm_conv_s4d__mixer_token_mlp__prompt_kernel_ok121
interleave_layers__ssm_conv_s4d__mixer_token_mlp__prompt_kernel_rt122:
    s_call_b64 s[44:45], interleave_layers__ssm_conv_s4d__mixer_token_mlp__prompt_kernel_reload31
    s_branch interleave_layers__ssm_conv_s4d__mixer_token_mlp__prompt_kernel_ok123
interleave_layers__ssm_conv_s4d__mixer_token_mlp__prompt_kernel_rt124:
    s_call_b64 s[44:45], interleave_layers__ssm_conv_s4d__mixer_token_mlp__prompt_kernel_reload26
    s_branch interleave_layers__ssm_conv_s4d__mixer_token_mlp__prompt_kernel_ok125
interleave_layers__ssm_conv_s4d__mixer_token_mlp__prompt_kernel_rt126:
    s_call_b64 s[44:45], interleave_layers__ssm_conv_s4d__mixer_token_mlp__prompt_kernel_reload27
    s_branch interleave_layers__ssm_conv_s4d__mixer_token_mlp__prompt_kernel_ok127
interleave_layers__ssm_conv_s4d__mixer_token_mlp__prompt_kernel_rt128:
    s_call_b64 s[44:45], interleave_layers__ssm_conv_s4d__mixer_token_mlp__prompt_kernel_reload28
    s_branch interleave_layers__ssm_conv_s4d__mixer_token_mlp__prompt_kernel_ok129
interleave_layers__ssm_conv_s4d__mixer_token_mlp__prompt_kernel_rt130:
    s_call_b64 s[44:45], interleave_layers__ssm_conv_s4d__mixer_token_mlp__prompt_kernel_reload29
    s_branch interleave_layers__ssm_conv_s4d__mixer_token_mlp__prompt_kernel_ok131
interleave_layers__ssm_conv_s4d__mixer_token_mlp__prompt_kernel_rt132:
    s_call_b64 s[44:45], interleave_layers__ssm_conv_s4d__mixer_token_mlp__prompt_kernel_reload30
    s_branch interleave_layers__ssm_conv_s4d__mixer_token_mlp__prompt_kernel_ok133
interleave_layers__ssm_conv_s4d__mixer_token_mlp__prompt_kernel_rt134:
    s_call_b64 s[44:45], interleave_layers__ssm_conv_s4d__mixer_token_mlp__prompt_kernel_reload31
    s_branch interleave_layers__ssm_conv_s4d__mixer_token_mlp__prompt_kernel_ok135
interleave_layers__ssm_conv_s4d__mixer_token_mlp__prompt_kernel_rt136:
    s_call_b64 s[44:45], interleave_layers__ssm_conv_s4d__mixer_token_mlp__prompt_kernel_reload26
    s_branch interleave_layers__ssm_conv_s4d__mixer_token_mlp__prompt_kernel_ok137
interleave_layers__ssm_conv_s4d__mixer_token_mlp__prompt_kernel_rt138:
    s_call_b64 s[44:45], interleave_layers__ssm_conv_s4d__mixer_token_mlp__prompt_kernel_reload27
    s_branch interleave_layers__ssm_conv_s4d__mixer_token_mlp__prompt_kernel_ok139
interleave_layers__ssm_conv_s4d__mixer_token_mlp__prompt_kernel_rt140:
    s_call_b64 s[44:45], interleave_layers__ssm_conv_s4d__mixer_token_mlp__prompt_kernel_reload28
    s_branch interleave_layers__ssm_conv_s4d__mixer_token_mlp__prompt_kernel_ok141
interleave_layers__ssm_conv_s4d__mixer_token_mlp__prompt_kernel_rt142:
    s_call_b64 s[44:45], interleave_layers__ssm_conv_s4d__mixer_token_mlp__prompt_kernel_reload29
    s_branch interleave_layers__ssm_conv_s4d__mixer_token_mlp__prompt_kernel_ok143
interleave_layers__ssm_conv_s4d__mixer_token_mlp__prompt_kernel_rt144:
    s_call_b64 s[44:45], interleave_layers__ssm_conv_s4d__mixer_token_mlp__prompt_kernel_reload30
    s_branch interleave_layers__ssm_conv_s4d__mixer_token_mlp__prompt_kernel_ok145
interleave_layers__ssm_conv_s4d__mixer_token_mlp__prompt_kernel_rt146:
    s_call_b64 s[44:45], interleave_layers__ssm_conv_s4d__mixer_token_mlp__prompt_kernel_reload31
    s_branch interleave_layers__ssm_conv_s4d__mixer_token_mlp__prompt_kernel_ok147
interleave_layers__ssm_conv_s4d__mixer_token_mlp__prompt_kernel_rt148:
    s_call_b64 s[44:45], interleave_layers__ssm_conv_s4d__mixer_token_mlp__prompt_kernel_reload26
    s_branch interleave_layers__ssm_conv_s4d__mixer_token_mlp__prompt_kernel_ok149
interleave_layers__ssm_conv_s4d__mixer_token_mlp__prompt_kernel_rt150:
    s_call_b64 s[44:45], interleave_layers__ssm_conv_s4d__mixer_token_mlp__prompt_kernel_reload27
    s_branch interleave_layers__ssm_conv_s4d__mixer_token_mlp__prompt_kernel_ok151
interleave_layers__ssm_conv_s4d__mixer_token_mlp__prompt_kernel_rt152:
    s_call_b64 s[44:45], interleave_layers__ssm_conv_s4d__mixer_token_mlp__prompt_kernel_reload28
    s_branch interleave_layers__ssm_conv_s4d__mixer_token_mlp__prompt_kernel_ok153
interleave_layers__ssm_conv_s4d__mixer_token_mlp__prompt_kernel_rt154:
    s_call_b64 s[44:45], interleave_layers__ssm_conv_s4d__mixer_token_mlp__prompt_kernel_reload29
    s_branch interleave_layers__ssm_conv_s4d__mixer_token_mlp__prompt_kernel_ok155
interleave_layers__ssm_conv_s4d__mixer_token_mlp__prompt_kernel_rt156:
    s_call_b64 s[44:45], interleave_layers__ssm_conv_s4d__mixer_token_mlp__prompt_kernel_reload30
    s_branch interleave_layers__ssm_conv_s4d__mixer_token_mlp__prompt_kernel_ok157
interleave_layers__ssm_conv_s4d__mixer_token_mlp__prompt_kernel_rt158:
    s_call_b64 s[44:45], interleave_layers__ssm_conv_s4d__mixer_token_mlp__prompt_kernel_reload31
    s_branch interleave_layers__ssm_conv_s4d__mixer_token_mlp__prompt_kernel_ok159
interleave_layers__ssm_conv_s4d__mixer_token_mlp__prompt_kernel_rt160:
    s_call_b64 s[44:45], interleave_layers__ssm_conv_s4d__mixer_token_mlp__prompt_kernel_reload26
    s_waitcnt vmcnt(0)
    s_branch interleave_layers__ssm_conv_s4d__mixer_token_mlp__prompt_kernel_ok161
interleave_layers__ssm_conv_s4d__mixer_token_mlp__prompt_kernel_rt162:
    s_call_b64 s[44:45], interleave_layers__ssm_conv_s4d__mixer_token_mlp__prompt_kernel_reload27
    s_waitcnt vmcnt(0)
    s_branch interleave_layers__ssm_conv_s4d__mixer_token_mlp__prompt_kernel_ok163
interleave_layers__ssm_conv_s4d__mixer_token_mlp__prompt_kernel_rt164:
    s_call_b64 s[44:45], interleave_layers__ssm_conv_s4d__mixer_token_mlp__prompt_kernel_reload28
    s_waitcnt vmcnt(0)
    s_branch interleave_layers__ssm_conv_s4d__mixer_token_mlp__prompt_kernel_ok165
interleave_layers__ssm_conv_s4d__mixer_token_mlp__prompt_kernel_rt166:
    s_call_b64 s[44:45], interleave_layers__ssm_conv_s4d__mixer_token_mlp__prompt_kernel_reload29
    s_waitcnt vmcnt(0)
    s_branch interleave_layers__ssm_conv_s4d__mixer_token_mlp__prompt_kernel_ok167
interleave_layers__ssm_conv_s4d__mixer_token_mlp__prompt_kernel_gretry168:
    s_mov_b32 s43, 0
interleave_layers__ssm_conv_s4d__mixer_token_mlp__prompt_kernel_glp170:
    s_mov_b64 exec, vcc
    buffer_load_dwordx4 v[48:51], v1, s[52:55], s8 offen sc1
    s_waitcnt vmcnt(0)
    v_max3_u32 v16, v48, v49, v50
    v_cmp_u_f32 vcc, v16, v51
    s_add_u32 s43, s43, 1
    s_cmp_ge_u32 s43, 32768
    s_cbranch_scc1 interleave_layers__ssm_conv_s4d__mixer_token_mlp__prompt_kernel_gfin171
    s_cbranch_vccnz interleave_layers__ssm_conv_s4d__mixer_token_mlp__prompt_kernel_glp170
interleave_layers__ssm_conv_s4d__mixer_token_mlp__prompt_kernel_gfin171:
    s_mov_b64 exec, -1
    s_branch interleave_layers__ssm_conv_s4d__mixer_token_mlp__prompt_kernel_gok169
interleave_layers__ssm_conv_s4d__mixer_token_mlp__prompt_kernel_gretry172:
    s_mov_b32 s43, 0
interleave_layers__ssm_conv_s4d__mixer_token_mlp__prompt_kernel_glp174:
    s_mov_b64 exec, vcc
    buffer_load_dwordx4 v[52:55], v1, s[52:55], s9 offen sc1
    s_waitcnt vmcnt(0)
    v_max3_u32 v11, v52, v53, v54
    v_cmp_u_f32_e64 vcc, v11, v55
    s_add_u32 s43, s43, 1
    s_cmp_ge_u32 s43, 32768
    s_cbranch_scc1 interleave_layers__ssm_conv_s4d__mixer_token_mlp__prompt_kernel_gfin175
    s_cbranch_vccnz interleave_layers__ssm_conv_s4d__mixer_token_mlp__prompt_kernel_glp174
interleave_layers__ssm_conv_s4d__mixer_token_mlp__prompt_kernel_gfin175:
    s_mov_b64 exec, -1
    s_branch interleave_layers__ssm_conv_s4d__mixer_token_mlp__prompt_kernel_gok173
interleave_layers__ssm_conv_s4d__mixer_token_mlp__prompt_kernel_gretry176:
    s_mov_b32 s43, 0
interleave_layers__ssm_conv_s4d__mixer_token_mlp__prompt_kernel_glp178:
    s_mov_b64 exec, vcc
    buffer_load_dwordx4 v[88:91], v96, s[52:55], s8 offen sc1
    s_mov_b64 exec, -1
    s_waitcnt vmcnt(1)
    v_max3_u32 v98, v92, v93, v94
    v_cmpx_u_f32 vcc, v98, v95
    s_cbranch_execz interleave_layers__ssm_conv_s4d__mixer_token_mlp__prompt_kernel_gsk180
    buffer_load_dwordx4 v[92:95], v96, s[52:55], s9 offen sc1
interleave_layers__ssm_conv_s4d__mixer_token_mlp__prompt_kernel_gsk180:
    s_mov_b64 exec, -1
    s_waitcnt vmcnt(0)
    v_max3_u32 v98, v88, v89, v90
    v_cmp_u_f32 vcc, v98, v91
    s_add_u32 s43, s43, 1
    s_cmp_ge_u32 s43, 32768
    s_cbranch_scc1 interleave_layers__ssm_conv_s4d__mixer_token_mlp__prompt_kernel_gfin179
    s_cbranch_vccnz interleave_layers__ssm_conv_s4d__mixer_token_mlp__prompt_kernel_glp178
interleave_layers__ssm_conv_s4d__mixer_token_mlp__prompt_kernel_gfin179:
    s_mov_b64 exec, -1
    s_branch interleave_layers__ssm_conv_s4d__mixer_token_mlp__prompt_kernel_gok177
interleave_layers__ssm_conv_s4d__mixer_token_mlp__prompt_kernel_gretry181:
    s_mov_b32 s43, 0
interleave_layers__ssm_conv_s4d__mixer_token_mlp__prompt_kernel_glp183:
    s_mov_b64 exec, vcc
    buffer_load_dwordx4 v[92:95], v96, s[52:55], s9 offen sc1
    s_waitcnt vmcnt(0)
    v_max3_u32 v98, v92, v93, v94
    v_cmp_u_f32_e64 vcc, v98, v95
    s_add_u32 s43, s43, 1
    s_cmp_ge_u32 s43, 32768
    s_cbranch_scc1 interleave_layers__ssm_conv_s4d__mixer_token_mlp__prompt_kernel_gfin184
    s_cbranch_vccnz interleave_layers__ssm_conv_s4d__mixer_token_mlp__prompt_kernel_glp183
interleave_layers__ssm_conv_s4d__mixer_token_mlp__prompt_kernel_gfin184:
    s_mov_b64 exec, -1
    s_branch interleave_layers__ssm_conv_s4d__mixer_token_mlp__prompt_kernel_gok182
interleave_layers__ssm_conv_s4d__mixer_token_mlp__prompt_kernel_gretry185:
    s_mov_b32 s43, 0
interleave_layers__ssm_conv_s4d__mixer_token_mlp__prompt_kernel_glp187:
    s_mov_b64 exec, vcc
    buffer_load_dwordx4 v[112:115], v106, s[52:55], s10 offen sc1
    s_mov_b64 exec, -1
    s_waitcnt vmcnt(1)
    v_max3_u32 v107, v116, v117, v118
    v_cmpx_u_f32 vcc, v107, v119
    s_cbranch_execz interleave_layers__ssm_conv_s4d__mixer_token_mlp__prompt_kernel_gsk189
    buffer_load_dwordx4 v[116:119], v106, s[52:55], s11 offen sc1
interleave_layers__ssm_conv_s4d__mixer_token_mlp__prompt_kernel_gsk189:
    s_mov_b64 exec, -1
    s_waitcnt vmcnt(0)
    v_max3_u32 v107, v112, v113, v114
    v_cmp_u_f32 vcc, v107, v115
    s_add_u32 s43, s43, 1
    s_cmp_ge_u32 s43, 32768
    s_cbranch_scc1 interleave_layers__ssm_conv_s4d__mixer_token_mlp__prompt_kernel_gfin188
    s_cbranch_vccnz interleave_layers__ssm_conv_s4d__mixer_token_mlp__prompt_kernel_glp187
interleave_layers__ssm_conv_s4d__mixer_token_mlp__prompt_kernel_gfin188:
    s_mov_b64 exec, -1
    s_branch interleave_layers__ssm_conv_s4d__mixer_token_mlp__prompt_kernel_gok186
interleave_layers__ssm_conv_s4d__mixer_token_mlp__prompt_kernel_gretry190:
    s_mov_b32 s43, 0
interleave_layers__ssm_conv_s4d__mixer_token_mlp__prompt_kernel_glp192:
    s_mov_b64 exec, vcc
    buffer_load_dwordx4 v[116:119], v106, s[52:55], s11 offen sc1
    s_waitcnt vmcnt(0)
    v_max3_u32 v107, v116, v117, v118
    v_cmp_u_f32_e64 vcc, v107, v119
    s_add_u32 s43, s43, 1
    s_cmp_ge_u32 s43, 32768
    s_nop 0
    s_cbranch_scc1 interleave_layers__ssm_conv_s4d__mixer_token_mlp__prompt_kernel_gfin193
    s_cbranch_vccnz interleave_layers__ssm_conv_s4d__mixer_token_mlp__prompt_kernel_glp192
interleave_layers__ssm_conv_s4d__mixer_token_mlp__prompt_kernel_gfin193:
    s_mov_b64 exec, -1
    s_branch interleave_layers__ssm_conv_s4d__mixer_token_mlp__prompt_kernel_gok191
interleave_layers__ssm_conv_s4d__mixer_token_mlp__prompt_kernel_reload194:
    s_sleep 2
    buffer_load_dwordx4 v[68:71], v3, s[52:55], s7 offen sc1
    buffer_load_dwordx4 v[64:67], v2, s[52:55], s7 offen sc1
    buffer_load_dwordx4 v[60:63], v3, s[52:55], s12 offen sc1
    buffer_load_dwordx4 v[56:59], v2, s[52:55], s12 offen sc1
    buffer_load_dwordx4 v[52:55], v3, s[52:55], s13 offen sc1
    buffer_load_dwordx4 v[48:51], v2, s[52:55], s13 offen sc1
    buffer_load_dwordx4 v[44:47], v3, s[52:55], s14 offen sc1
    buffer_load_dwordx4 v[40:43], v2, s[52:55], s14 offen sc1
    buffer_load_dwordx4 v[36:39], v3, s[52:55], s15 offen sc1
    buffer_load_dwordx4 v[32:35], v2, s[52:55], s15 offen sc1
    s_add_u32 s43, s43, 1
    s_waitcnt vmcnt(8)
    v_cmp_u_f32_e64 vcc, v64, v68
    s_cmp_ge_u32 s43, 32768
    s_cbranch_scc1 interleave_layers__ssm_conv_s4d__mixer_token_mlp__prompt_kernel_rfin208
    s_cbranch_vccnz interleave_layers__ssm_conv_s4d__mixer_token_mlp__prompt_kernel_reload194
interleave_layers__ssm_conv_s4d__mixer_token_mlp__prompt_kernel_rfin208:
    s_setpc_b64 s[44:45]
interleave_layers__ssm_conv_s4d__mixer_token_mlp__prompt_kernel_reload195:
    s_sleep 2
    buffer_load_dwordx4 v[60:63], v3, s[52:55], s12 offen sc1
    buffer_load_dwordx4 v[56:59], v2, s[52:55], s12 offen sc1
    buffer_load_dwordx4 v[52:55], v3, s[52:55], s13 offen sc1
    buffer_load_dwordx4 v[48:51], v2, s[52:55], s13 offen sc1
    buffer_load_dwordx4 v[44:47], v3, s[52:55], s14 offen sc1
    buffer_load_dwordx4 v[40:43], v2, s[52:55], s14 offen sc1
    buffer_load_dwordx4 v[36:39], v3, s[52:55], s15 offen sc1
    buffer_load_dwordx4 v[32:35], v2, s[52:55], s15 offen sc1
    buffer_load_dwordx4 v[28:31], v3, s[52:55], s70 offen sc1
    buffer_load_dwordx4 v[24:27], v2, s[52:55], s70 offen sc1
    s_add_u32 s43, s43, 1
    s_waitcnt vmcnt(8)
    v_cmp_u_f32_e64 vcc, v56, v60
    s_cmp_ge_u32 s43, 32768
    s_cbranch_scc1 interleave_layers__ssm_conv_s4d__mixer_token_mlp__prompt_kernel_rfin209
    s_cbranch_vccnz interleave_layers__ssm_conv_s4d__mixer_token_mlp__prompt_kernel_reload195
interleave_layers__ssm_conv_s4d__mixer_token_mlp__prompt_kernel_rfin209:
    s_setpc_b64 s[44:45]
interleave_layers__ssm_conv_s4d__mixer_token_mlp__prompt_kernel_reload196:
    s_sleep 2
    buffer_load_dwordx4 v[52:55], v3, s[52:55], s13 offen sc1
    buffer_load_dwordx4 v[48:51], v2, s[52:55], s13 offen sc1
    buffer_load_dwordx4 v[44:47], v3, s[52:55], s14 offen sc1
    buffer_load_dwordx4 v[40:43], v2, s[52:55], s14 offen sc1
    buffer_load_dwordx4 v[36:39], v3, s[52:55], s15 offen sc1
    buffer_load_dwordx4 v[32:35], v2, s[52:55], s15 offen sc1
    buffer_load_dwordx4 v[28:31], v3, s[52:55], s70 offen sc1
    buffer_load_dwordx4 v[24:27], v2, s[52:55], s70 offen sc1
    buffer_load_dwordx4 v[68:71], v3, s[52:55], s7 offen sc1
    buffer_load_dwordx4 v[64:67], v2, s[52:55], s7 offen sc1
    s_add_u32 s43, s43, 1
    s_waitcnt vmcnt(8)
    v_cmp_u_f32_e64 vcc, v48, v52
    s_cmp_ge_u32 s43, 32768
    s_cbranch_scc1 interleave_layers__ssm_conv_s4d__mixer_token_mlp__prompt_kernel_rfin210
    s_cbranch_vccnz interleave_layers__ssm_conv_s4d__mixer_token_mlp__prompt_kernel_reload196
interleave_layers__ssm_conv_s4d__mixer_token_mlp__prompt_kernel_rfin210:
    s_setpc_b64 s[44:45]
interleave_layers__ssm_conv_s4d__mixer_token_mlp__prompt_kernel_reload197:
    s_sleep 2
    buffer_load_dwordx4 v[44:47], v3, s[52:55], s14 offen sc1
    buffer_load_dwordx4 v[40:43], v2, s[52:55], s14 offen sc1
    buffer_load_dwordx4 v[36:39], v3, s[52:55], s15 offen sc1
    buffer_load_dwordx4 v[32:35], v2, s[52:55], s15 offen sc1
    buffer_load_dwordx4 v[28:31], v3, s[52:55], s70 offen sc1
    buffer_load_dwordx4 v[24:27], v2, s[52:55], s70 offen sc1
    buffer_load_dwordx4 v[68:71], v3, s[52:55], s7 offen sc1
    buffer_load_dwordx4 v[64:67], v2, s[52:55], s7 offen sc1
    buffer_load_dwordx4 v[60:63], v3, s[52:55], s12 offen sc1
    buffer_load_dwordx4 v[56:59], v2, s[52:55], s12 offen sc1
    s_add_u32 s43, s43, 1
    s_waitcnt vmcnt(8)
    v_cmp_u_f32_e64 vcc, v40, v44
    s_cmp_ge_u32 s43, 32768
    s_cbranch_scc1 interleave_layers__ssm_conv_s4d__mixer_token_mlp__prompt_kernel_rfin211
    s_cbranch_vccnz interleave_layers__ssm_conv_s4d__mixer_token_mlp__prompt_kernel_reload197
interleave_layers__ssm_conv_s4d__mixer_token_mlp__prompt_kernel_rfin211:
    s_setpc_b64 s[44:45]
interleave_layers__ssm_conv_s4d__mixer_token_mlp__prompt_kernel_reload198:
    s_sleep 2
    buffer_load_dwordx4 v[36:39], v3, s[52:55], s15 offen sc1
    buffer_load_dwordx4 v[32:35], v2, s[52:55], s15 offen sc1
    buffer_load_dwordx4 v[28:31], v3, s[52:55], s70 offen sc1
    buffer_load_dwordx4 v[24:27], v2, s[52:55], s70 offen sc1
    buffer_load_dwordx4 v[68:71], v3, s[52:55], s7 offen sc1
    buffer_load_dwordx4 v[64:67], v2, s[52:55], s7 offen sc1
    buffer_load_dwordx4 v[60:63], v3, s[52:55], s12 offen sc1
    buffer_load_dwordx4 v[56:59], v2, s[52:55], s12 offen sc1
    buffer_load_dwordx4 v[52:55], v3, s[52:55], s13 offen sc1
    buffer_load_dwordx4 v[48:51], v2, s[52:55], s13 offen sc1
    s_add_u32 s43, s43, 1
    s_waitcnt vmcnt(8)
    v_cmp_u_f32_e64 vcc, v32, v36
    s_cmp_ge_u32 s43, 32768
    s_cbranch_scc1 interleave_layers__ssm_conv_s4d__mixer_token_mlp__prompt_kernel_rfin212
    s_cbranch_vccnz interleave_layers__ssm_conv_s4d__mixer_token_mlp__prompt_kernel_reload198
interleave_layers__ssm_conv_s4d__mixer_token_mlp__prompt_kernel_rfin212:
    s_setpc_b64 s[44:45]
interleave_layers__ssm_conv_s4d__mixer_token_mlp__prompt_kernel_reload199:
    s_sleep 2
    buffer_load_dwordx4 v[28:31], v3, s[52:55], s70 offen sc1
    buffer_load_dwordx4 v[24:27], v2, s[52:55], s70 offen sc1
    buffer_load_dwordx4 v[68:71], v3, s[52:55], s7 offen sc1
    buffer_load_dwordx4 v[64:67], v2, s[52:55], s7 offen sc1
    buffer_load_dwordx4 v[60:63], v3, s[52:55], s12 offen sc1
    buffer_load_dwordx4 v[56:59], v2, s[52:55], s12 offen sc1
    buffer_load_dwordx4 v[52:55], v3, s[52:55], s13 offen sc1
    buffer_load_dwordx4 v[48:51], v2, s[52:55], s13 offen sc1
    buffer_load_dwordx4 v[44:47], v3, s[52:55], s14 offen sc1
    buffer_load_dwordx4 v[40:43], v2, s[52:55], s14 offen sc1
    s_add_u32 s43, s43, 1
    s_waitcnt vmcnt(8)
    v_cmp_u_f32_e64 vcc, v24, v28
    s_cmp_ge_u32 s43, 32768
    s_cbranch_scc1 interleave_layers__ssm_conv_s4d__mixer_token_mlp__prompt_kernel_rfin213
    s_cbranch_vccnz interleave_layers__ssm_conv_s4d__mixer_token_mlp__prompt_kernel_reload199
interleave_layers__ssm_conv_s4d__mixer_token_mlp__prompt_kernel_rfin213:
    s_setpc_b64 s[44:45]
interleave_layers__ssm_conv_s4d__mixer_token_mlp__prompt_kernel_rt214:
    s_call_b64 s[44:45], interleave_layers__ssm_conv_s4d__mixer_token_mlp__prompt_kernel_reload194
    s_branch interleave_layers__ssm_conv_s4d__mixer_token_mlp__prompt_kernel_ok215
interleave_layers__ssm_conv_s4d__mixer_token_mlp__prompt_kernel_rt216:
    s_call_b64 s[44:45], interleave_layers__ssm_conv_s4d__mixer_token_mlp__prompt_kernel_reload195
    s_branch interleave_layers__ssm_conv_s4d__mixer_token_mlp__prompt_kernel_ok217
interleave_layers__ssm_conv_s4d__mixer_token_mlp__prompt_kernel_rt218:
    s_call_b64 s[44:45], interleave_layers__ssm_conv_s4d__mixer_token_mlp__prompt_kernel_reload196
    s_branch interleave_layers__ssm_conv_s4d__mixer_token_mlp__prompt_kernel_ok219
interleave_layers__ssm_conv_s4d__mixer_token_mlp__prompt_kernel_rt220:
    s_call_b64 s[44:45], interleave_layers__ssm_conv_s4d__mixer_token_mlp__prompt_kernel_reload197
    s_branch interleave_layers__ssm_conv_s4d__mixer_token_mlp__prompt_kernel_ok221
interleave_layers__ssm_conv_s4d__mixer_token_mlp__prompt_kernel_rt222:
    s_call_b64 s[44:45], interleave_layers__ssm_conv_s4d__mixer_token_mlp__prompt_kernel_reload198
    s_branch interleave_layers__ssm_conv_s4d__mixer_token_mlp__prompt_kernel_ok223
interleave_layers__ssm_conv_s4d__mixer_token_mlp__prompt_kernel_rt224:
    s_call_b64 s[44:45], interleave_layers__ssm_conv_s4d__mixer_token_mlp__prompt_kernel_reload199
    s_branch interleave_layers__ssm_conv_s4d__mixer_token_mlp__prompt_kernel_ok225
interleave_layers__ssm_conv_s4d__mixer_token_mlp__prompt_kernel_rt226:
    s_call_b64 s[44:45], interleave_layers__ssm_conv_s4d__mixer_token_mlp__prompt_kernel_reload194
    s_branch interleave_layers__ssm_conv_s4d__mixer_token_mlp__prompt_kernel_ok227
interleave_layers__ssm_conv_s4d__mixer_token_mlp__prompt_kernel_rt228:
    s_call_b64 s[44:45], interleave_layers__ssm_conv_s4d__mixer_token_mlp__prompt_kernel_reload195
    s_branch interleave_layers__ssm_conv_s4d__mixer_token_mlp__prompt_kernel_ok229
interleave_layers__ssm_conv_s4d__mixer_token_mlp__prompt_kernel_rt230:
    s_call_b64 s[44:45], interleave_layers__ssm_conv_s4d__mixer_token_mlp__prompt_kernel_reload196
    s_branch interleave_layers__ssm_conv_s4d__mixer_token_mlp__prompt_kernel_ok231
interleave_layers__ssm_conv_s4d__mixer_token_mlp__prompt_kernel_rt232:
    s_call_b64 s[44:45], interleave_layers__ssm_conv_s4d__mixer_token_mlp__prompt_kernel_reload197
    s_branch interleave_layers__ssm_conv_s4d__mixer_token_mlp__prompt_kernel_ok233
interleave_layers__ssm_conv_s4d__mixer_token_mlp__prompt_kernel_rt234:
    s_call_b64 s[44:45], interleave_layers__ssm_conv_s4d__mixer_token_mlp__prompt_kernel_reload198
    s_branch interleave_layers__ssm_conv_s4d__mixer_token_mlp__prompt_kernel_ok235
interleave_layers__ssm_conv_s4d__mixer_token_mlp__prompt_kernel_rt236:
    s_call_b64 s[44:45], interleave_layers__ssm_conv_s4d__mixer_token_mlp__prompt_kernel_reload199
    s_branch interleave_layers__ssm_conv_s4d__mixer_token_mlp__prompt_kernel_ok237
interleave_layers__ssm_conv_s4d__mixer_token_mlp__prompt_kernel_rt238:
    s_call_b64 s[44:45], interleave_layers__ssm_conv_s4d__mixer_token_mlp__prompt_kernel_reload194
    s_branch interleave_layers__ssm_conv_s4d__mixer_token_mlp__prompt_kernel_ok239
interleave_layers__ssm_conv_s4d__mixer_token_mlp__prompt_kernel_rt240:
    s_call_b64 s[44:45], interleave_layers__ssm_conv_s4d__mixer_token_mlp__prompt_kernel_reload195
    s_branch interleave_layers__ssm_conv_s4d__mixer_token_mlp__prompt_kernel_ok241
interleave_layers__ssm_conv_s4d__mixer_token_mlp__prompt_kernel_rt242:
    s_call_b64 s[44:45], interleave_layers__ssm_conv_s4d__mixer_token_mlp__prompt_kernel_reload196
    s_branch interleave_layers__ssm_conv_s4d__mixer_token_mlp__prompt_kernel_ok243
interleave_layers__ssm_conv_s4d__mixer_token_mlp__prompt_kernel_rt244:
    s_call_b64 s[44:45], interleave_layers__ssm_conv_s4d__mixer_token_mlp__prompt_kernel_reload197
    s_branch interleave_layers__ssm_conv_s4d__mixer_token_mlp__prompt_kernel_ok245
interleave_layers__ssm_conv_s4d__mixer_token_mlp__prompt_kernel_rt246:
    s_call_b64 s[44:45], interleave_layers__ssm_conv_s4d__mixer_token_mlp__prompt_kernel_reload198
    s_branch interleave_layers__ssm_conv_s4d__mixer_token_mlp__prompt_kernel_ok247
interleave_layers__ssm_conv_s4d__mixer_token_mlp__prompt_kernel_rt248:
    s_call_b64 s[44:45], interleave_layers__ssm_conv_s4d__mixer_token_mlp__prompt_kernel_reload199
    s_branch interleave_layers__ssm_conv_s4d__mixer_token_mlp__prompt_kernel_ok249
interleave_layers__ssm_conv_s4d__mixer_token_mlp__prompt_kernel_rt250:
    s_call_b64 s[44:45], interleave_layers__ssm_conv_s4d__mixer_token_mlp__prompt_kernel_reload194
    s_branch interleave_layers__ssm_conv_s4d__mixer_token_mlp__prompt_kernel_ok251
interleave_layers__ssm_conv_s4d__mixer_token_mlp__prompt_kernel_rt252:
    s_call_b64 s[44:45], interleave_layers__ssm_conv_s4d__mixer_token_mlp__prompt_kernel_reload195
    s_branch interleave_layers__ssm_conv_s4d__mixer_token_mlp__prompt_kernel_ok253
interleave_layers__ssm_conv_s4d__mixer_token_mlp__prompt_kernel_rt254:
    s_call_b64 s[44:45], interleave_layers__ssm_conv_s4d__mixer_token_mlp__prompt_kernel_reload196
    s_branch interleave_layers__ssm_conv_s4d__mixer_token_mlp__prompt_kernel_ok255
interleave_layers__ssm_conv_s4d__mixer_token_mlp__prompt_kernel_rt256:
    s_call_b64 s[44:45], interleave_layers__ssm_conv_s4d__mixer_token_mlp__prompt_kernel_reload197
    s_branch interleave_layers__ssm_conv_s4d__mixer_token_mlp__prompt_kernel_ok257
interleave_layers__ssm_conv_s4d__mixer_token_mlp__prompt_kernel_rt258:
    s_call_b64 s[44:45], interleave_layers__ssm_conv_s4d__mixer_token_mlp__prompt_kernel_reload198
    s_branch interleave_layers__ssm_conv_s4d__mixer_token_mlp__prompt_kernel_ok259
interleave_layers__ssm_conv_s4d__mixer_token_mlp__prompt_kernel_rt260:
    s_call_b64 s[44:45], interleave_layers__ssm_conv_s4d__mixer_token_mlp__prompt_kernel_reload199
    s_branch interleave_layers__ssm_conv_s4d__mixer_token_mlp__prompt_kernel_ok261
interleave_layers__ssm_conv_s4d__mixer_token_mlp__prompt_kernel_rt262:
    s_call_b64 s[44:45], interleave_layers__ssm_conv_s4d__mixer_token_mlp__prompt_kernel_reload194
    s_branch interleave_layers__ssm_conv_s4d__mixer_token_mlp__prompt_kernel_ok263
interleave_layers__ssm_conv_s4d__mixer_token_mlp__prompt_kernel_rt264:
    s_call_b64 s[44:45], interleave_layers__ssm_conv_s4d__mixer_token_mlp__prompt_kernel_reload195
    s_branch interleave_layers__ssm_conv_s4d__mixer_token_mlp__prompt_kernel_ok265
interleave_layers__ssm_conv_s4d__mixer_token_mlp__prompt_kernel_rt266:
    s_call_b64 s[44:45], interleave_layers__ssm_conv_s4d__mixer_token_mlp__prompt_kernel_reload196
    s_branch interleave_layers__ssm_conv_s4d__mixer_token_mlp__prompt_kernel_ok267
interleave_layers__ssm_conv_s4d__mixer_token_mlp__prompt_kernel_rt268:
    s_call_b64 s[44:45], interleave_layers__ssm_conv_s4d__mixer_token_mlp__prompt_kernel_reload197
    s_waitcnt vmcnt(0)
    s_branch interleave_layers__ssm_conv_s4d__mixer_token_mlp__prompt_kernel_ok269
interleave_layers__ssm_conv_s4d__mixer_token_mlp__prompt_kernel_rt270:
    s_call_b64 s[44:45], interleave_layers__ssm_conv_s4d__mixer_token_mlp__prompt_kernel_reload198
    s_waitcnt vmcnt(0)
    s_branch interleave_layers__ssm_conv_s4d__mixer_token_mlp__prompt_kernel_ok271
interleave_layers__ssm_conv_s4d__mixer_token_mlp__prompt_kernel_rt272:
    s_call_b64 s[44:45], interleave_layers__ssm_conv_s4d__mixer_token_mlp__prompt_kernel_reload199
    s_waitcnt vmcnt(0)
    s_branch interleave_layers__ssm_conv_s4d__mixer_token_mlp__prompt_kernel_ok273
interleave_layers__ssm_conv_s4d__mixer_token_mlp__prompt_kernel_rt274:
    s_call_b64 s[44:45], interleave_layers__ssm_conv_s4d__mixer_token_mlp__prompt_kernel_reload194
    s_waitcnt vmcnt(0)
    s_branch interleave_layers__ssm_conv_s4d__mixer_token_mlp__prompt_kernel_ok275
interleave_layers__ssm_conv_s4d__mixer_token_mlp__prompt_kernel_x3rt276:
    s_mov_b32 m0, s87
    v_and_b32 v98, 63, v0
    v_lshlrev_b32 v98, 2, v98
    buffer_load_dwordx4 v2, s[52:55], s84 offen offset:0 sc1 lds
    buffer_load_dwordx4 v2, s[52:55], s85 offen offset:1024 sc1 lds
    s_lshl_b32 s42, s3, 8
    s_add_u32 m0, s42, 44032
    s_nop 0
    buffer_load_dword v98, s[52:55], s88 offen sc1 lds
    s_waitcnt vmcnt(0)
    v_and_b32 v96, 0xc0, v0
    v_and_b32 v97, 15, v0
    v_lshlrev_b32_e64 v96, 2, v96
    v_lshl_add_u32 v96, v97, 3, v96
    ds_read_b64_tr_b16 v[80:81], v12 offset:0
    ds_read_b64_tr_b16 v[82:83], v12 offset:512
    ds_read_b64_tr_b16 v[84:85], v12 offset:1024
    ds_read_b64_tr_b16 v[86:87], v12 offset:1536
    ds_read_b64 v[92:93], v96 offset:44032
    ds_read_b64 v[94:95], v96 offset:44160
    s_nop 0
    s_waitcnt lgkmcnt(0)
    v_pk_max_u16 v5, v80, v81
    v_pk_max_u16 v5, v5, v82
    v_pk_max_u16 v5, v5, v83
    v_pk_max_u16 v5, v5, v84
    v_pk_max_u16 v5, v5, v85
    v_pk_max_u16 v5, v5, v86
    v_pk_max_u16 v5, v5, v87
    v_lshlrev_b32_e64 v97, 16, v5
    v_max3_u32 v97, v97, v92, v94
    v_cmp_u_f32 vcc, v5, v97
    s_add_u32 s43, s43, 1
    s_cmp_ge_u32 s43, 32768
    s_cbranch_scc1 interleave_layers__ssm_conv_s4d__mixer_token_mlp__prompt_kernel_x3ok277
    s_cbranch_vccnz interleave_layers__ssm_conv_s4d__mixer_token_mlp__prompt_kernel_x3rt276
    s_branch interleave_layers__ssm_conv_s4d__mixer_token_mlp__prompt_kernel_x3ok277
interleave_layers__ssm_conv_s4d__mixer_token_mlp__prompt_kernel_rt278:
    s_call_b64 s[44:45], interleave_layers__ssm_conv_s4d__mixer_token_mlp__prompt_kernel_reload195
    s_waitcnt vmcnt(0)
    s_branch interleave_layers__ssm_conv_s4d__mixer_token_mlp__prompt_kernel_ok279
interleave_layers__ssm_conv_s4d__mixer_token_mlp__prompt_kernel_g1idle206:
    s_mov_b32 s39, 5
interleave_layers__ssm_conv_s4d__mixer_token_mlp__prompt_kernel_walk280:
    s_and_b32 s40, s39, 31
    v_readlane_b32 s41, v4, s40
    s_add_u32 s39, s39, 1
    s_cmp_lt_u32 s39, 40
    s_nop 2
    buffer_load_dwordx4 v[72:75], v2, s[52:55], s41 offen sc1
    buffer_load_dwordx4 v[76:79], v3, s[52:55], s41 offen sc1
    s_waitcnt vmcnt(8)
    s_cbranch_scc1 interleave_layers__ssm_conv_s4d__mixer_token_mlp__prompt_kernel_walk280
    s_mov_b32 s43, 0
interleave_layers__ssm_conv_s4d__mixer_token_mlp__prompt_kernel_x3rt281:
    s_mov_b32 m0, s87
    v_and_b32 v98, 63, v0
    v_lshlrev_b32_e64 v98, 2, v98
    buffer_load_dwordx4 v2, s[52:55], s84 offen offset:0 sc1 lds
    buffer_load_dwordx4 v2, s[52:55], s85 offen offset:1024 sc1 lds
    s_lshl_b32 s42, s3, 8
    s_add_u32 m0, s42, 44032
    s_nop 0
    buffer_load_dword v98, s[52:55], s88 offen sc1 lds
    s_waitcnt vmcnt(0)
    v_and_b32 v96, 0xc0, v0
    v_and_b32 v97, 15, v0
    v_lshlrev_b32_e64 v96, 2, v96
    v_lshl_add_u32 v96, v97, 3, v96
    ds_read_b64_tr_b16 v[80:81], v12 offset:0
    ds_read_b64_tr_b16 v[82:83], v12 offset:512
    ds_read_b64_tr_b16 v[84:85], v12 offset:1024
    ds_read_b64_tr_b16 v[86:87], v12 offset:1536
    ds_read_b64 v[92:93], v96 offset:44032
    ds_read_b64 v[94:95], v96 offset:44160
    s_nop 0
    s_waitcnt lgkmcnt(0)
    v_pk_max_u16 v5, v80, v81
    v_pk_max_u16 v5, v5, v82
    v_pk_max_u16 v5, v5, v83
    v_pk_max_u16 v5, v5, v84
    v_pk_max_u16 v5, v5, v85
    v_pk_max_u16 v5, v5, v86
    v_pk_max_u16 v5, v5, v87
    v_lshlrev_b32_e64 v97, 16, v5
    v_max3_u32 v97, v97, v92, v94
    v_cmp_u_f32 vcc, v5, v97
    s_add_u32 s43, s43, 1
    s_cmp_ge_u32 s43, 32768
    s_cbranch_scc1 interleave_layers__ssm_conv_s4d__mixer_token_mlp__prompt_kernel_x3ok282
    s_cbranch_vccnz interleave_layers__ssm_conv_s4d__mixer_token_mlp__prompt_kernel_x3rt281
interleave_layers__ssm_conv_s4d__mixer_token_mlp__prompt_kernel_x3ok282:
    v_lshlrev_b32_e64 v72, 16, v80
    v_and_b32 v73, 0xffff0000, v80
    v_lshlrev_b32_e64 v74, 16, v81
    v_and_b32 v75, 0xffff0000, v81
    v_lshlrev_b32_e64 v76, 16, v82
    v_and_b32 v77, 0xffff0000, v82
    v_lshlrev_b32_e64 v78, 16, v83
    v_and_b32 v79, 0xffff0000, v83
    v_fma_f32 v72, v72, v92, v93
    v_fma_f32 v73, v73, v92, v93
    v_fma_f32 v74, v74, v92, v93
    v_fma_f32 v75, v75, v92, v93
    v_fma_f32 v76, v76, v94, v95
    v_fma_f32 v77, v77, v94, v95
    v_fma_f32 v78, v78, v94, v95
    v_fma_f32 v79, v79, v94, v95
    v_readlane_b32 s7, v4, 32
    v_readlane_b32 s12, v4, 39
    v_readlane_b32 s13, v4, 33
    v_readlane_b32 s14, v4, 40
    v_readlane_b32 s15, v4, 34
    v_readlane_b32 s70, v4, 41
    buffer_load_dwordx4 v[68:71], v3, s[52:55], s7 offen sc1
    buffer_load_dwordx4 v[64:67], v2, s[52:55], s7 offen sc1
    buffer_load_dwordx4 v[52:55], v3, s[52:55], s12 offen sc1
    buffer_load_dwordx4 v[48:51], v2, s[52:55], s12 offen sc1
    buffer_load_dwordx4 v[44:47], v3, s[52:55], s13 offen sc1
    buffer_load_dwordx4 v[40:43], v2, s[52:55], s13 offen sc1
    buffer_load_dwordx4 v[36:39], v3, s[52:55], s14 offen sc1
    buffer_load_dwordx4 v[32:35], v2, s[52:55], s14 offen sc1
    buffer_load_dwordx4 v[28:31], v3, s[52:55], s15 offen sc1
    buffer_load_dwordx4 v[24:27], v2, s[52:55], s15 offen sc1
    s_nop 0
    s_waitcnt vmcnt(0) lgkmcnt(0)
    s_branch interleave_layers__ssm_conv_s4d__mixer_token_mlp__prompt_kernel_g1skip207
interleave_layers__ssm_conv_s4d__mixer_token_mlp__prompt_kernel_reload200:
    s_sleep 2
    buffer_load_dwordx4 v[68:71], v3, s[52:55], s7 offen sc1
    buffer_load_dwordx4 v[64:67], v2, s[52:55], s7 offen sc1
    buffer_load_dwordx4 v[52:55], v3, s[52:55], s12 offen sc1
    buffer_load_dwordx4 v[48:51], v2, s[52:55], s12 offen sc1
    buffer_load_dwordx4 v[44:47], v3, s[52:55], s13 offen sc1
    buffer_load_dwordx4 v[40:43], v2, s[52:55], s13 offen sc1
    buffer_load_dwordx4 v[36:39], v3, s[52:55], s14 offen sc1
    buffer_load_dwordx4 v[32:35], v2, s[52:55], s14 offen sc1
    buffer_load_dwordx4 v[28:31], v3, s[52:55], s15 offen sc1
    buffer_load_dwordx4 v[24:27], v2, s[52:55], s15 offen sc1
    s_add_u32 s43, s43, 1
    s_waitcnt vmcnt(8)
    v_cmp_u_f32_e64 vcc, v64, v68
    s_cmp_ge_u32 s43, 32768
    s_cbranch_scc1 interleave_layers__ssm_conv_s4d__mixer_token_mlp__prompt_kernel_rfin283
    s_cbranch_vccnz interleave_layers__ssm_conv_s4d__mixer_token_mlp__prompt_kernel_reload200
interleave_layers__ssm_conv_s4d__mixer_token_mlp__prompt_kernel_rfin283:
    s_setpc_b64 s[44:45]
interleave_layers__ssm_conv_s4d__mixer_token_mlp__prompt_kernel_reload201:
    s_sleep 2
    buffer_load_dwordx4 v[52:55], v3, s[52:55], s12 offen sc1
    buffer_load_dwordx4 v[48:51], v2, s[52:55], s12 offen sc1
    buffer_load_dwordx4 v[44:47], v3, s[52:55], s13 offen sc1
    buffer_load_dwordx4 v[40:43], v2, s[52:55], s13 offen sc1
    buffer_load_dwordx4 v[36:39], v3, s[52:55], s14 offen sc1
    buffer_load_dwordx4 v[32:35], v2, s[52:55], s14 offen sc1
    buffer_load_dwordx4 v[28:31], v3, s[52:55], s15 offen sc1
    buffer_load_dwordx4 v[24:27], v2, s[52:55], s15 offen sc1
    buffer_load_dwordx4 v[140:143], v3, s[52:55], s70 offen sc1
    buffer_load_dwordx4 v[136:139], v2, s[52:55], s70 offen sc1
    s_add_u32 s43, s43, 1
    s_waitcnt vmcnt(8)
    v_cmp_u_f32_e64 vcc, v48, v52
    s_cmp_ge_u32 s43, 32768
    s_cbranch_scc1 interleave_layers__ssm_conv_s4d__mixer_token_mlp__prompt_kernel_rfin284
    s_cbranch_vccnz interleave_layers__ssm_conv_s4d__mixer_token_mlp__prompt_kernel_reload201
interleave_layers__ssm_conv_s4d__mixer_token_mlp__prompt_kernel_rfin284:
    s_setpc_b64 s[44:45]
interleave_layers__ssm_conv_s4d__mixer_token_mlp__prompt_kernel_reload202:
    s_sleep 2
    buffer_load_dwordx4 v[44:47], v3, s[52:55], s13 offen sc1
    buffer_load_dwordx4 v[40:43], v2, s[52:55], s13 offen sc1
    buffer_load_dwordx4 v[36:39], v3, s[52:55], s14 offen sc1
    buffer_load_dwordx4 v[32:35], v2, s[52:55], s14 offen sc1
    buffer_load_dwordx4 v[28:31], v3, s[52:55], s15 offen sc1
    buffer_load_dwordx4 v[24:27], v2, s[52:55], s15 offen sc1
    buffer_load_dwordx4 v[140:143], v3, s[52:55], s70 offen sc1
    buffer_load_dwordx4 v[136:139], v2, s[52:55], s70 offen sc1
    buffer_load_dwordx4 v[68:71], v3, s[52:55], s7 offen sc1
    buffer_load_dwordx4 v[64:67], v2, s[52:55], s7 offen sc1
    s_add_u32 s43, s43, 1
    s_waitcnt vmcnt(8)
    v_cmp_u_f32_e64 vcc, v40, v44
    s_cmp_ge_u32 s43, 32768
    s_cbranch_scc1 interleave_layers__ssm_conv_s4d__mixer_token_mlp__prompt_kernel_rfin285
    s_cbranch_vccnz interleave_layers__ssm_conv_s4d__mixer_token_mlp__prompt_kernel_reload202
interleave_layers__ssm_conv_s4d__mixer_token_mlp__prompt_kernel_rfin285:
    s_setpc_b64 s[44:45]
interleave_layers__ssm_conv_s4d__mixer_token_mlp__prompt_kernel_reload203:
    s_sleep 2
    buffer_load_dwordx4 v[36:39], v3, s[52:55], s14 offen sc1
    buffer_load_dwordx4 v[32:35], v2, s[52:55], s14 offen sc1
    buffer_load_dwordx4 v[28:31], v3, s[52:55], s15 offen sc1
    buffer_load_dwordx4 v[24:27], v2, s[52:55], s15 offen sc1
    buffer_load_dwordx4 v[140:143], v3, s[52:55], s70 offen sc1
    buffer_load_dwordx4 v[136:139], v2, s[52:55], s70 offen sc1
    buffer_load_dwordx4 v[68:71], v3, s[52:55], s7 offen sc1
    buffer_load_dwordx4 v[64:67], v2, s[52:55], s7 offen sc1
    buffer_load_dwordx4 v[52:55], v3, s[52:55], s12 offen sc1
    buffer_load_dwordx4 v[48:51], v2, s[52:55], s12 offen sc1
    s_add_u32 s43, s43, 1
    s_waitcnt vmcnt(8)
    v_cmp_u_f32_e64 vcc, v32, v36
    s_cmp_ge_u32 s43, 32768
    s_cbranch_scc1 interleave_layers__ssm_conv_s4d__mixer_token_mlp__prompt_kernel_rfin286
    s_cbranch_vccnz interleave_layers__ssm_conv_s4d__mixer_token_mlp__prompt_kernel_reload203
interleave_layers__ssm_conv_s4d__mixer_token_mlp__prompt_kernel_rfin286:
    s_setpc_b64 s[44:45]
interleave_layers__ssm_conv_s4d__mixer_token_mlp__prompt_kernel_reload204:
    s_sleep 2
    buffer_load_dwordx4 v[28:31], v3, s[52:55], s15 offen sc1
    buffer_load_dwordx4 v[24:27], v2, s[52:55], s15 offen sc1
    buffer_load_dwordx4 v[140:143], v3, s[52:55], s70 offen sc1
    buffer_load_dwordx4 v[136:139], v2, s[52:55], s70 offen sc1
    buffer_load_dwordx4 v[68:71], v3, s[52:55], s7 offen sc1
    buffer_load_dwordx4 v[64:67], v2, s[52:55], s7 offen sc1
    buffer_load_dwordx4 v[52:55], v3, s[52:55], s12 offen sc1
    buffer_load_dwordx4 v[48:51], v2, s[52:55], s12 offen sc1
    buffer_load_dwordx4 v[44:47], v3, s[52:55], s13 offen sc1
    buffer_load_dwordx4 v[40:43], v2, s[52:55], s13 offen sc1
    s_add_u32 s43, s43, 1
    s_waitcnt vmcnt(8)
    v_cmp_u_f32_e64 vcc, v24, v28
    s_cmp_ge_u32 s43, 32768
    s_cbranch_scc1 interleave_layers__ssm_conv_s4d__mixer_token_mlp__prompt_kernel_rfin287
    s_cbranch_vccnz interleave_layers__ssm_conv_s4d__mixer_token_mlp__prompt_kernel_reload204
interleave_layers__ssm_conv_s4d__mixer_token_mlp__prompt_kernel_rfin287:
    s_setpc_b64 s[44:45]
interleave_layers__ssm_conv_s4d__mixer_token_mlp__prompt_kernel_reload205:
    s_sleep 2
    buffer_load_dwordx4 v[140:143], v3, s[52:55], s70 offen sc1
    buffer_load_dwordx4 v[136:139], v2, s[52:55], s70 offen sc1
    buffer_load_dwordx4 v[68:71], v3, s[52:55], s7 offen sc1
    buffer_load_dwordx4 v[64:67], v2, s[52:55], s7 offen sc1
    buffer_load_dwordx4 v[52:55], v3, s[52:55], s12 offen sc1
    buffer_load_dwordx4 v[48:51], v2, s[52:55], s12 offen sc1
    buffer_load_dwordx4 v[44:47], v3, s[52:55], s13 offen sc1
    buffer_load_dwordx4 v[40:43], v2, s[52:55], s13 offen sc1
    buffer_load_dwordx4 v[36:39], v3, s[52:55], s14 offen sc1
    buffer_load_dwordx4 v[32:35], v2, s[52:55], s14 offen sc1
    s_add_u32 s43, s43, 1
    s_waitcnt vmcnt(8)
    v_cmp_u_f32_e64 vcc, v136, v140
    s_cmp_ge_u32 s43, 32768
    s_cbranch_scc1 interleave_layers__ssm_conv_s4d__mixer_token_mlp__prompt_kernel_rfin288
    s_cbranch_vccnz interleave_layers__ssm_conv_s4d__mixer_token_mlp__prompt_kernel_reload205
interleave_layers__ssm_conv_s4d__mixer_token_mlp__prompt_kernel_rfin288:
    s_setpc_b64 s[44:45]
interleave_layers__ssm_conv_s4d__mixer_token_mlp__prompt_kernel_rt289:
    s_call_b64 s[44:45], interleave_layers__ssm_conv_s4d__mixer_token_mlp__prompt_kernel_reload200
    s_waitcnt vmcnt(0)
    s_branch interleave_layers__ssm_conv_s4d__mixer_token_mlp__prompt_kernel_ok290
interleave_layers__ssm_conv_s4d__mixer_token_mlp__prompt_kernel_rt291:
    s_call_b64 s[44:45], interleave_layers__ssm_conv_s4d__mixer_token_mlp__prompt_kernel_reload201
    s_waitcnt vmcnt(0)
    s_branch interleave_layers__ssm_conv_s4d__mixer_token_mlp__prompt_kernel_ok292
interleave_layers__ssm_conv_s4d__mixer_token_mlp__prompt_kernel_rt293:
    s_call_b64 s[44:45], interleave_layers__ssm_conv_s4d__mixer_token_mlp__prompt_kernel_reload202
    s_waitcnt vmcnt(0)
    s_branch interleave_layers__ssm_conv_s4d__mixer_token_mlp__prompt_kernel_ok294
interleave_layers__ssm_conv_s4d__mixer_token_mlp__prompt_kernel_rt295:
    s_call_b64 s[44:45], interleave_layers__ssm_conv_s4d__mixer_token_mlp__prompt_kernel_reload203
    s_waitcnt vmcnt(0)
    s_branch interleave_layers__ssm_conv_s4d__mixer_token_mlp__prompt_kernel_ok296
interleave_layers__ssm_conv_s4d__mixer_token_mlp__prompt_kernel_rt297:
    s_call_b64 s[44:45], interleave_layers__ssm_conv_s4d__mixer_token_mlp__prompt_kernel_reload204
    s_waitcnt vmcnt(0)
    s_branch interleave_layers__ssm_conv_s4d__mixer_token_mlp__prompt_kernel_ok298
interleave_layers__ssm_conv_s4d__mixer_token_mlp__prompt_kernel_rt299:
    s_call_b64 s[44:45], interleave_layers__ssm_conv_s4d__mixer_token_mlp__prompt_kernel_reload205
    s_branch interleave_layers__ssm_conv_s4d__mixer_token_mlp__prompt_kernel_ok300
interleave_layers__ssm_conv_s4d__mixer_token_mlp__prompt_kernel_rt301:
    s_call_b64 s[44:45], interleave_layers__ssm_conv_s4d__mixer_token_mlp__prompt_kernel_reload200
    s_branch interleave_layers__ssm_conv_s4d__mixer_token_mlp__prompt_kernel_ok302
interleave_layers__ssm_conv_s4d__mixer_token_mlp__prompt_kernel_rt303:
    s_call_b64 s[44:45], interleave_layers__ssm_conv_s4d__mixer_token_mlp__prompt_kernel_reload201
    s_branch interleave_layers__ssm_conv_s4d__mixer_token_mlp__prompt_kernel_ok304
interleave_layers__ssm_conv_s4d__mixer_token_mlp__prompt_kernel_rt305:
    s_call_b64 s[44:45], interleave_layers__ssm_conv_s4d__mixer_token_mlp__prompt_kernel_reload202
    s_branch interleave_layers__ssm_conv_s4d__mixer_token_mlp__prompt_kernel_ok306
interleave_layers__ssm_conv_s4d__mixer_token_mlp__prompt_kernel_rt307:
    s_call_b64 s[44:45], interleave_layers__ssm_conv_s4d__mixer_token_mlp__prompt_kernel_reload203
    s_branch interleave_layers__ssm_conv_s4d__mixer_token_mlp__prompt_kernel_ok308
interleave_layers__ssm_conv_s4d__mixer_token_mlp__prompt_kernel_rt309:
    s_call_b64 s[44:45], interleave_layers__ssm_conv_s4d__mixer_token_mlp__prompt_kernel_reload204
    s_branch interleave_layers__ssm_conv_s4d__mixer_token_mlp__prompt_kernel_ok310
interleave_layers__ssm_conv_s4d__mixer_token_mlp__prompt_kernel_rt311:
    s_call_b64 s[44:45], interleave_layers__ssm_conv_s4d__mixer_token_mlp__prompt_kernel_reload205
    s_branch interleave_layers__ssm_conv_s4d__mixer_token_mlp__prompt_kernel_ok312
interleave_layers__ssm_conv_s4d__mixer_token_mlp__prompt_kernel_rt313:
    s_call_b64 s[44:45], interleave_layers__ssm_conv_s4d__mixer_token_mlp__prompt_kernel_reload200
    s_branch interleave_layers__ssm_conv_s4d__mixer_token_mlp__prompt_kernel_ok314
interleave_layers__ssm_conv_s4d__mixer_token_mlp__prompt_kernel_rt315:
    s_call_b64 s[44:45], interleave_layers__ssm_conv_s4d__mixer_token_mlp__prompt_kernel_reload201
    s_branch interleave_layers__ssm_conv_s4d__mixer_token_mlp__prompt_kernel_ok316
interleave_layers__ssm_conv_s4d__mixer_token_mlp__prompt_kernel_rt317:
    s_call_b64 s[44:45], interleave_layers__ssm_conv_s4d__mixer_token_mlp__prompt_kernel_reload202
    s_branch interleave_layers__ssm_conv_s4d__mixer_token_mlp__prompt_kernel_ok318
interleave_layers__ssm_conv_s4d__mixer_token_mlp__prompt_kernel_rt319:
    s_call_b64 s[44:45], interleave_layers__ssm_conv_s4d__mixer_token_mlp__prompt_kernel_reload203
    s_branch interleave_layers__ssm_conv_s4d__mixer_token_mlp__prompt_kernel_ok320
interleave_layers__ssm_conv_s4d__mixer_token_mlp__prompt_kernel_rt321:
    s_call_b64 s[44:45], interleave_layers__ssm_conv_s4d__mixer_token_mlp__prompt_kernel_reload204
    s_branch interleave_layers__ssm_conv_s4d__mixer_token_mlp__prompt_kernel_ok322
interleave_layers__ssm_conv_s4d__mixer_token_mlp__prompt_kernel_rt323:
    s_call_b64 s[44:45], interleave_layers__ssm_conv_s4d__mixer_token_mlp__prompt_kernel_reload205
    s_branch interleave_layers__ssm_conv_s4d__mixer_token_mlp__prompt_kernel_ok324
interleave_layers__ssm_conv_s4d__mixer_token_mlp__prompt_kernel_rt325:
    s_call_b64 s[44:45], interleave_layers__ssm_conv_s4d__mixer_token_mlp__prompt_kernel_reload200
    s_branch interleave_layers__ssm_conv_s4d__mixer_token_mlp__prompt_kernel_ok326
interleave_layers__ssm_conv_s4d__mixer_token_mlp__prompt_kernel_rt327:
    s_call_b64 s[44:45], interleave_layers__ssm_conv_s4d__mixer_token_mlp__prompt_kernel_reload201
    s_branch interleave_layers__ssm_conv_s4d__mixer_token_mlp__prompt_kernel_ok328
interleave_layers__ssm_conv_s4d__mixer_token_mlp__prompt_kernel_rt329:
    s_call_b64 s[44:45], interleave_layers__ssm_conv_s4d__mixer_token_mlp__prompt_kernel_reload202
    s_branch interleave_layers__ssm_conv_s4d__mixer_token_mlp__prompt_kernel_ok330
interleave_layers__ssm_conv_s4d__mixer_token_mlp__prompt_kernel_rt331:
    s_call_b64 s[44:45], interleave_layers__ssm_conv_s4d__mixer_token_mlp__prompt_kernel_reload203
    s_branch interleave_layers__ssm_conv_s4d__mixer_token_mlp__prompt_kernel_ok332
interleave_layers__ssm_conv_s4d__mixer_token_mlp__prompt_kernel_rt333:
    s_call_b64 s[44:45], interleave_layers__ssm_conv_s4d__mixer_token_mlp__prompt_kernel_reload204
    s_branch interleave_layers__ssm_conv_s4d__mixer_token_mlp__prompt_kernel_ok334
interleave_layers__ssm_conv_s4d__mixer_token_mlp__prompt_kernel_rt335:
    s_call_b64 s[44:45], interleave_layers__ssm_conv_s4d__mixer_token_mlp__prompt_kernel_reload205
    s_branch interleave_layers__ssm_conv_s4d__mixer_token_mlp__prompt_kernel_ok336
interleave_layers__ssm_conv_s4d__mixer_token_mlp__prompt_kernel_rt337:
    s_call_b64 s[44:45], interleave_layers__ssm_conv_s4d__mixer_token_mlp__prompt_kernel_reload200
    s_waitcnt vmcnt(0)
    s_branch interleave_layers__ssm_conv_s4d__mixer_token_mlp__prompt_kernel_ok338
interleave_layers__ssm_conv_s4d__mixer_token_mlp__prompt_kernel_rt339:
    s_call_b64 s[44:45], interleave_layers__ssm_conv_s4d__mixer_token_mlp__prompt_kernel_reload201
    s_waitcnt vmcnt(0)
    s_branch interleave_layers__ssm_conv_s4d__mixer_token_mlp__prompt_kernel_ok340
interleave_layers__ssm_conv_s4d__mixer_token_mlp__prompt_kernel_rt341:
    s_call_b64 s[44:45], interleave_layers__ssm_conv_s4d__mixer_token_mlp__prompt_kernel_reload202
    s_waitcnt vmcnt(0)
    s_branch interleave_layers__ssm_conv_s4d__mixer_token_mlp__prompt_kernel_ok342
interleave_layers__ssm_conv_s4d__mixer_token_mlp__prompt_kernel_rt343:
    s_call_b64 s[44:45], interleave_layers__ssm_conv_s4d__mixer_token_mlp__prompt_kernel_reload203
    s_waitcnt vmcnt(0)
    s_branch interleave_layers__ssm_conv_s4d__mixer_token_mlp__prompt_kernel_ok344
.p2align 4
.type interleave_layers__ssm_conv_s4d__mixer_token_mlp__prompt_kernel_order,@object
interleave_layers__ssm_conv_s4d__mixer_token_mlp__prompt_kernel_order:
.long 0x54983210, 0xfedcba76, 0x76543210, 0xdcba98
.long 0xa0765432, 0xfedc981b, 0x91065432, 0xdcb87a
.long 0x32107654, 0xfebadc98, 0xb3210654, 0xda987c
.long 0x54321076, 0xdfecba98, 0xd5432106, 0xcba987
.long 0xdc10ba98, 0x765432fe, 0xdcba987, 0x654321
.long 0x28fedcba, 0x76541093, 0x287dcba9, 0x654103
.long 0xba98fedc, 0x76325410, 0x4a987dcb, 0x632105
.long 0xdcba98fe, 0x57643210, 0x6cba987d, 0x543210
.size interleave_layers__ssm_conv_s4d__mixer_token_mlp__prompt_kernel_order, 128
interleave_layers__ssm_conv_s4d__mixer_token_mlp__prompt_kernel_codeend:

.section .rodata,"a"
.p2align 6
.amdhsa_kernel interleave_layers__ssm_conv_s4d__mixer_token_mlp__prompt_kernel
  .amdhsa_next_free_vgpr 512
  .amdhsa_next_free_sgpr 89
  .amdhsa_accum_offset 256
  .amdhsa_group_segment_fixed_size 0
  .amdhsa_kernarg_size 120
  .amdhsa_user_sgpr_count 2
  .amdhsa_user_sgpr_kernarg_segment_ptr 1
  .amdhsa_system_sgpr_workgroup_id_x 1
  .amdhsa_float_denorm_mode_32 3
.end_amdhsa_kernel
```
